```python
import torch

def _softmax(x, axis=-1):
    return torch.softmax(x, dim=axis)
def _gelu(x):
    return torch.nn.functional.gelu(x, approximate="tanh")
def _silu(x):
    return torch.nn.functional.silu(x)
def _sigmoid(x):
    return torch.sigmoid(x)
def _layernorm(x, axis=-1, eps=1e-5):
    m = x.mean(dim=axis, keepdim=True)
    v = x.var(dim=axis, keepdim=True, unbiased=False)
    return (x - m) / torch.sqrt(v + eps)
def _scatter_add(tgt, idx, src, axis=0):
    return tgt.clone().index_add_(axis, idx, src)
def _segment_sum(src, seg, n):
    out = torch.zeros((n,) + src.shape[1:], dtype=src.dtype)
    return out.index_add_(0, seg, src)
def _pad(x, pw):
    flat = tuple(v for pair in reversed(pw) for v in pair)
    return torch.nn.functional.pad(x, flat)

kernel_name = 'concat_heads__mha_block_cached__gqa_block_cached__near_ridge'

def setup_inputs():

    _w = (lambda a: (lambda t: t.to(torch.bfloat16) if t.is_floating_point() else t)(torch.as_tensor(a)))
    def _A_setup():
        B, Sq, D = 8, 192, 640
        H, Sk, Dh = 32, 512, 192
        return {
            "x": _w((lambda *s: torch.randn(*s, dtype=torch.bfloat16) * 0.8)(B, Sq, D)),
            "k_cache": _w((lambda *s: torch.randn(*s, dtype=torch.bfloat16) * 0.8)(B, H, Sk, Dh)),
            "v_cache": _w((lambda *s: torch.randn(*s, dtype=torch.bfloat16) * 0.05)(B, H, Sk, Dh)),
            "wq": _w((lambda *s: torch.randn(*s, dtype=torch.bfloat16) * 0.8)(D, H * Dh) * (D ** -0.5)),
            "wo": _w((lambda *s: torch.randn(*s, dtype=torch.bfloat16) * 0.05)(H * Dh, D) * ((H * Dh) ** -0.5)),
        }
    _A_in = _A_setup()

    def _B_setup():
        B, Sq, D = 8, 192, 640
        Hq, Hkv, Sk, Dh = 32, 32, 512, 192
        assert Hq % Hkv == 0, (Hq, Hkv)
        return {
            "x": _w((lambda *s: torch.randn(*s, dtype=torch.bfloat16) * 0.8)(B, Sq, D)),
            "k_cache": _w((lambda *s: torch.randn(*s, dtype=torch.bfloat16) * 0.8)(B, Hkv, Sk, Dh)),
            "v_cache": _w((lambda *s: torch.randn(*s, dtype=torch.bfloat16) * 0.05)(B, Hkv, Sk, Dh)),
            "wq": _w((lambda *s: torch.randn(*s, dtype=torch.bfloat16) * 0.8)(D, Hq * Dh) * (D ** -0.5)),
            "wo": _w((lambda *s: torch.randn(*s, dtype=torch.bfloat16) * 0.05)(Hq * Dh, D) * ((Hq * Dh) ** -0.5)),
        }
    _B_in = _B_setup()

    return {
        "A_x": _A_in["x"],
        "A_k_cache": _A_in["k_cache"],
        "A_v_cache": _A_in["v_cache"],
        "A_wq": _A_in["wq"],
        "A_wo": _A_in["wo"],
        "B_x": _B_in["x"],
        "B_k_cache": _B_in["k_cache"],
        "B_v_cache": _B_in["v_cache"],
        "B_wq": _B_in["wq"],
        "B_wo": _B_in["wo"],
    }

def reference(A_x, A_k_cache, A_v_cache, A_wq, A_wo, B_x, B_k_cache, B_v_cache, B_wq, B_wo):
    def _A_ref(x, k_cache, v_cache, wq, wo):
        B, Sq, D = x.shape
        H, Dh = 32, 192
        q = (lambda x, *d: x.permute(*d))((x @ wq).reshape(B, Sq, H, Dh), 0, 2, 1, 3)
        scores = torch.einsum("bhqd,bhkd->bhqk", q, k_cache) * (Dh ** -0.5)
        p = _softmax(scores, axis=-1)
        o = torch.einsum("bhqk,bhkd->bhqd", p, v_cache)
        return (lambda x, *d: x.permute(*d))(o, 0, 2, 1, 3).reshape(B, Sq, H * Dh) @ wo

    def _B_ref(x, k_cache, v_cache, wq, wo):
        B, Sq, D = x.shape
        Hq, Dh = 32, 192
        Hkv = k_cache.shape[1]
        rep = Hq // Hkv
        q = (lambda x, *d: x.permute(*d))((x @ wq).reshape(B, Sq, Hq, Dh), 0, 2, 1, 3)
        k = (lambda x, n, axis: torch.repeat_interleave(x, n, dim=axis))(k_cache, rep, axis=1)
        v = (lambda x, n, axis: torch.repeat_interleave(x, n, dim=axis))(v_cache, rep, axis=1)
        scores = torch.einsum("bhqd,bhkd->bhqk", q, k) * (Dh ** -0.5)
        p = _softmax(scores, axis=-1)
        o = torch.einsum("bhqk,bhkd->bhqd", p, v)
        return (lambda x, *d: x.permute(*d))(o, 0, 2, 1, 3).reshape(B, Sq, Hq * Dh) @ wo

    a = _A_ref(A_x, A_k_cache, A_v_cache, A_wq, A_wo)
    b = _B_ref(B_x, B_k_cache, B_v_cache, B_wq, B_wo)
    return torch.concatenate([a, b], axis=-1)
```

```asm
; @launch grid=(256,1,1) block=(256,1,1) lds=163840
.amdgcn_target "amdgcn-amd-amdhsa--gfx950"
.text
.globl concat_heads__mha_block_cached__gqa_block_cached__near_ridge_kernel
.p2align 8
.type concat_heads__mha_block_cached__gqa_block_cached__near_ridge_kernel,@function
concat_heads__mha_block_cached__gqa_block_cached__near_ridge_kernel:
    s_cmp_ge_u32 s2, 256
    s_cbranch_scc1 L_exit1
    s_load_dwordx8 s[56:63], s[0:1], 0
    s_load_dwordx8 s[64:71], s[0:1], 40
    s_load_dwordx2 s[72:73], s[0:1], 96
    v_lshrrev_b32 v64, 6, v0
    v_and_b32 v0, 63, v0
    v_readfirstlane_b32 s31, v64
    s_getpc_b64 s[86:87]
L_pc0:
    s_lshr_b32 s88, s2, 3
    s_lshl_b32 s88, s88, 2
    s_nop 0
    s_add_u32 s88, s88, s31
    s_lshl_b32 s88, s88, 9
    v_and_b32 v65, 3, v0
    v_lshlrev_b32 v65, 7, v65
    v_add_u32 v65, s88, v65
    v_min_u32 v65, L_code_end-L_pc0-4, v65
    v_and_b32 v65, 0xfffffffc, v65
    global_load_dword v111, v65, s[86:87]
    v_lshlrev_b32 v1, 4, v0
    s_and_b32 s74, s2, 7
    s_lshr_b32 s75, s2, 3
    s_lshr_b32 s76, s74, 2
    s_and_b32 s77, s74, 3
    s_and_b32 s78, s75, 7
    s_lshr_b32 s85, s75, 3
    s_lshl_b32 s77, s77, 3
    s_lshl_b32 s79, s85, 1
    s_add_u32 s79, s79, s77
    s_mul_i32 s80, s31, 192
    s_movk_i32 s81, 2731
    s_movk_i32 s82, 384
    s_movk_i32 s83, 12288
    s_movk_i32 s84, 1280
    v_add_u32 v64, s80, v0
    v_lshrrev_b32 v65, 3, v64
    v_and_b32 v66, 7, v64
    v_bfe_u32 v68, v64, 4, 3
    v_xor_b32 v68, v66, v68
    v_lshlrev_b32 v68, 4, v68
    v_mul_lo_u32 v69, v65, s84
    v_add_u32 v68, v68, v69
    v_subrev_u32 v2, 0, v68
    v_add_u32 v5, 122880, v2
    v_mul_lo_u32 v65, v64, s81
    v_lshrrev_b32 v65, 16, v65
    v_mul_u32_u24 v66, 24, v65
    v_sub_u32 v66, v64, v66
    v_lshrrev_b32 v67, 1, v65
    v_and_b32 v68, 1, v67
    v_lshrrev_b32 v70, 1, v67
    v_and_b32 v70, 2, v70
    v_or_b32 v68, v68, v70
    v_lshlrev_b32 v68, 1, v68
    v_xor_b32 v68, v66, v68
    v_lshlrev_b32 v68, 4, v68
    v_mul_lo_u32 v69, v65, s83
    v_add_u32 v68, v68, v69
    v_subrev_u32 v8, 0, v68
    v_add_u32 v11, 393216, v8
    v_bfe_u32 v68, v65, 3, 1
    v_mul_u32_u24 v68, 6, v68
    v_and_b32 v70, 1, v67
    v_or_b32 v68, v68, v70
    v_xor_b32 v68, v66, v68
    v_lshlrev_b32 v68, 4, v68
    v_mul_lo_u32 v69, v65, s82
    v_add_u32 v68, v68, v69
    v_subrev_u32 v14, 0, v68
    v_and_b32 v68, 3, v67
    v_lshlrev_b32 v68, 1, v68
    v_xor_b32 v68, v66, v68
    v_lshlrev_b32 v68, 4, v68
    v_add_u32 v68, v68, v69
    v_subrev_u32 v17, 0, v68
    v_add_u32 v64, s80, v0
    v_add_u32 v64, 64, v64
    v_lshrrev_b32 v65, 3, v64
    v_and_b32 v66, 7, v64
    v_bfe_u32 v68, v64, 4, 3
    v_xor_b32 v68, v66, v68
    v_lshlrev_b32 v68, 4, v68
    v_mul_lo_u32 v69, v65, s84
    v_add_u32 v68, v68, v69
    v_subrev_u32 v3, 1024, v68
    v_add_u32 v6, 122880, v3
    v_mul_lo_u32 v65, v64, s81
    v_lshrrev_b32 v65, 16, v65
    v_mul_u32_u24 v66, 24, v65
    v_sub_u32 v66, v64, v66
    v_lshrrev_b32 v67, 1, v65
    v_and_b32 v68, 1, v67
    v_lshrrev_b32 v70, 1, v67
    v_and_b32 v70, 2, v70
    v_or_b32 v68, v68, v70
    v_lshlrev_b32 v68, 1, v68
    v_xor_b32 v68, v66, v68
    v_lshlrev_b32 v68, 4, v68
    v_mul_lo_u32 v69, v65, s83
    v_add_u32 v68, v68, v69
    v_subrev_u32 v9, 1024, v68
    v_add_u32 v12, 393216, v9
    v_bfe_u32 v68, v65, 3, 1
    v_mul_u32_u24 v68, 6, v68
    v_and_b32 v70, 1, v67
    v_or_b32 v68, v68, v70
    v_xor_b32 v68, v66, v68
    v_lshlrev_b32 v68, 4, v68
    v_mul_lo_u32 v69, v65, s82
    v_add_u32 v68, v68, v69
    v_subrev_u32 v15, 1024, v68
    v_and_b32 v68, 3, v67
    v_lshlrev_b32 v68, 1, v68
    v_xor_b32 v68, v66, v68
    v_lshlrev_b32 v68, 4, v68
    v_add_u32 v68, v68, v69
    v_subrev_u32 v18, 1024, v68
    v_add_u32 v64, s80, v0
    v_add_u32 v64, 128, v64
    v_lshrrev_b32 v65, 3, v64
    v_and_b32 v66, 7, v64
    v_bfe_u32 v68, v64, 4, 3
    v_xor_b32 v68, v66, v68
    v_lshlrev_b32 v68, 4, v68
    v_mul_lo_u32 v69, v65, s84
    v_add_u32 v68, v68, v69
    v_subrev_u32 v4, 2048, v68
    v_add_u32 v7, 122880, v4
    v_mul_lo_u32 v65, v64, s81
    v_lshrrev_b32 v65, 16, v65
    v_mul_u32_u24 v66, 24, v65
    v_sub_u32 v66, v64, v66
    v_lshrrev_b32 v67, 1, v65
    v_and_b32 v68, 1, v67
    v_lshrrev_b32 v70, 1, v67
    v_and_b32 v70, 2, v70
    v_or_b32 v68, v68, v70
    v_lshlrev_b32 v68, 1, v68
    v_xor_b32 v68, v66, v68
    v_lshlrev_b32 v68, 4, v68
    v_mul_lo_u32 v69, v65, s83
    v_add_u32 v68, v68, v69
    v_subrev_u32 v10, 2048, v68
    v_add_u32 v13, 393216, v10
    v_bfe_u32 v68, v65, 3, 1
    v_mul_u32_u24 v68, 6, v68
    v_and_b32 v70, 1, v67
    v_or_b32 v68, v68, v70
    v_xor_b32 v68, v66, v68
    v_lshlrev_b32 v68, 4, v68
    v_mul_lo_u32 v69, v65, s82
    v_add_u32 v68, v68, v69
    v_subrev_u32 v16, 2048, v68
    v_and_b32 v68, 3, v67
    v_lshlrev_b32 v68, 1, v68
    v_xor_b32 v68, v66, v68
    v_lshlrev_b32 v68, 4, v68
    v_add_u32 v68, v68, v69
    v_subrev_u32 v19, 2048, v68
    s_waitcnt lgkmcnt(0)
    s_cmp_eq_u32 s76, 0
    s_cselect_b64 s[56:57], s[56:57], s[64:65]
    s_cselect_b64 s[58:59], s[58:59], s[66:67]
    s_cselect_b64 s[60:61], s[60:61], s[68:69]
    s_cselect_b64 s[62:63], s[62:63], s[70:71]
    s_mul_i32 s80, s78, 245760
    s_add_u32 s4, s56, s80
    s_addc_u32 s5, s57, 0
    s_mov_b32 s6, 245760
    s_mov_b32 s7, 0x20000
    s_mul_i32 s80, s79, 384
    s_add_u32 s8, s62, s80
    s_addc_u32 s9, s63, 0
    s_sub_u32 s10, 7864320, s80
    s_mov_b32 s11, 0x20000
    s_mul_i32 s80, s85, 3
    s_add_u32 s80, s80, s78
    s_cmp_ge_u32 s80, 10
    s_cselect_b32 s81, 10, 0
    s_sub_u32 s80, s80, s81
    s_lshl_b32 s24, s80, 7
    s_mul_i32 s25, s80, 786432
    s_mov_b32 s26, 0
    s_mul_i32 s29, s31, 3072
    s_add_u32 m0, s29, 0
    s_nop 0
    buffer_load_dwordx4 v2, s[4:7], s24 offen lds
    buffer_load_dwordx4 v3, s[4:7], s24 offen offset:1024 lds
    buffer_load_dwordx4 v4, s[4:7], s24 offen offset:2048 lds
    s_add_u32 m0, s29, 12288
    s_nop 0
    buffer_load_dwordx4 v5, s[4:7], s24 offen lds
    buffer_load_dwordx4 v6, s[4:7], s24 offen offset:1024 lds
    buffer_load_dwordx4 v7, s[4:7], s24 offen offset:2048 lds
    s_add_u32 m0, s29, 24576
    s_nop 0
    buffer_load_dwordx4 v8, s[8:11], s25 offen lds
    buffer_load_dwordx4 v9, s[8:11], s25 offen offset:1024 lds
    buffer_load_dwordx4 v10, s[8:11], s25 offen offset:2048 lds
    s_add_u32 m0, s29, 36864
    s_nop 0
    buffer_load_dwordx4 v11, s[8:11], s25 offen lds
    buffer_load_dwordx4 v12, s[8:11], s25 offen offset:1024 lds
    buffer_load_dwordx4 v13, s[8:11], s25 offen offset:2048 lds
    s_add_u32 s25, s25, 786432
    s_add_u32 s24, s24, 128
    s_cmp_eq_u32 s24, 1280
    s_cmov_b32 s24, 0
    s_cmov_b32 s25, s26
    s_lshl_b32 s80, s78, 5
    s_add_u32 s80, s80, s79
    s_mul_i32 s80, s80, 196608
    s_add_u32 s12, s58, s80
    s_addc_u32 s13, s59, 0
    s_mov_b32 s14, 393216
    s_mov_b32 s15, 0x20000
    s_add_u32 s16, s60, s80
    s_addc_u32 s17, s61, 0
    s_mov_b32 s18, 393216
    s_mov_b32 s19, 0x20000
    s_mov_b32 s27, 0
    s_mov_b32 s28, 0
    s_mov_b32 s20, s72
    s_mov_b32 s21, s73
    s_mov_b32 s22, 0
    s_mov_b32 s23, 0x20000
    s_mul_i32 s80, s76, 96
    s_mul_i32 s81, s78, 12
    s_add_u32 s80, s80, s81
    s_mul_i32 s81, s31, 3
    s_add_u32 s80, s80, s81
    s_mul_i32 s80, s80, 192
    s_mul_i32 s81, s79, 6
    s_add_u32 s80, s80, s81
    s_lshl_b32 s32, s80, 10
    s_sub_u32 s32, s32, 6144
    s_mov_b32 s30, 0
    v_and_b32 v64, 15, v0
    v_lshrrev_b32 v65, 4, v0
    v_bfe_u32 v66, v0, 2, 2
    v_and_b32 v67, 3, v0
    v_lshl_add_u32 v68, v65, 3, v66
    v_mul_lo_u32 v69, v68, s82
    v_and_b32 v70, 1, v67
    v_lshl_add_u32 v69, v70, 3, v69
    v_and_b32 v68, 2, v66
    v_and_b32 v70, 1, v65
    v_lshl_or_b32 v68, v70, 2, v68
    v_lshrrev_b32 v71, 1, v67
    v_add_u32 v70, 0, v71
    v_xor_b32 v70, v70, v68
    v_lshl_add_u32 v38, v70, 4, v69
    v_add_u32 v39, 49152, v38
    v_add_u32 v40, 98304, v38
    v_add_u32 v70, 2, v71
    v_xor_b32 v70, v70, v68
    v_lshl_add_u32 v41, v70, 4, v69
    v_add_u32 v42, 49152, v41
    v_add_u32 v43, 98304, v41
    v_add_u32 v70, 4, v71
    v_xor_b32 v70, v70, v68
    v_lshl_add_u32 v44, v70, 4, v69
    v_add_u32 v45, 49152, v44
    v_add_u32 v46, 98304, v44
    v_add_u32 v70, 6, v71
    v_xor_b32 v70, v70, v68
    v_lshl_add_u32 v47, v70, 4, v69
    v_add_u32 v48, 49152, v47
    v_add_u32 v49, 98304, v47
    s_and_b32 s80, s31, 1
    s_mul_i32 s80, s80, 6144
    s_lshr_b32 s81, s31, 1
    s_mul_i32 s81, s81, 12288
    s_add_u32 s80, s80, s81
    v_lshrrev_b32 v68, 1, v64
    v_lshlrev_b32 v69, 7, v64
    v_add_u32 v69, s80, v69
    v_add_u32 v70, 0, v65
    v_xor_b32 v70, v70, v68
    v_lshl_add_u32 v50, v70, 4, v69
    v_add_u32 v51, 49152, v50
    v_add_u32 v52, 98304, v50
    v_add_u32 v70, 4, v65
    v_xor_b32 v70, v70, v68
    v_lshl_add_u32 v53, v70, 4, v69
    v_add_u32 v54, 49152, v53
    v_add_u32 v55, 98304, v53
    v_mul_lo_u32 v69, v64, s82
    v_bfe_u32 v68, v64, 3, 1
    v_mul_u32_u24 v68, 6, v68
    v_bfe_u32 v70, v64, 1, 1
    v_or_b32 v68, v68, v70
    v_lshrrev_b32 v72, 1, v65
    v_and_b32 v73, 1, v65
    v_lshl_or_b32 v72, v73, 1, v72
    v_add_u32 v70, 0, v72
    v_xor_b32 v70, v70, v68
    v_lshl_add_u32 v20, v70, 4, v69
    v_add_u32 v21, 49152, v20
    v_add_u32 v22, 98304, v20
    v_add_u32 v70, 4, v72
    v_xor_b32 v70, v70, v68
    v_lshl_add_u32 v23, v70, 4, v69
    v_add_u32 v24, 49152, v23
    v_add_u32 v25, 98304, v23
    v_lshl_add_u32 v68, v65, 2, v66
    v_mul_lo_u32 v69, v68, s82
    v_and_b32 v70, 1, v67
    v_lshl_add_u32 v69, v70, 3, v69
    v_and_b32 v68, 6, v68
    v_add_u32 v70, 0, v71
    v_xor_b32 v70, v70, v68
    v_lshl_add_u32 v26, v70, 4, v69
    v_add_u32 v27, 49152, v26
    v_add_u32 v28, 98304, v26
    v_add_u32 v70, 2, v71
    v_xor_b32 v70, v70, v68
    v_lshl_add_u32 v29, v70, 4, v69
    v_add_u32 v30, 49152, v29
    v_add_u32 v31, 98304, v29
    v_add_u32 v70, 4, v71
    v_xor_b32 v70, v70, v68
    v_lshl_add_u32 v32, v70, 4, v69
    v_add_u32 v33, 49152, v32
    v_add_u32 v34, 98304, v32
    v_add_u32 v70, 6, v71
    v_xor_b32 v70, v70, v68
    v_lshl_add_u32 v35, v70, 4, v69
    v_add_u32 v36, 49152, v35
    v_add_u32 v37, 98304, v35
    s_load_dwordx2 s[56:57], s[0:1], 32
    s_load_dwordx2 s[58:59], s[0:1], 72
    s_load_dwordx4 s[60:63], s[0:1], 80
    s_lshr_b32 s89, s77, 3
    s_lshr_b32 s90, s31, 1
    s_and_b32 s91, s31, 1
    s_add_u32 s98, s78, s85
    s_and_b32 s98, s98, 3
    s_mul_i32 s64, s31, 589824
    s_mul_i32 s65, s31, 192
    v_add_u32 v64, s64, v1
    v_accvgpr_write_b32 a228, v64
    v_add_u32 v64, s65, v0
    v_mul_u32_u24 v65, 2731, v64
    v_lshrrev_b32 v65, 16, v65
    v_mul_u32_u24 v66, 24, v65
    v_sub_u32 v66, v64, v66
    v_and_b32 v67, 6, v65
    v_xor_b32 v67, v66, v67
    v_cmp_gt_u32 vcc, 20, v67
    v_mul_u32_u24 v68, 1280, v65
    v_lshl_add_u32 v68, v67, 4, v68
    v_subrev_u32 v68, 0, v68
    v_mov_b32 v69, 0x7fff0000
    v_cndmask_b32 v68, v69, v68, vcc
    v_accvgpr_write_b32 a231, v68
    v_add_u32 v64, s64, v1
    v_add_u32 v64, 195584, v64
    v_accvgpr_write_b32 a229, v64
    v_add_u32 v64, s65, v0
    v_add_u32 v64, 64, v64
    v_mul_u32_u24 v65, 2731, v64
    v_lshrrev_b32 v65, 16, v65
    v_mul_u32_u24 v66, 24, v65
    v_sub_u32 v66, v64, v66
    v_and_b32 v67, 6, v65
    v_xor_b32 v67, v66, v67
    v_cmp_gt_u32 vcc, 20, v67
    v_mul_u32_u24 v68, 1280, v65
    v_lshl_add_u32 v68, v67, 4, v68
    v_subrev_u32 v68, 1024, v68
    v_mov_b32 v69, 0x7fff0000
    v_cndmask_b32 v68, v69, v68, vcc
    v_accvgpr_write_b32 a232, v68
    v_add_u32 v64, s64, v1
    v_add_u32 v64, 391168, v64
    v_accvgpr_write_b32 a230, v64
    v_add_u32 v64, s65, v0
    v_add_u32 v64, 128, v64
    v_mul_u32_u24 v65, 2731, v64
    v_lshrrev_b32 v65, 16, v65
    v_mul_u32_u24 v66, 24, v65
    v_sub_u32 v66, v64, v66
    v_and_b32 v67, 6, v65
    v_xor_b32 v67, v66, v67
    v_cmp_gt_u32 vcc, 20, v67
    v_mul_u32_u24 v68, 1280, v65
    v_lshl_add_u32 v68, v67, 4, v68
    v_subrev_u32 v68, 2048, v68
    v_mov_b32 v69, 0x7fff0000
    v_cndmask_b32 v68, v69, v68, vcc
    v_accvgpr_write_b32 a233, v68
    s_mul_i32 s64, s90, 6144
    v_add_u32 v64, s64, v1
    v_accvgpr_write_b32 a234, v64
    v_lshrrev_b32 v64, 2, v0
    v_mul_u32_u24 v65, 384, v64
    v_and_b32 v66, 1, v0
    v_lshl_add_u32 v65, v66, 3, v65
    v_and_b32 v64, 6, v64
    v_bfe_u32 v66, v0, 1, 1
    s_mul_i32 s64, s91, 5
    s_add_u32 s65, s64, 0
    s_and_b32 s66, s65, 3
    s_lshl_b32 s66, s66, 1
    s_lshr_b32 s67, s65, 2
    s_lshl_b32 s67, s67, 7
    v_add_u32 v67, s66, v66
    v_xor_b32 v67, v67, v64
    v_lshl_add_u32 v67, v67, 4, v65
    v_add_u32 v67, s67, v67
    v_accvgpr_write_b32 a235, v67
    s_add_u32 s65, s64, 1
    s_and_b32 s66, s65, 3
    s_lshl_b32 s66, s66, 1
    s_lshr_b32 s67, s65, 2
    s_lshl_b32 s67, s67, 7
    v_add_u32 v67, s66, v66
    v_xor_b32 v67, v67, v64
    v_lshl_add_u32 v67, v67, 4, v65
    v_add_u32 v67, s67, v67
    v_accvgpr_write_b32 a236, v67
    s_add_u32 s65, s64, 2
    s_and_b32 s66, s65, 3
    s_lshl_b32 s66, s66, 1
    s_lshr_b32 s67, s65, 2
    s_lshl_b32 s67, s67, 7
    v_add_u32 v67, s66, v66
    v_xor_b32 v67, v67, v64
    v_lshl_add_u32 v67, v67, 4, v65
    v_add_u32 v67, s67, v67
    v_accvgpr_write_b32 a237, v67
    s_add_u32 s65, s64, 3
    s_and_b32 s66, s65, 3
    s_lshl_b32 s66, s66, 1
    s_lshr_b32 s67, s65, 2
    s_lshl_b32 s67, s67, 7
    v_add_u32 v67, s66, v66
    v_xor_b32 v67, v67, v64
    v_lshl_add_u32 v67, v67, 4, v65
    v_add_u32 v67, s67, v67
    v_accvgpr_write_b32 a238, v67
    s_add_u32 s65, s64, 4
    s_and_b32 s66, s65, 3
    s_lshl_b32 s66, s66, 1
    s_lshr_b32 s67, s65, 2
    s_lshl_b32 s67, s67, 7
    v_add_u32 v67, s66, v66
    v_xor_b32 v67, v67, v64
    v_lshl_add_u32 v67, v67, 4, v65
    v_add_u32 v67, s67, v67
    v_accvgpr_write_b32 a239, v67
    s_lshl_b32 s64, s76, 2
    s_add_u32 s64, s64, s89
    s_lshl_b32 s64, s64, 3
    s_add_u32 s64, s64, s78
    s_lshl_b32 s64, s64, 2
    s_lshl_b32 s65, s76, 3
    s_add_u32 s65, s65, s78
    s_lshl_b32 s65, s65, 2
    s_add_u32 s65, s65, s85
    v_cmp_eq_u32 vcc, 0, v0
    v_mov_b32 v69, 0x7fff0000
    v_mov_b32 v64, s64
    v_cndmask_b32 v64, v69, v64, vcc
    v_accvgpr_write_b32 a240, v64
    s_lshl_b32 s66, s65, 2
    v_mov_b32 v64, s66
    v_cndmask_b32 v64, v69, v64, vcc
    v_accvgpr_write_b32 a241, v64
    v_mul_u32_u24 v65, 21846, v0
    v_lshrrev_b32 v65, 16, v65
    v_mul_u32_u24 v66, 3, v65
    v_sub_u32 v66, v0, v66
    v_mul_u32_u24 v65, 1280, v65
    v_lshl_add_u32 v65, v66, 7, v65
    v_cmp_gt_u32 vcc, 63, v0
    v_mov_b32 v66, 0x7fff0000
    s_mul_i32 s80, s78, 245760
    v_cndmask_b32 v65, v66, v65, vcc
    v_accvgpr_write_b32 a242, v65
    s_waitcnt lgkmcnt(0)
    s_cmp_eq_u32 s76, 0
    s_cselect_b64 s[56:57], s[56:57], s[58:59]
    s_mul_i32 s66, s89, 1966080
    s_mul_i32 s67, s85, 320
    s_add_u32 s66, s66, s67
    s_add_u32 s40, s56, s66
    s_addc_u32 s41, s57, 0
    s_mov_b32 s42, 1965120
    s_mov_b32 s43, 0x20000
    s_mov_b32 s68, s40
    s_mov_b32 s69, s41
    s_mov_b32 s70, 0
    s_mov_b32 s71, 0x20000
    s_mul_i32 s66, s76, 96
    s_mul_i32 s67, s78, 12
    s_add_u32 s66, s66, s67
    s_mul_i32 s66, s66, 192
    s_mul_i32 s67, s89, 48
    s_add_u32 s66, s66, s67
    s_lshl_b32 s66, s66, 10
    s_add_u32 s36, s72, s66
    s_addc_u32 s37, s73, 0
    s_mov_b32 s38, 2211840
    s_mov_b32 s39, 0x20000
    s_mul_i32 s66, s65, 491520
    s_add_u32 s66, s66, 67108864
    s_add_u32 s44, s72, s66
    s_addc_u32 s45, s73, 0
    s_mov_b32 s46, 491520
    s_mov_b32 s47, 0x20000
    s_mov_b32 s52, s62
    s_mov_b32 s53, s63
    s_mov_b32 s54, 256
    s_mov_b32 s55, 0x20000
    s_mul_i32 s66, s78, 491520
    s_mul_i32 s67, s76, 1280
    s_add_u32 s66, s66, s67
    s_mul_i32 s67, s85, 320
    s_add_u32 s66, s66, s67
    s_add_u32 s48, s60, s66
    s_addc_u32 s49, s61, 0
    s_sub_u32 s50, 3932160, s66
    s_mov_b32 s51, 0x20000
    s_lshl_b32 s66, s65, 7
    s_add_u32 s66, s66, 50331648
    s_add_u32 s76, s72, s66
    s_addc_u32 s77, s73, 0
    s_mov_b32 s78, 128
    s_mov_b32 s79, 0x20000
    v_cmp_eq_u32 vcc, 0, v0
    v_mov_b32 v69, 0x7fff0000
    v_mov_b32 v64, 0
    v_cndmask_b32 v65, v69, v64, vcc
    v_accvgpr_write_b32 a245, v65
    s_cmp_lg_u32 s89, 0
    s_cbranch_scc1 L_nozero
    s_cmp_lg_u32 s31, 0
    s_cbranch_scc1 L_nozero
    buffer_store_dword v64, v65, s[76:79], 0 offen sc1
L_nozero:
    v_mov_b32 v64, 0x3f803f80
    v_accvgpr_write_b32 a156, v64
    v_accvgpr_write_b32 a157, v64
    v_accvgpr_write_b32 a158, v64
    v_accvgpr_write_b32 a159, v64
    s_add_u32 m0, s29, 49152
    s_nop 0
    buffer_load_dwordx4 v2, s[4:7], s24 offen lds
    buffer_load_dwordx4 v3, s[4:7], s24 offen offset:1024 lds
    buffer_load_dwordx4 v4, s[4:7], s24 offen offset:2048 lds
    s_add_u32 m0, s29, 61440
    s_nop 0
    buffer_load_dwordx4 v5, s[4:7], s24 offen lds
    buffer_load_dwordx4 v6, s[4:7], s24 offen offset:1024 lds
    buffer_load_dwordx4 v7, s[4:7], s24 offen offset:2048 lds
    s_add_u32 m0, s29, 73728
    s_nop 0
    buffer_load_dwordx4 v8, s[8:11], s25 offen lds
    buffer_load_dwordx4 v9, s[8:11], s25 offen offset:1024 lds
    buffer_load_dwordx4 v10, s[8:11], s25 offen offset:2048 lds
    s_add_u32 m0, s29, 86016
    s_nop 0
    buffer_load_dwordx4 v11, s[8:11], s25 offen lds
    buffer_load_dwordx4 v12, s[8:11], s25 offen offset:1024 lds
    buffer_load_dwordx4 v13, s[8:11], s25 offen offset:2048 lds
    s_add_u32 s25, s25, 786432
    s_add_u32 s24, s24, 128
    s_cmp_eq_u32 s24, 1280
    s_cmov_b32 s24, 0
    s_cmov_b32 s25, s26
    s_add_u32 m0, s29, 98304
    s_nop 0
    buffer_load_dwordx4 v2, s[4:7], s24 offen lds
    buffer_load_dwordx4 v3, s[4:7], s24 offen offset:1024 lds
    buffer_load_dwordx4 v4, s[4:7], s24 offen offset:2048 lds
    s_add_u32 m0, s29, 110592
    s_nop 0
    buffer_load_dwordx4 v5, s[4:7], s24 offen lds
    buffer_load_dwordx4 v6, s[4:7], s24 offen offset:1024 lds
    buffer_load_dwordx4 v7, s[4:7], s24 offen offset:2048 lds
    s_waitcnt vmcnt(18)
    s_barrier
    ds_read_b128 a[192:195], v50 offset:0
    ds_read_b128 a[196:199], v50 offset:2048
    ds_read_b128 a[200:203], v50 offset:4096
    ds_read_b64_tr_b16 a[160:161], v38 offset:24576
    ds_read_b64_tr_b16 a[162:163], v38 offset:26112
    ds_read_b64_tr_b16 a[164:165], v41 offset:24576
    ds_read_b64_tr_b16 a[166:167], v41 offset:26112
    ds_read_b64_tr_b16 a[168:169], v44 offset:24576
    ds_read_b64_tr_b16 a[170:171], v44 offset:26112
    ds_read_b64_tr_b16 a[172:173], v47 offset:24576
    ds_read_b64_tr_b16 a[174:175], v47 offset:26112
    ds_read_b64_tr_b16 a[176:177], v38 offset:24704
    ds_read_b64_tr_b16 a[178:179], v38 offset:26240
    ds_read_b64_tr_b16 a[180:181], v41 offset:24704
    ds_read_b64_tr_b16 a[182:183], v41 offset:26240
L_item:
    s_add_u32 m0, s29, 122880
    s_waitcnt lgkmcnt(6)
    v_mfma_f32_16x16x32_bf16 v[112:115], a[160:163], a[192:195], 0
    ds_read_b64_tr_b16 a[184:185], v44 offset:24704
    v_mfma_f32_16x16x32_bf16 v[120:123], a[160:163], a[196:199], 0
    ds_read_b64_tr_b16 a[186:187], v44 offset:26240
    v_mfma_f32_16x16x32_bf16 v[128:131], a[160:163], a[200:203], 0
    ds_read_b128 a[204:207], v53 offset:0
    v_mfma_f32_16x16x32_bf16 v[116:119], a[164:167], a[192:195], 0
    ds_read_b64_tr_b16 a[188:189], v47 offset:24704
    v_mfma_f32_16x16x32_bf16 v[124:127], a[164:167], a[196:199], 0
    ds_read_b64_tr_b16 a[190:191], v47 offset:26240
    v_mfma_f32_16x16x32_bf16 v[132:135], a[164:167], a[200:203], 0
    ds_read_b128 a[208:211], v53 offset:2048
    s_waitcnt lgkmcnt(10)
    v_mfma_f32_16x16x32_bf16 v[136:139], a[168:171], a[192:195], 0
    ds_read_b64_tr_b16 a[160:161], v38 offset:24832
    v_mfma_f32_16x16x32_bf16 v[144:147], a[168:171], a[196:199], 0
    ds_read_b64_tr_b16 a[162:163], v38 offset:26368
    v_mfma_f32_16x16x32_bf16 v[152:155], a[168:171], a[200:203], 0
    ds_read_b128 a[212:215], v53 offset:4096
    v_mfma_f32_16x16x32_bf16 v[140:143], a[172:175], a[192:195], 0
    ds_read_b64_tr_b16 a[164:165], v41 offset:24832
    v_mfma_f32_16x16x32_bf16 v[148:151], a[172:175], a[196:199], 0
    ds_read_b64_tr_b16 a[166:167], v41 offset:26368
    v_mfma_f32_16x16x32_bf16 v[156:159], a[172:175], a[200:203], 0
    s_waitcnt lgkmcnt(11)
    v_mfma_f32_16x16x32_bf16 v[160:163], a[176:179], a[192:195], 0
    ds_read_b64_tr_b16 a[168:169], v44 offset:24832
    v_mfma_f32_16x16x32_bf16 v[168:171], a[176:179], a[196:199], 0
    ds_read_b64_tr_b16 a[170:171], v44 offset:26368
    v_mfma_f32_16x16x32_bf16 v[176:179], a[176:179], a[200:203], 0
    buffer_load_dwordx4 v8, s[8:11], s25 offen lds
    v_mfma_f32_16x16x32_bf16 v[164:167], a[180:183], a[192:195], 0
    ds_read_b64_tr_b16 a[172:173], v47 offset:24832
    v_mfma_f32_16x16x32_bf16 v[172:175], a[180:183], a[196:199], 0
    ds_read_b64_tr_b16 a[174:175], v47 offset:26368
    v_mfma_f32_16x16x32_bf16 v[180:183], a[180:183], a[200:203], 0
    s_waitcnt lgkmcnt(10)
    v_mfma_f32_16x16x32_bf16 v[184:187], a[184:187], a[192:195], 0
    ds_read_b64_tr_b16 a[176:177], v38 offset:36864
    v_mfma_f32_16x16x32_bf16 v[192:195], a[184:187], a[196:199], 0
    ds_read_b64_tr_b16 a[178:179], v38 offset:38400
    v_mfma_f32_16x16x32_bf16 v[200:203], a[184:187], a[200:203], 0
    v_mfma_f32_16x16x32_bf16 v[188:191], a[188:191], a[192:195], 0
    ds_read_b64_tr_b16 a[180:181], v41 offset:36864
    v_mfma_f32_16x16x32_bf16 v[196:199], a[188:191], a[196:199], 0
    ds_read_b64_tr_b16 a[182:183], v41 offset:38400
    v_mfma_f32_16x16x32_bf16 v[204:207], a[188:191], a[200:203], 0
    s_waitcnt lgkmcnt(8)
    v_mfma_f32_16x16x32_bf16 v[208:211], a[160:163], a[192:195], 0
    ds_read_b64_tr_b16 a[184:185], v44 offset:36864
    v_mfma_f32_16x16x32_bf16 v[216:219], a[160:163], a[196:199], 0
    ds_read_b64_tr_b16 a[186:187], v44 offset:38400
    v_mfma_f32_16x16x32_bf16 v[224:227], a[160:163], a[200:203], 0
    buffer_load_dwordx4 v9, s[8:11], s25 offen offset:1024 lds
    v_mfma_f32_16x16x32_bf16 v[212:215], a[164:167], a[192:195], 0
    ds_read_b64_tr_b16 a[188:189], v47 offset:36864
    v_mfma_f32_16x16x32_bf16 v[220:223], a[164:167], a[196:199], 0
    ds_read_b64_tr_b16 a[190:191], v47 offset:38400
    v_mfma_f32_16x16x32_bf16 v[228:231], a[164:167], a[200:203], 0
    s_waitcnt lgkmcnt(8)
    v_mfma_f32_16x16x32_bf16 v[232:235], a[168:171], a[192:195], 0
    ds_read_b64_tr_b16 a[160:161], v38 offset:36992
    v_mfma_f32_16x16x32_bf16 v[240:243], a[168:171], a[196:199], 0
    ds_read_b64_tr_b16 a[162:163], v38 offset:38528
    v_mfma_f32_16x16x32_bf16 v[248:251], a[168:171], a[200:203], 0
    v_mfma_f32_16x16x32_bf16 v[236:239], a[172:175], a[192:195], 0
    ds_read_b64_tr_b16 a[164:165], v41 offset:36992
    v_mfma_f32_16x16x32_bf16 v[244:247], a[172:175], a[196:199], 0
    ds_read_b64_tr_b16 a[166:167], v41 offset:38528
    v_mfma_f32_16x16x32_bf16 v[252:255], a[172:175], a[200:203], 0
    s_waitcnt lgkmcnt(8)
    v_mfma_f32_16x16x32_bf16 v[112:115], a[176:179], a[204:207], v[112:115]
    ds_read_b64_tr_b16 a[168:169], v44 offset:36992
    v_mfma_f32_16x16x32_bf16 v[120:123], a[176:179], a[208:211], v[120:123]
    ds_read_b64_tr_b16 a[170:171], v44 offset:38528
    v_mfma_f32_16x16x32_bf16 v[128:131], a[176:179], a[212:215], v[128:131]
    buffer_load_dwordx4 v10, s[8:11], s25 offen offset:2048 lds
    v_mfma_f32_16x16x32_bf16 v[116:119], a[180:183], a[204:207], v[116:119]
    ds_read_b64_tr_b16 a[172:173], v47 offset:36992
    v_mfma_f32_16x16x32_bf16 v[124:127], a[180:183], a[208:211], v[124:127]
    ds_read_b64_tr_b16 a[174:175], v47 offset:38528
    v_mfma_f32_16x16x32_bf16 v[132:135], a[180:183], a[212:215], v[132:135]
    s_waitcnt lgkmcnt(8)
    v_mfma_f32_16x16x32_bf16 v[136:139], a[184:187], a[204:207], v[136:139]
    ds_read_b64_tr_b16 a[176:177], v38 offset:37120
    v_mfma_f32_16x16x32_bf16 v[144:147], a[184:187], a[208:211], v[144:147]
    ds_read_b64_tr_b16 a[178:179], v38 offset:38656
    v_mfma_f32_16x16x32_bf16 v[152:155], a[184:187], a[212:215], v[152:155]
    v_mfma_f32_16x16x32_bf16 v[140:143], a[188:191], a[204:207], v[140:143]
    ds_read_b64_tr_b16 a[180:181], v41 offset:37120
    v_mfma_f32_16x16x32_bf16 v[148:151], a[188:191], a[208:211], v[148:151]
    ds_read_b64_tr_b16 a[182:183], v41 offset:38656
    v_mfma_f32_16x16x32_bf16 v[156:159], a[188:191], a[212:215], v[156:159]
    s_waitcnt lgkmcnt(8)
    v_mfma_f32_16x16x32_bf16 v[160:163], a[160:163], a[204:207], v[160:163]
    ds_read_b64_tr_b16 a[184:185], v44 offset:37120
    v_mfma_f32_16x16x32_bf16 v[168:171], a[160:163], a[208:211], v[168:171]
    ds_read_b64_tr_b16 a[186:187], v44 offset:38656
    v_mfma_f32_16x16x32_bf16 v[176:179], a[160:163], a[212:215], v[176:179]
    v_mfma_f32_16x16x32_bf16 v[164:167], a[164:167], a[204:207], v[164:167]
    ds_read_b64_tr_b16 a[188:189], v47 offset:37120
    v_mfma_f32_16x16x32_bf16 v[172:175], a[164:167], a[208:211], v[172:175]
    ds_read_b64_tr_b16 a[190:191], v47 offset:38656
    v_mfma_f32_16x16x32_bf16 v[180:183], a[164:167], a[212:215], v[180:183]
    s_waitcnt vmcnt(9)
    s_barrier
    s_cmp_eq_u32 s30, 0
    s_cbranch_scc1 L_ool8
L_ool8_r:
    s_waitcnt lgkmcnt(8)
    v_mfma_f32_16x16x32_bf16 v[184:187], a[168:171], a[204:207], v[184:187]
    s_add_u32 m0, s29, 135168
    ds_read_b64_tr_b16 a[160:161], v39 offset:24576
    v_mfma_f32_16x16x32_bf16 v[192:195], a[168:171], a[208:211], v[192:195]
    ds_read_b64_tr_b16 a[162:163], v39 offset:26112
    v_mfma_f32_16x16x32_bf16 v[200:203], a[168:171], a[212:215], v[200:203]
    ds_read_b128 a[192:195], v51 offset:0
    v_mfma_f32_16x16x32_bf16 v[188:191], a[172:175], a[204:207], v[188:191]
    ds_read_b64_tr_b16 a[164:165], v42 offset:24576
    v_mfma_f32_16x16x32_bf16 v[196:199], a[172:175], a[208:211], v[196:199]
    ds_read_b64_tr_b16 a[166:167], v42 offset:26112
    v_mfma_f32_16x16x32_bf16 v[204:207], a[172:175], a[212:215], v[204:207]
    ds_read_b128 a[196:199], v51 offset:2048
    s_waitcnt lgkmcnt(10)
    v_mfma_f32_16x16x32_bf16 v[208:211], a[176:179], a[204:207], v[208:211]
    ds_read_b64_tr_b16 a[168:169], v45 offset:24576
    v_mfma_f32_16x16x32_bf16 v[216:219], a[176:179], a[208:211], v[216:219]
    ds_read_b64_tr_b16 a[170:171], v45 offset:26112
    v_mfma_f32_16x16x32_bf16 v[224:227], a[176:179], a[212:215], v[224:227]
    ds_read_b128 a[200:203], v51 offset:4096
    v_mfma_f32_16x16x32_bf16 v[212:215], a[180:183], a[204:207], v[212:215]
    ds_read_b64_tr_b16 a[172:173], v48 offset:24576
    v_mfma_f32_16x16x32_bf16 v[220:223], a[180:183], a[208:211], v[220:223]
    ds_read_b64_tr_b16 a[174:175], v48 offset:26112
    v_mfma_f32_16x16x32_bf16 v[228:231], a[180:183], a[212:215], v[228:231]
    buffer_load_dwordx4 v11, s[8:11], s25 offen lds
    s_waitcnt lgkmcnt(11)
    v_mfma_f32_16x16x32_bf16 v[232:235], a[184:187], a[204:207], v[232:235]
    ds_read_b64_tr_b16 a[176:177], v39 offset:24704
    v_mfma_f32_16x16x32_bf16 v[240:243], a[184:187], a[208:211], v[240:243]
    ds_read_b64_tr_b16 a[178:179], v39 offset:26240
    v_mfma_f32_16x16x32_bf16 v[248:251], a[184:187], a[212:215], v[248:251]
    buffer_load_dwordx4 v12, s[8:11], s25 offen offset:1024 lds
    v_mfma_f32_16x16x32_bf16 v[236:239], a[188:191], a[204:207], v[236:239]
    ds_read_b64_tr_b16 a[180:181], v42 offset:24704
    v_mfma_f32_16x16x32_bf16 v[244:247], a[188:191], a[208:211], v[244:247]
    ds_read_b64_tr_b16 a[182:183], v42 offset:26240
    v_mfma_f32_16x16x32_bf16 v[252:255], a[188:191], a[212:215], v[252:255]
    buffer_load_dwordx4 v13, s[8:11], s25 offen offset:2048 lds
    s_waitcnt lgkmcnt(6)
    v_mfma_f32_16x16x32_bf16 v[112:115], a[160:163], a[192:195], v[112:115]
    s_add_u32 s33, s32, 0
    ds_read_b64_tr_b16 a[184:185], v45 offset:24704
    v_mfma_f32_16x16x32_bf16 v[120:123], a[160:163], a[196:199], v[120:123]
    ds_read_b64_tr_b16 a[186:187], v45 offset:26240
    v_mfma_f32_16x16x32_bf16 v[128:131], a[160:163], a[200:203], v[128:131]
    ds_read_b128 a[204:207], v54 offset:0
    v_mfma_f32_16x16x32_bf16 v[116:119], a[164:167], a[192:195], v[116:119]
    ds_read_b64_tr_b16 a[188:189], v48 offset:24704
    v_mfma_f32_16x16x32_bf16 v[124:127], a[164:167], a[196:199], v[124:127]
    ds_read_b64_tr_b16 a[190:191], v48 offset:26240
    v_mfma_f32_16x16x32_bf16 v[132:135], a[164:167], a[200:203], v[132:135]
    ds_read_b128 a[208:211], v54 offset:2048
    s_waitcnt lgkmcnt(10)
    v_mfma_f32_16x16x32_bf16 v[136:139], a[168:171], a[192:195], v[136:139]
    ds_read_b64_tr_b16 a[160:161], v39 offset:24832
    v_mfma_f32_16x16x32_bf16 v[144:147], a[168:171], a[196:199], v[144:147]
    ds_read_b64_tr_b16 a[162:163], v39 offset:26368
    v_mfma_f32_16x16x32_bf16 v[152:155], a[168:171], a[200:203], v[152:155]
    ds_read_b128 a[212:215], v54 offset:4096
    v_mfma_f32_16x16x32_bf16 v[140:143], a[172:175], a[192:195], v[140:143]
    ds_read_b64_tr_b16 a[164:165], v42 offset:24832
    v_mfma_f32_16x16x32_bf16 v[148:151], a[172:175], a[196:199], v[148:151]
    ds_read_b64_tr_b16 a[166:167], v42 offset:26368
    v_mfma_f32_16x16x32_bf16 v[156:159], a[172:175], a[200:203], v[156:159]
    s_add_u32 s25, s25, 786432
    s_add_u32 s24, s24, 128
    s_waitcnt lgkmcnt(11)
    v_mfma_f32_16x16x32_bf16 v[160:163], a[176:179], a[192:195], v[160:163]
    ds_read_b64_tr_b16 a[168:169], v45 offset:24832
    v_mfma_f32_16x16x32_bf16 v[168:171], a[176:179], a[196:199], v[168:171]
    ds_read_b64_tr_b16 a[170:171], v45 offset:26368
    v_mfma_f32_16x16x32_bf16 v[176:179], a[176:179], a[200:203], v[176:179]
    s_cmp_eq_u32 s24, 1280
    s_cmov_b32 s24, 0
    s_cmov_b32 s25, s26
    v_mfma_f32_16x16x32_bf16 v[164:167], a[180:183], a[192:195], v[164:167]
    s_add_u32 m0, s29, 0
    ds_read_b64_tr_b16 a[172:173], v48 offset:24832
    v_mfma_f32_16x16x32_bf16 v[172:175], a[180:183], a[196:199], v[172:175]
    ds_read_b64_tr_b16 a[174:175], v48 offset:26368
    v_mfma_f32_16x16x32_bf16 v[180:183], a[180:183], a[200:203], v[180:183]
    buffer_load_dwordx4 v2, s[4:7], s24 offen lds
    s_waitcnt lgkmcnt(10)
    v_mfma_f32_16x16x32_bf16 v[184:187], a[184:187], a[192:195], v[184:187]
    ds_read_b64_tr_b16 a[176:177], v39 offset:36864
    v_mfma_f32_16x16x32_bf16 v[192:195], a[184:187], a[196:199], v[192:195]
    ds_read_b64_tr_b16 a[178:179], v39 offset:38400
    v_mfma_f32_16x16x32_bf16 v[200:203], a[184:187], a[200:203], v[200:203]
    buffer_load_dwordx4 v3, s[4:7], s24 offen offset:1024 lds
    v_mfma_f32_16x16x32_bf16 v[188:191], a[188:191], a[192:195], v[188:191]
    ds_read_b64_tr_b16 a[180:181], v42 offset:36864
    v_mfma_f32_16x16x32_bf16 v[196:199], a[188:191], a[196:199], v[196:199]
    ds_read_b64_tr_b16 a[182:183], v42 offset:38400
    v_mfma_f32_16x16x32_bf16 v[204:207], a[188:191], a[200:203], v[204:207]
    buffer_load_dwordx4 v4, s[4:7], s24 offen offset:2048 lds
    s_waitcnt lgkmcnt(8)
    v_mfma_f32_16x16x32_bf16 v[208:211], a[160:163], a[192:195], v[208:211]
    s_add_u32 m0, s29, 12288
    ds_read_b64_tr_b16 a[184:185], v45 offset:36864
    v_mfma_f32_16x16x32_bf16 v[216:219], a[160:163], a[196:199], v[216:219]
    ds_read_b64_tr_b16 a[186:187], v45 offset:38400
    v_mfma_f32_16x16x32_bf16 v[224:227], a[160:163], a[200:203], v[224:227]
    buffer_load_dwordx4 v5, s[4:7], s24 offen lds
    v_mfma_f32_16x16x32_bf16 v[212:215], a[164:167], a[192:195], v[212:215]
    ds_read_b64_tr_b16 a[188:189], v48 offset:36864
    v_mfma_f32_16x16x32_bf16 v[220:223], a[164:167], a[196:199], v[220:223]
    ds_read_b64_tr_b16 a[190:191], v48 offset:38400
    v_mfma_f32_16x16x32_bf16 v[228:231], a[164:167], a[200:203], v[228:231]
    buffer_load_dwordx4 v6, s[4:7], s24 offen offset:1024 lds
    s_waitcnt lgkmcnt(8)
    v_mfma_f32_16x16x32_bf16 v[232:235], a[168:171], a[192:195], v[232:235]
    ds_read_b64_tr_b16 a[160:161], v39 offset:36992
    v_mfma_f32_16x16x32_bf16 v[240:243], a[168:171], a[196:199], v[240:243]
    ds_read_b64_tr_b16 a[162:163], v39 offset:38528
    v_mfma_f32_16x16x32_bf16 v[248:251], a[168:171], a[200:203], v[248:251]
    buffer_load_dwordx4 v7, s[4:7], s24 offen offset:2048 lds
    v_mfma_f32_16x16x32_bf16 v[236:239], a[172:175], a[192:195], v[236:239]
    ds_read_b64_tr_b16 a[164:165], v42 offset:36992
    v_mfma_f32_16x16x32_bf16 v[244:247], a[172:175], a[196:199], v[244:247]
    ds_read_b64_tr_b16 a[166:167], v42 offset:38528
    v_mfma_f32_16x16x32_bf16 v[252:255], a[172:175], a[200:203], v[252:255]
    s_add_u32 m0, s29, 24576
    s_waitcnt lgkmcnt(8)
    v_mfma_f32_16x16x32_bf16 v[112:115], a[176:179], a[204:207], v[112:115]
    ds_read_b64_tr_b16 a[168:169], v45 offset:36992
    v_mfma_f32_16x16x32_bf16 v[120:123], a[176:179], a[208:211], v[120:123]
    ds_read_b64_tr_b16 a[170:171], v45 offset:38528
    v_mfma_f32_16x16x32_bf16 v[128:131], a[176:179], a[212:215], v[128:131]
    buffer_store_dwordx4 a[84:87], v1, s[20:23], s33 offen sc1
    s_add_u32 s33, s32, 196608
    v_mfma_f32_16x16x32_bf16 v[116:119], a[180:183], a[204:207], v[116:119]
    ds_read_b64_tr_b16 a[172:173], v48 offset:36992
    v_mfma_f32_16x16x32_bf16 v[124:127], a[180:183], a[208:211], v[124:127]
    ds_read_b64_tr_b16 a[174:175], v48 offset:38528
    v_mfma_f32_16x16x32_bf16 v[132:135], a[180:183], a[212:215], v[132:135]
    buffer_load_dwordx4 v8, s[8:11], s25 offen lds
    s_waitcnt lgkmcnt(8)
    v_mfma_f32_16x16x32_bf16 v[136:139], a[184:187], a[204:207], v[136:139]
    ds_read_b64_tr_b16 a[176:177], v39 offset:37120
    v_mfma_f32_16x16x32_bf16 v[144:147], a[184:187], a[208:211], v[144:147]
    ds_read_b64_tr_b16 a[178:179], v39 offset:38656
    v_mfma_f32_16x16x32_bf16 v[152:155], a[184:187], a[212:215], v[152:155]
    buffer_load_dwordx4 v9, s[8:11], s25 offen offset:1024 lds
    v_mfma_f32_16x16x32_bf16 v[140:143], a[188:191], a[204:207], v[140:143]
    ds_read_b64_tr_b16 a[180:181], v42 offset:37120
    v_mfma_f32_16x16x32_bf16 v[148:151], a[188:191], a[208:211], v[148:151]
    ds_read_b64_tr_b16 a[182:183], v42 offset:38656
    v_mfma_f32_16x16x32_bf16 v[156:159], a[188:191], a[212:215], v[156:159]
    buffer_load_dwordx4 v10, s[8:11], s25 offen offset:2048 lds
    s_waitcnt lgkmcnt(8)
    v_mfma_f32_16x16x32_bf16 v[160:163], a[160:163], a[204:207], v[160:163]
    ds_read_b64_tr_b16 a[184:185], v45 offset:37120
    v_mfma_f32_16x16x32_bf16 v[168:171], a[160:163], a[208:211], v[168:171]
    ds_read_b64_tr_b16 a[186:187], v45 offset:38656
    v_mfma_f32_16x16x32_bf16 v[176:179], a[160:163], a[212:215], v[176:179]
    buffer_store_dwordx4 a[88:91], v1, s[20:23], s33 offen sc1
    s_add_u32 s33, s32, 393216
    v_mfma_f32_16x16x32_bf16 v[164:167], a[164:167], a[204:207], v[164:167]
    buffer_store_dwordx4 a[92:95], v1, s[20:23], s33 offen sc1
    v_mfma_f32_16x16x32_bf16 v[172:175], a[164:167], a[208:211], v[172:175]
    ds_read_b64_tr_b16 a[188:189], v48 offset:37120
    v_mfma_f32_16x16x32_bf16 v[180:183], a[164:167], a[212:215], v[180:183]
    s_waitcnt vmcnt(12)
    s_barrier
    s_waitcnt lgkmcnt(7)
    v_mfma_f32_16x16x32_bf16 v[184:187], a[168:171], a[204:207], v[184:187]
    s_add_u32 m0, s29, 36864
    ds_read_b64_tr_b16 a[190:191], v48 offset:38656
    v_mfma_f32_16x16x32_bf16 v[192:195], a[168:171], a[208:211], v[192:195]
    ds_read_b64_tr_b16 a[160:161], v40 offset:24576
    v_mfma_f32_16x16x32_bf16 v[200:203], a[168:171], a[212:215], v[200:203]
    ds_read_b64_tr_b16 a[162:163], v40 offset:26112
    v_mfma_f32_16x16x32_bf16 v[188:191], a[172:175], a[204:207], v[188:191]
    ds_read_b64_tr_b16 a[164:165], v43 offset:24576
    v_mfma_f32_16x16x32_bf16 v[196:199], a[172:175], a[208:211], v[196:199]
    ds_read_b64_tr_b16 a[166:167], v43 offset:26112
    v_mfma_f32_16x16x32_bf16 v[204:207], a[172:175], a[212:215], v[204:207]
    ds_read_b128 a[192:195], v52 offset:0
    s_waitcnt lgkmcnt(9)
    v_mfma_f32_16x16x32_bf16 v[208:211], a[176:179], a[204:207], v[208:211]
    ds_read_b64_tr_b16 a[168:169], v46 offset:24576
    v_mfma_f32_16x16x32_bf16 v[216:219], a[176:179], a[208:211], v[216:219]
    ds_read_b64_tr_b16 a[170:171], v46 offset:26112
    v_mfma_f32_16x16x32_bf16 v[224:227], a[176:179], a[212:215], v[224:227]
    ds_read_b128 a[196:199], v52 offset:2048
    v_mfma_f32_16x16x32_bf16 v[212:215], a[180:183], a[204:207], v[212:215]
    ds_read_b64_tr_b16 a[172:173], v49 offset:24576
    v_mfma_f32_16x16x32_bf16 v[220:223], a[180:183], a[208:211], v[220:223]
    ds_read_b128 a[200:203], v52 offset:4096
    v_mfma_f32_16x16x32_bf16 v[228:231], a[180:183], a[212:215], v[228:231]
    ds_read_b64_tr_b16 a[174:175], v49 offset:26112
    s_waitcnt lgkmcnt(11)
    v_mfma_f32_16x16x32_bf16 v[232:235], a[184:187], a[204:207], v[232:235]
    ds_read_b64_tr_b16 a[176:177], v40 offset:24704
    v_mfma_f32_16x16x32_bf16 v[240:243], a[184:187], a[208:211], v[240:243]
    ds_read_b64_tr_b16 a[178:179], v40 offset:26240
    v_mfma_f32_16x16x32_bf16 v[248:251], a[184:187], a[212:215], v[248:251]
    buffer_load_dwordx4 v11, s[8:11], s25 offen lds
    v_mfma_f32_16x16x32_bf16 v[236:239], a[188:191], a[204:207], v[236:239]
    ds_read_b64_tr_b16 a[180:181], v43 offset:24704
    v_mfma_f32_16x16x32_bf16 v[244:247], a[188:191], a[208:211], v[244:247]
    ds_read_b64_tr_b16 a[182:183], v43 offset:26240
    v_mfma_f32_16x16x32_bf16 v[252:255], a[188:191], a[212:215], v[252:255]
    buffer_load_dwordx4 v12, s[8:11], s25 offen offset:1024 lds
    s_waitcnt lgkmcnt(5)
    v_mfma_f32_16x16x32_bf16 v[112:115], a[160:163], a[192:195], v[112:115]
    ds_read_b64_tr_b16 a[184:185], v46 offset:24704
    v_mfma_f32_16x16x32_bf16 v[120:123], a[160:163], a[196:199], v[120:123]
    ds_read_b64_tr_b16 a[186:187], v46 offset:26240
    v_mfma_f32_16x16x32_bf16 v[128:131], a[160:163], a[200:203], v[128:131]
    ds_read_b128 a[204:207], v55 offset:0
    v_mfma_f32_16x16x32_bf16 v[116:119], a[164:167], a[192:195], v[116:119]
    ds_read_b64_tr_b16 a[188:189], v49 offset:24704
    v_mfma_f32_16x16x32_bf16 v[124:127], a[164:167], a[196:199], v[124:127]
    ds_read_b64_tr_b16 a[190:191], v49 offset:26240
    v_mfma_f32_16x16x32_bf16 v[132:135], a[164:167], a[200:203], v[132:135]
    ds_read_b128 a[208:211], v55 offset:2048
    s_waitcnt lgkmcnt(10)
    v_mfma_f32_16x16x32_bf16 v[136:139], a[168:171], a[192:195], v[136:139]
    ds_read_b64_tr_b16 a[160:161], v40 offset:24832
    v_mfma_f32_16x16x32_bf16 v[144:147], a[168:171], a[196:199], v[144:147]
    ds_read_b64_tr_b16 a[162:163], v40 offset:26368
    v_mfma_f32_16x16x32_bf16 v[152:155], a[168:171], a[200:203], v[152:155]
    ds_read_b128 a[212:215], v55 offset:4096
    v_mfma_f32_16x16x32_bf16 v[140:143], a[172:175], a[192:195], v[140:143]
    ds_read_b64_tr_b16 a[164:165], v43 offset:24832
    v_mfma_f32_16x16x32_bf16 v[148:151], a[172:175], a[196:199], v[148:151]
    ds_read_b64_tr_b16 a[166:167], v43 offset:26368
    v_mfma_f32_16x16x32_bf16 v[156:159], a[172:175], a[200:203], v[156:159]
    buffer_load_dwordx4 v13, s[8:11], s25 offen offset:2048 lds
    s_waitcnt lgkmcnt(11)
    v_mfma_f32_16x16x32_bf16 v[160:163], a[176:179], a[192:195], v[160:163]
    s_add_u32 s33, s32, 1024
    ds_read_b64_tr_b16 a[168:169], v46 offset:24832
    v_mfma_f32_16x16x32_bf16 v[168:171], a[176:179], a[196:199], v[168:171]
    ds_read_b64_tr_b16 a[170:171], v46 offset:26368
    v_mfma_f32_16x16x32_bf16 v[176:179], a[176:179], a[200:203], v[176:179]
    s_add_u32 s25, s25, 786432
    s_add_u32 s24, s24, 128
    v_mfma_f32_16x16x32_bf16 v[164:167], a[180:183], a[192:195], v[164:167]
    ds_read_b64_tr_b16 a[172:173], v49 offset:24832
    v_mfma_f32_16x16x32_bf16 v[172:175], a[180:183], a[196:199], v[172:175]
    ds_read_b64_tr_b16 a[174:175], v49 offset:26368
    v_mfma_f32_16x16x32_bf16 v[180:183], a[180:183], a[200:203], v[180:183]
    buffer_store_dwordx4 a[108:111], v1, s[20:23], s33 offen sc1
    s_waitcnt lgkmcnt(10)
    v_mfma_f32_16x16x32_bf16 v[184:187], a[184:187], a[192:195], v[184:187]
    s_add_u32 s33, s32, 197632
    ds_read_b64_tr_b16 a[176:177], v40 offset:36864
    v_mfma_f32_16x16x32_bf16 v[192:195], a[184:187], a[196:199], v[192:195]
    ds_read_b64_tr_b16 a[178:179], v40 offset:38400
    v_mfma_f32_16x16x32_bf16 v[200:203], a[184:187], a[200:203], v[200:203]
    s_cmp_eq_u32 s24, 1280
    s_cmov_b32 s24, 0
    s_cmov_b32 s25, s26
    v_mfma_f32_16x16x32_bf16 v[188:191], a[188:191], a[192:195], v[188:191]
    s_add_u32 m0, s29, 49152
    ds_read_b64_tr_b16 a[180:181], v43 offset:36864
    v_mfma_f32_16x16x32_bf16 v[196:199], a[188:191], a[196:199], v[196:199]
    ds_read_b64_tr_b16 a[182:183], v43 offset:38400
    v_mfma_f32_16x16x32_bf16 v[204:207], a[188:191], a[200:203], v[204:207]
    buffer_load_dwordx4 v2, s[4:7], s24 offen lds
    s_waitcnt lgkmcnt(8)
    v_mfma_f32_16x16x32_bf16 v[208:211], a[160:163], a[192:195], v[208:211]
    ds_read_b64_tr_b16 a[184:185], v46 offset:36864
    v_mfma_f32_16x16x32_bf16 v[216:219], a[160:163], a[196:199], v[216:219]
    ds_read_b64_tr_b16 a[186:187], v46 offset:38400
    v_mfma_f32_16x16x32_bf16 v[224:227], a[160:163], a[200:203], v[224:227]
    buffer_load_dwordx4 v3, s[4:7], s24 offen offset:1024 lds
    v_mfma_f32_16x16x32_bf16 v[212:215], a[164:167], a[192:195], v[212:215]
    ds_read_b64_tr_b16 a[188:189], v49 offset:36864
    v_mfma_f32_16x16x32_bf16 v[220:223], a[164:167], a[196:199], v[220:223]
    ds_read_b64_tr_b16 a[190:191], v49 offset:38400
    v_mfma_f32_16x16x32_bf16 v[228:231], a[164:167], a[200:203], v[228:231]
    buffer_load_dwordx4 v4, s[4:7], s24 offen offset:2048 lds
    s_waitcnt lgkmcnt(8)
    v_mfma_f32_16x16x32_bf16 v[232:235], a[168:171], a[192:195], v[232:235]
    s_add_u32 m0, s29, 61440
    ds_read_b64_tr_b16 a[160:161], v40 offset:36992
    v_mfma_f32_16x16x32_bf16 v[240:243], a[168:171], a[196:199], v[240:243]
    ds_read_b64_tr_b16 a[162:163], v40 offset:38528
    v_mfma_f32_16x16x32_bf16 v[248:251], a[168:171], a[200:203], v[248:251]
    buffer_load_dwordx4 v5, s[4:7], s24 offen lds
    v_mfma_f32_16x16x32_bf16 v[236:239], a[172:175], a[192:195], v[236:239]
    ds_read_b64_tr_b16 a[164:165], v43 offset:36992
    v_mfma_f32_16x16x32_bf16 v[244:247], a[172:175], a[196:199], v[244:247]
    ds_read_b64_tr_b16 a[166:167], v43 offset:38528
    v_mfma_f32_16x16x32_bf16 v[252:255], a[172:175], a[200:203], v[252:255]
    buffer_load_dwordx4 v6, s[4:7], s24 offen offset:1024 lds
    s_waitcnt lgkmcnt(8)
    v_mfma_f32_16x16x32_bf16 v[112:115], a[176:179], a[204:207], v[112:115]
    ds_read_b64_tr_b16 a[168:169], v46 offset:36992
    v_mfma_f32_16x16x32_bf16 v[120:123], a[176:179], a[208:211], v[120:123]
    ds_read_b64_tr_b16 a[170:171], v46 offset:38528
    v_mfma_f32_16x16x32_bf16 v[128:131], a[176:179], a[212:215], v[128:131]
    buffer_load_dwordx4 v7, s[4:7], s24 offen offset:2048 lds
    s_add_u32 m0, s29, 73728
    v_mfma_f32_16x16x32_bf16 v[116:119], a[180:183], a[204:207], v[116:119]
    ds_read_b64_tr_b16 a[172:173], v49 offset:36992
    v_mfma_f32_16x16x32_bf16 v[124:127], a[180:183], a[208:211], v[124:127]
    ds_read_b64_tr_b16 a[174:175], v49 offset:38528
    v_mfma_f32_16x16x32_bf16 v[132:135], a[180:183], a[212:215], v[132:135]
    buffer_load_dwordx4 v8, s[8:11], s25 offen lds
    s_waitcnt lgkmcnt(8)
    v_mfma_f32_16x16x32_bf16 v[136:139], a[184:187], a[204:207], v[136:139]
    ds_read_b64_tr_b16 a[176:177], v40 offset:37120
    v_mfma_f32_16x16x32_bf16 v[144:147], a[184:187], a[208:211], v[144:147]
    ds_read_b64_tr_b16 a[178:179], v40 offset:38656
    v_mfma_f32_16x16x32_bf16 v[152:155], a[184:187], a[212:215], v[152:155]
    buffer_load_dwordx4 v9, s[8:11], s25 offen offset:1024 lds
    v_mfma_f32_16x16x32_bf16 v[140:143], a[188:191], a[204:207], v[140:143]
    ds_read_b64_tr_b16 a[180:181], v43 offset:37120
    v_mfma_f32_16x16x32_bf16 v[148:151], a[188:191], a[208:211], v[148:151]
    ds_read_b64_tr_b16 a[182:183], v43 offset:38656
    v_mfma_f32_16x16x32_bf16 v[156:159], a[188:191], a[212:215], v[156:159]
    buffer_load_dwordx4 v10, s[8:11], s25 offen offset:2048 lds
    s_waitcnt lgkmcnt(8)
    v_mfma_f32_16x16x32_bf16 v[160:163], a[160:163], a[204:207], v[160:163]
    ds_read_b64_tr_b16 a[184:185], v46 offset:37120
    v_mfma_f32_16x16x32_bf16 v[168:171], a[160:163], a[208:211], v[168:171]
    ds_read_b64_tr_b16 a[186:187], v46 offset:38656
    v_mfma_f32_16x16x32_bf16 v[176:179], a[160:163], a[212:215], v[176:179]
    buffer_store_dwordx4 a[112:115], v1, s[20:23], s33 offen sc1
    v_mfma_f32_16x16x32_bf16 v[164:167], a[164:167], a[204:207], v[164:167]
    ds_read_b64_tr_b16 a[188:189], v49 offset:37120
    v_mfma_f32_16x16x32_bf16 v[172:175], a[164:167], a[208:211], v[172:175]
    ds_read_b64_tr_b16 a[190:191], v49 offset:38656
    v_mfma_f32_16x16x32_bf16 v[180:183], a[164:167], a[212:215], v[180:183]
    s_waitcnt vmcnt(11)
    s_barrier
    s_waitcnt lgkmcnt(8)
    v_mfma_f32_16x16x32_bf16 v[184:187], a[168:171], a[204:207], v[184:187]
    s_add_u32 m0, s29, 86016
    ds_read_b64_tr_b16 a[160:161], v38 offset:24576
    v_mfma_f32_16x16x32_bf16 v[192:195], a[168:171], a[208:211], v[192:195]
    ds_read_b64_tr_b16 a[162:163], v38 offset:26112
    v_mfma_f32_16x16x32_bf16 v[200:203], a[168:171], a[212:215], v[200:203]
    ds_read_b128 a[192:195], v50 offset:0
    v_mfma_f32_16x16x32_bf16 v[188:191], a[172:175], a[204:207], v[188:191]
    ds_read_b64_tr_b16 a[164:165], v41 offset:24576
    v_mfma_f32_16x16x32_bf16 v[196:199], a[172:175], a[208:211], v[196:199]
    ds_read_b64_tr_b16 a[166:167], v41 offset:26112
    v_mfma_f32_16x16x32_bf16 v[204:207], a[172:175], a[212:215], v[204:207]
    ds_read_b128 a[196:199], v50 offset:2048
    s_waitcnt lgkmcnt(10)
    v_mfma_f32_16x16x32_bf16 v[208:211], a[176:179], a[204:207], v[208:211]
    ds_read_b64_tr_b16 a[168:169], v44 offset:24576
    v_mfma_f32_16x16x32_bf16 v[216:219], a[176:179], a[208:211], v[216:219]
    ds_read_b64_tr_b16 a[170:171], v44 offset:26112
    v_mfma_f32_16x16x32_bf16 v[224:227], a[176:179], a[212:215], v[224:227]
    ds_read_b128 a[200:203], v50 offset:4096
    v_mfma_f32_16x16x32_bf16 v[212:215], a[180:183], a[204:207], v[212:215]
    ds_read_b64_tr_b16 a[172:173], v47 offset:24576
    v_mfma_f32_16x16x32_bf16 v[220:223], a[180:183], a[208:211], v[220:223]
    ds_read_b64_tr_b16 a[174:175], v47 offset:26112
    v_mfma_f32_16x16x32_bf16 v[228:231], a[180:183], a[212:215], v[228:231]
    buffer_load_dwordx4 v11, s[8:11], s25 offen lds
    s_waitcnt lgkmcnt(11)
    v_mfma_f32_16x16x32_bf16 v[232:235], a[184:187], a[204:207], v[232:235]
    ds_read_b64_tr_b16 a[176:177], v38 offset:24704
    v_mfma_f32_16x16x32_bf16 v[240:243], a[184:187], a[208:211], v[240:243]
    ds_read_b64_tr_b16 a[178:179], v38 offset:26240
    v_mfma_f32_16x16x32_bf16 v[248:251], a[184:187], a[212:215], v[248:251]
    buffer_load_dwordx4 v12, s[8:11], s25 offen offset:1024 lds
    v_mfma_f32_16x16x32_bf16 v[236:239], a[188:191], a[204:207], v[236:239]
    ds_read_b64_tr_b16 a[180:181], v41 offset:24704
    v_mfma_f32_16x16x32_bf16 v[244:247], a[188:191], a[208:211], v[244:247]
    ds_read_b64_tr_b16 a[182:183], v41 offset:26240
    v_mfma_f32_16x16x32_bf16 v[252:255], a[188:191], a[212:215], v[252:255]
    buffer_load_dwordx4 v13, s[8:11], s25 offen offset:2048 lds
    s_waitcnt lgkmcnt(6)
    v_mfma_f32_16x16x32_bf16 v[112:115], a[160:163], a[192:195], v[112:115]
    s_add_u32 s33, s32, 394240
    ds_read_b64_tr_b16 a[184:185], v44 offset:24704
    v_mfma_f32_16x16x32_bf16 v[120:123], a[160:163], a[196:199], v[120:123]
    ds_read_b64_tr_b16 a[186:187], v44 offset:26240
    v_mfma_f32_16x16x32_bf16 v[128:131], a[160:163], a[200:203], v[128:131]
    ds_read_b128 a[204:207], v53 offset:0
    v_mfma_f32_16x16x32_bf16 v[116:119], a[164:167], a[192:195], v[116:119]
    ds_read_b64_tr_b16 a[188:189], v47 offset:24704
    v_mfma_f32_16x16x32_bf16 v[124:127], a[164:167], a[196:199], v[124:127]
    ds_read_b64_tr_b16 a[190:191], v47 offset:26240
    v_mfma_f32_16x16x32_bf16 v[132:135], a[164:167], a[200:203], v[132:135]
    ds_read_b128 a[208:211], v53 offset:2048
    s_waitcnt lgkmcnt(10)
    v_mfma_f32_16x16x32_bf16 v[136:139], a[168:171], a[192:195], v[136:139]
    ds_read_b64_tr_b16 a[160:161], v38 offset:24832
    v_mfma_f32_16x16x32_bf16 v[144:147], a[168:171], a[196:199], v[144:147]
    ds_read_b64_tr_b16 a[162:163], v38 offset:26368
    v_mfma_f32_16x16x32_bf16 v[152:155], a[168:171], a[200:203], v[152:155]
    ds_read_b128 a[212:215], v53 offset:4096
    v_mfma_f32_16x16x32_bf16 v[140:143], a[172:175], a[192:195], v[140:143]
    ds_read_b64_tr_b16 a[164:165], v41 offset:24832
    v_mfma_f32_16x16x32_bf16 v[148:151], a[172:175], a[196:199], v[148:151]
    ds_read_b64_tr_b16 a[166:167], v41 offset:26368
    v_mfma_f32_16x16x32_bf16 v[156:159], a[172:175], a[200:203], v[156:159]
    s_add_u32 s25, s25, 786432
    s_add_u32 s24, s24, 128
    s_waitcnt lgkmcnt(11)
    v_mfma_f32_16x16x32_bf16 v[160:163], a[176:179], a[192:195], v[160:163]
    ds_read_b64_tr_b16 a[168:169], v44 offset:24832
    v_mfma_f32_16x16x32_bf16 v[168:171], a[176:179], a[196:199], v[168:171]
    ds_read_b64_tr_b16 a[170:171], v44 offset:26368
    v_mfma_f32_16x16x32_bf16 v[176:179], a[176:179], a[200:203], v[176:179]
    s_cmp_eq_u32 s24, 1280
    s_cmov_b32 s24, 0
    s_cmov_b32 s25, s26
    v_mfma_f32_16x16x32_bf16 v[164:167], a[180:183], a[192:195], v[164:167]
    s_add_u32 m0, s29, 98304
    ds_read_b64_tr_b16 a[172:173], v47 offset:24832
    v_mfma_f32_16x16x32_bf16 v[172:175], a[180:183], a[196:199], v[172:175]
    ds_read_b64_tr_b16 a[174:175], v47 offset:26368
    v_mfma_f32_16x16x32_bf16 v[180:183], a[180:183], a[200:203], v[180:183]
    buffer_load_dwordx4 v2, s[4:7], s24 offen lds
    s_waitcnt lgkmcnt(10)
    v_mfma_f32_16x16x32_bf16 v[184:187], a[184:187], a[192:195], v[184:187]
    ds_read_b64_tr_b16 a[176:177], v38 offset:36864
    v_mfma_f32_16x16x32_bf16 v[192:195], a[184:187], a[196:199], v[192:195]
    ds_read_b64_tr_b16 a[178:179], v38 offset:38400
    v_mfma_f32_16x16x32_bf16 v[200:203], a[184:187], a[200:203], v[200:203]
    buffer_load_dwordx4 v3, s[4:7], s24 offen offset:1024 lds
    v_mfma_f32_16x16x32_bf16 v[188:191], a[188:191], a[192:195], v[188:191]
    ds_read_b64_tr_b16 a[180:181], v41 offset:36864
    v_mfma_f32_16x16x32_bf16 v[196:199], a[188:191], a[196:199], v[196:199]
    ds_read_b64_tr_b16 a[182:183], v41 offset:38400
    v_mfma_f32_16x16x32_bf16 v[204:207], a[188:191], a[200:203], v[204:207]
    buffer_load_dwordx4 v4, s[4:7], s24 offen offset:2048 lds
    s_waitcnt lgkmcnt(8)
    v_mfma_f32_16x16x32_bf16 v[208:211], a[160:163], a[192:195], v[208:211]
    s_add_u32 m0, s29, 110592
    ds_read_b64_tr_b16 a[184:185], v44 offset:36864
    v_mfma_f32_16x16x32_bf16 v[216:219], a[160:163], a[196:199], v[216:219]
    ds_read_b64_tr_b16 a[186:187], v44 offset:38400
    v_mfma_f32_16x16x32_bf16 v[224:227], a[160:163], a[200:203], v[224:227]
    buffer_load_dwordx4 v5, s[4:7], s24 offen lds
    v_mfma_f32_16x16x32_bf16 v[212:215], a[164:167], a[192:195], v[212:215]
    ds_read_b64_tr_b16 a[188:189], v47 offset:36864
    v_mfma_f32_16x16x32_bf16 v[220:223], a[164:167], a[196:199], v[220:223]
    ds_read_b64_tr_b16 a[190:191], v47 offset:38400
    v_mfma_f32_16x16x32_bf16 v[228:231], a[164:167], a[200:203], v[228:231]
    buffer_load_dwordx4 v6, s[4:7], s24 offen offset:1024 lds
    s_waitcnt lgkmcnt(8)
    v_mfma_f32_16x16x32_bf16 v[232:235], a[168:171], a[192:195], v[232:235]
    ds_read_b64_tr_b16 a[160:161], v38 offset:36992
    v_mfma_f32_16x16x32_bf16 v[240:243], a[168:171], a[196:199], v[240:243]
    ds_read_b64_tr_b16 a[162:163], v38 offset:38528
    v_mfma_f32_16x16x32_bf16 v[248:251], a[168:171], a[200:203], v[248:251]
    buffer_load_dwordx4 v7, s[4:7], s24 offen offset:2048 lds
    v_mfma_f32_16x16x32_bf16 v[236:239], a[172:175], a[192:195], v[236:239]
    ds_read_b64_tr_b16 a[164:165], v41 offset:36992
    v_mfma_f32_16x16x32_bf16 v[244:247], a[172:175], a[196:199], v[244:247]
    ds_read_b64_tr_b16 a[166:167], v41 offset:38528
    v_mfma_f32_16x16x32_bf16 v[252:255], a[172:175], a[200:203], v[252:255]
    s_add_u32 m0, s29, 122880
    s_waitcnt lgkmcnt(8)
    v_mfma_f32_16x16x32_bf16 v[112:115], a[176:179], a[204:207], v[112:115]
    ds_read_b64_tr_b16 a[168:169], v44 offset:36992
    v_mfma_f32_16x16x32_bf16 v[120:123], a[176:179], a[208:211], v[120:123]
    ds_read_b64_tr_b16 a[170:171], v44 offset:38528
    v_mfma_f32_16x16x32_bf16 v[128:131], a[176:179], a[212:215], v[128:131]
    buffer_store_dwordx4 a[116:119], v1, s[20:23], s33 offen sc1
    s_add_u32 s33, s32, 2048
    v_mfma_f32_16x16x32_bf16 v[116:119], a[180:183], a[204:207], v[116:119]
    ds_read_b64_tr_b16 a[172:173], v47 offset:36992
    v_mfma_f32_16x16x32_bf16 v[124:127], a[180:183], a[208:211], v[124:127]
    ds_read_b64_tr_b16 a[174:175], v47 offset:38528
    v_mfma_f32_16x16x32_bf16 v[132:135], a[180:183], a[212:215], v[132:135]
    buffer_load_dwordx4 v8, s[8:11], s25 offen lds
    s_waitcnt lgkmcnt(8)
    v_mfma_f32_16x16x32_bf16 v[136:139], a[184:187], a[204:207], v[136:139]
    ds_read_b64_tr_b16 a[176:177], v38 offset:37120
    v_mfma_f32_16x16x32_bf16 v[144:147], a[184:187], a[208:211], v[144:147]
    ds_read_b64_tr_b16 a[178:179], v38 offset:38656
    v_mfma_f32_16x16x32_bf16 v[152:155], a[184:187], a[212:215], v[152:155]
    buffer_load_dwordx4 v9, s[8:11], s25 offen offset:1024 lds
    v_mfma_f32_16x16x32_bf16 v[140:143], a[188:191], a[204:207], v[140:143]
    ds_read_b64_tr_b16 a[180:181], v41 offset:37120
    v_mfma_f32_16x16x32_bf16 v[148:151], a[188:191], a[208:211], v[148:151]
    ds_read_b64_tr_b16 a[182:183], v41 offset:38656
    v_mfma_f32_16x16x32_bf16 v[156:159], a[188:191], a[212:215], v[156:159]
    buffer_load_dwordx4 v10, s[8:11], s25 offen offset:2048 lds
    s_waitcnt lgkmcnt(8)
    v_mfma_f32_16x16x32_bf16 v[160:163], a[160:163], a[204:207], v[160:163]
    ds_read_b64_tr_b16 a[184:185], v44 offset:37120
    v_mfma_f32_16x16x32_bf16 v[168:171], a[160:163], a[208:211], v[168:171]
    ds_read_b64_tr_b16 a[186:187], v44 offset:38656
    v_mfma_f32_16x16x32_bf16 v[176:179], a[160:163], a[212:215], v[176:179]
    buffer_store_dwordx4 a[132:135], v1, s[20:23], s33 offen sc1
    v_mfma_f32_16x16x32_bf16 v[164:167], a[164:167], a[204:207], v[164:167]
    ds_read_b64_tr_b16 a[188:189], v47 offset:37120
    v_mfma_f32_16x16x32_bf16 v[172:175], a[164:167], a[208:211], v[172:175]
    ds_read_b64_tr_b16 a[190:191], v47 offset:38656
    v_mfma_f32_16x16x32_bf16 v[180:183], a[164:167], a[212:215], v[180:183]
    s_waitcnt vmcnt(11)
    s_barrier
    s_waitcnt lgkmcnt(8)
    v_mfma_f32_16x16x32_bf16 v[184:187], a[168:171], a[204:207], v[184:187]
    s_add_u32 m0, s29, 135168
    ds_read_b64_tr_b16 a[160:161], v39 offset:24576
    v_mfma_f32_16x16x32_bf16 v[192:195], a[168:171], a[208:211], v[192:195]
    ds_read_b64_tr_b16 a[162:163], v39 offset:26112
    v_mfma_f32_16x16x32_bf16 v[200:203], a[168:171], a[212:215], v[200:203]
    ds_read_b128 a[192:195], v51 offset:0
    v_mfma_f32_16x16x32_bf16 v[188:191], a[172:175], a[204:207], v[188:191]
    ds_read_b64_tr_b16 a[164:165], v42 offset:24576
    v_mfma_f32_16x16x32_bf16 v[196:199], a[172:175], a[208:211], v[196:199]
    ds_read_b64_tr_b16 a[166:167], v42 offset:26112
    v_mfma_f32_16x16x32_bf16 v[204:207], a[172:175], a[212:215], v[204:207]
    ds_read_b128 a[196:199], v51 offset:2048
    s_waitcnt lgkmcnt(10)
    v_mfma_f32_16x16x32_bf16 v[208:211], a[176:179], a[204:207], v[208:211]
    ds_read_b64_tr_b16 a[168:169], v45 offset:24576
    v_mfma_f32_16x16x32_bf16 v[216:219], a[176:179], a[208:211], v[216:219]
    ds_read_b64_tr_b16 a[170:171], v45 offset:26112
    v_mfma_f32_16x16x32_bf16 v[224:227], a[176:179], a[212:215], v[224:227]
    ds_read_b128 a[200:203], v51 offset:4096
    v_mfma_f32_16x16x32_bf16 v[212:215], a[180:183], a[204:207], v[212:215]
    ds_read_b64_tr_b16 a[172:173], v48 offset:24576
    v_mfma_f32_16x16x32_bf16 v[220:223], a[180:183], a[208:211], v[220:223]
    ds_read_b64_tr_b16 a[174:175], v48 offset:26112
    v_mfma_f32_16x16x32_bf16 v[228:231], a[180:183], a[212:215], v[228:231]
    buffer_load_dwordx4 v11, s[8:11], s25 offen lds
    s_waitcnt lgkmcnt(11)
    v_mfma_f32_16x16x32_bf16 v[232:235], a[184:187], a[204:207], v[232:235]
    ds_read_b64_tr_b16 a[176:177], v39 offset:24704
    v_mfma_f32_16x16x32_bf16 v[240:243], a[184:187], a[208:211], v[240:243]
    ds_read_b64_tr_b16 a[178:179], v39 offset:26240
    v_mfma_f32_16x16x32_bf16 v[248:251], a[184:187], a[212:215], v[248:251]
    buffer_load_dwordx4 v12, s[8:11], s25 offen offset:1024 lds
    v_mfma_f32_16x16x32_bf16 v[236:239], a[188:191], a[204:207], v[236:239]
    ds_read_b64_tr_b16 a[180:181], v42 offset:24704
    v_mfma_f32_16x16x32_bf16 v[244:247], a[188:191], a[208:211], v[244:247]
    ds_read_b64_tr_b16 a[182:183], v42 offset:26240
    v_mfma_f32_16x16x32_bf16 v[252:255], a[188:191], a[212:215], v[252:255]
    buffer_load_dwordx4 v13, s[8:11], s25 offen offset:2048 lds
    s_waitcnt lgkmcnt(6)
    v_mfma_f32_16x16x32_bf16 v[112:115], a[160:163], a[192:195], v[112:115]
    s_add_u32 s33, s32, 198656
    ds_read_b64_tr_b16 a[184:185], v45 offset:24704
    v_mfma_f32_16x16x32_bf16 v[120:123], a[160:163], a[196:199], v[120:123]
    ds_read_b64_tr_b16 a[186:187], v45 offset:26240
    v_mfma_f32_16x16x32_bf16 v[128:131], a[160:163], a[200:203], v[128:131]
    ds_read_b128 a[204:207], v54 offset:0
    v_mfma_f32_16x16x32_bf16 v[116:119], a[164:167], a[192:195], v[116:119]
    ds_read_b64_tr_b16 a[188:189], v48 offset:24704
    v_mfma_f32_16x16x32_bf16 v[124:127], a[164:167], a[196:199], v[124:127]
    ds_read_b64_tr_b16 a[190:191], v48 offset:26240
    v_mfma_f32_16x16x32_bf16 v[132:135], a[164:167], a[200:203], v[132:135]
    ds_read_b128 a[208:211], v54 offset:2048
    s_waitcnt lgkmcnt(10)
    v_mfma_f32_16x16x32_bf16 v[136:139], a[168:171], a[192:195], v[136:139]
    ds_read_b64_tr_b16 a[160:161], v39 offset:24832
    v_mfma_f32_16x16x32_bf16 v[144:147], a[168:171], a[196:199], v[144:147]
    ds_read_b64_tr_b16 a[162:163], v39 offset:26368
    v_mfma_f32_16x16x32_bf16 v[152:155], a[168:171], a[200:203], v[152:155]
    ds_read_b128 a[212:215], v54 offset:4096
    v_mfma_f32_16x16x32_bf16 v[140:143], a[172:175], a[192:195], v[140:143]
    ds_read_b64_tr_b16 a[164:165], v42 offset:24832
    v_mfma_f32_16x16x32_bf16 v[148:151], a[172:175], a[196:199], v[148:151]
    ds_read_b64_tr_b16 a[166:167], v42 offset:26368
    v_mfma_f32_16x16x32_bf16 v[156:159], a[172:175], a[200:203], v[156:159]
    s_add_u32 s25, s25, 786432
    s_add_u32 s24, s24, 128
    s_waitcnt lgkmcnt(11)
    v_mfma_f32_16x16x32_bf16 v[160:163], a[176:179], a[192:195], v[160:163]
    ds_read_b64_tr_b16 a[168:169], v45 offset:24832
    v_mfma_f32_16x16x32_bf16 v[168:171], a[176:179], a[196:199], v[168:171]
    ds_read_b64_tr_b16 a[170:171], v45 offset:26368
    v_mfma_f32_16x16x32_bf16 v[176:179], a[176:179], a[200:203], v[176:179]
    s_cmp_eq_u32 s24, 1280
    s_cmov_b32 s24, 0
    s_cmov_b32 s25, s26
    v_mfma_f32_16x16x32_bf16 v[164:167], a[180:183], a[192:195], v[164:167]
    s_add_u32 m0, s29, 0
    ds_read_b64_tr_b16 a[172:173], v48 offset:24832
    v_mfma_f32_16x16x32_bf16 v[172:175], a[180:183], a[196:199], v[172:175]
    ds_read_b64_tr_b16 a[174:175], v48 offset:26368
    v_mfma_f32_16x16x32_bf16 v[180:183], a[180:183], a[200:203], v[180:183]
    buffer_load_dwordx4 v2, s[4:7], s24 offen lds
    s_waitcnt lgkmcnt(10)
    v_mfma_f32_16x16x32_bf16 v[184:187], a[184:187], a[192:195], v[184:187]
    ds_read_b64_tr_b16 a[176:177], v39 offset:36864
    v_mfma_f32_16x16x32_bf16 v[192:195], a[184:187], a[196:199], v[192:195]
    ds_read_b64_tr_b16 a[178:179], v39 offset:38400
    v_mfma_f32_16x16x32_bf16 v[200:203], a[184:187], a[200:203], v[200:203]
    buffer_load_dwordx4 v3, s[4:7], s24 offen offset:1024 lds
    v_mfma_f32_16x16x32_bf16 v[188:191], a[188:191], a[192:195], v[188:191]
    ds_read_b64_tr_b16 a[180:181], v42 offset:36864
    v_mfma_f32_16x16x32_bf16 v[196:199], a[188:191], a[196:199], v[196:199]
    ds_read_b64_tr_b16 a[182:183], v42 offset:38400
    v_mfma_f32_16x16x32_bf16 v[204:207], a[188:191], a[200:203], v[204:207]
    buffer_load_dwordx4 v4, s[4:7], s24 offen offset:2048 lds
    s_waitcnt lgkmcnt(8)
    v_mfma_f32_16x16x32_bf16 v[208:211], a[160:163], a[192:195], v[208:211]
    s_add_u32 m0, s29, 12288
    ds_read_b64_tr_b16 a[184:185], v45 offset:36864
    v_mfma_f32_16x16x32_bf16 v[216:219], a[160:163], a[196:199], v[216:219]
    ds_read_b64_tr_b16 a[186:187], v45 offset:38400
    v_mfma_f32_16x16x32_bf16 v[224:227], a[160:163], a[200:203], v[224:227]
    buffer_load_dwordx4 v5, s[4:7], s24 offen lds
    v_mfma_f32_16x16x32_bf16 v[212:215], a[164:167], a[192:195], v[212:215]
    ds_read_b64_tr_b16 a[188:189], v48 offset:36864
    v_mfma_f32_16x16x32_bf16 v[220:223], a[164:167], a[196:199], v[220:223]
    ds_read_b64_tr_b16 a[190:191], v48 offset:38400
    v_mfma_f32_16x16x32_bf16 v[228:231], a[164:167], a[200:203], v[228:231]
    buffer_load_dwordx4 v6, s[4:7], s24 offen offset:1024 lds
    s_waitcnt lgkmcnt(8)
    v_mfma_f32_16x16x32_bf16 v[232:235], a[168:171], a[192:195], v[232:235]
    ds_read_b64_tr_b16 a[160:161], v39 offset:36992
    v_mfma_f32_16x16x32_bf16 v[240:243], a[168:171], a[196:199], v[240:243]
    ds_read_b64_tr_b16 a[162:163], v39 offset:38528
    v_mfma_f32_16x16x32_bf16 v[248:251], a[168:171], a[200:203], v[248:251]
    buffer_load_dwordx4 v7, s[4:7], s24 offen offset:2048 lds
    v_mfma_f32_16x16x32_bf16 v[236:239], a[172:175], a[192:195], v[236:239]
    ds_read_b64_tr_b16 a[164:165], v42 offset:36992
    v_mfma_f32_16x16x32_bf16 v[244:247], a[172:175], a[196:199], v[244:247]
    ds_read_b64_tr_b16 a[166:167], v42 offset:38528
    v_mfma_f32_16x16x32_bf16 v[252:255], a[172:175], a[200:203], v[252:255]
    s_add_u32 m0, s29, 24576
    s_waitcnt lgkmcnt(8)
    v_mfma_f32_16x16x32_bf16 v[112:115], a[176:179], a[204:207], v[112:115]
    ds_read_b64_tr_b16 a[168:169], v45 offset:36992
    v_mfma_f32_16x16x32_bf16 v[120:123], a[176:179], a[208:211], v[120:123]
    ds_read_b64_tr_b16 a[170:171], v45 offset:38528
    v_mfma_f32_16x16x32_bf16 v[128:131], a[176:179], a[212:215], v[128:131]
    buffer_store_dwordx4 a[136:139], v1, s[20:23], s33 offen sc1
    s_add_u32 s33, s32, 395264
    v_mfma_f32_16x16x32_bf16 v[116:119], a[180:183], a[204:207], v[116:119]
    ds_read_b64_tr_b16 a[172:173], v48 offset:36992
    v_mfma_f32_16x16x32_bf16 v[124:127], a[180:183], a[208:211], v[124:127]
    ds_read_b64_tr_b16 a[174:175], v48 offset:38528
    v_mfma_f32_16x16x32_bf16 v[132:135], a[180:183], a[212:215], v[132:135]
    buffer_load_dwordx4 v8, s[8:11], s25 offen lds
    s_waitcnt lgkmcnt(8)
    v_mfma_f32_16x16x32_bf16 v[136:139], a[184:187], a[204:207], v[136:139]
    ds_read_b64_tr_b16 a[176:177], v39 offset:37120
    v_mfma_f32_16x16x32_bf16 v[144:147], a[184:187], a[208:211], v[144:147]
    ds_read_b64_tr_b16 a[178:179], v39 offset:38656
    v_mfma_f32_16x16x32_bf16 v[152:155], a[184:187], a[212:215], v[152:155]
    buffer_load_dwordx4 v9, s[8:11], s25 offen offset:1024 lds
    v_mfma_f32_16x16x32_bf16 v[140:143], a[188:191], a[204:207], v[140:143]
    ds_read_b64_tr_b16 a[180:181], v42 offset:37120
    v_mfma_f32_16x16x32_bf16 v[148:151], a[188:191], a[208:211], v[148:151]
    ds_read_b64_tr_b16 a[182:183], v42 offset:38656
    v_mfma_f32_16x16x32_bf16 v[156:159], a[188:191], a[212:215], v[156:159]
    buffer_load_dwordx4 v10, s[8:11], s25 offen offset:2048 lds
    s_waitcnt lgkmcnt(8)
    v_mfma_f32_16x16x32_bf16 v[160:163], a[160:163], a[204:207], v[160:163]
    ds_read_b64_tr_b16 a[184:185], v45 offset:37120
    v_mfma_f32_16x16x32_bf16 v[168:171], a[160:163], a[208:211], v[168:171]
    ds_read_b64_tr_b16 a[186:187], v45 offset:38656
    v_mfma_f32_16x16x32_bf16 v[176:179], a[160:163], a[212:215], v[176:179]
    buffer_store_dwordx4 a[140:143], v1, s[20:23], s33 offen sc1
    v_mfma_f32_16x16x32_bf16 v[164:167], a[164:167], a[204:207], v[164:167]
    ds_read_b64_tr_b16 a[188:189], v48 offset:37120
    v_mfma_f32_16x16x32_bf16 v[172:175], a[164:167], a[208:211], v[172:175]
    ds_read_b64_tr_b16 a[190:191], v48 offset:38656
    v_mfma_f32_16x16x32_bf16 v[180:183], a[164:167], a[212:215], v[180:183]
    s_waitcnt vmcnt(11)
    s_barrier
    s_waitcnt lgkmcnt(8)
    v_mfma_f32_16x16x32_bf16 v[184:187], a[168:171], a[204:207], v[184:187]
    s_add_u32 m0, s29, 36864
    ds_read_b64_tr_b16 a[160:161], v40 offset:24576
    v_mfma_f32_16x16x32_bf16 v[192:195], a[168:171], a[208:211], v[192:195]
    ds_read_b64_tr_b16 a[162:163], v40 offset:26112
    v_mfma_f32_16x16x32_bf16 v[200:203], a[168:171], a[212:215], v[200:203]
    ds_read_b128 a[192:195], v52 offset:0
    v_mfma_f32_16x16x32_bf16 v[188:191], a[172:175], a[204:207], v[188:191]
    ds_read_b64_tr_b16 a[164:165], v43 offset:24576
    v_mfma_f32_16x16x32_bf16 v[196:199], a[172:175], a[208:211], v[196:199]
    ds_read_b64_tr_b16 a[166:167], v43 offset:26112
    v_mfma_f32_16x16x32_bf16 v[204:207], a[172:175], a[212:215], v[204:207]
    ds_read_b128 a[196:199], v52 offset:2048
    s_waitcnt lgkmcnt(10)
    v_mfma_f32_16x16x32_bf16 v[208:211], a[176:179], a[204:207], v[208:211]
    ds_read_b64_tr_b16 a[168:169], v46 offset:24576
    v_mfma_f32_16x16x32_bf16 v[216:219], a[176:179], a[208:211], v[216:219]
    ds_read_b64_tr_b16 a[170:171], v46 offset:26112
    v_mfma_f32_16x16x32_bf16 v[224:227], a[176:179], a[212:215], v[224:227]
    ds_read_b128 a[200:203], v52 offset:4096
    v_mfma_f32_16x16x32_bf16 v[212:215], a[180:183], a[204:207], v[212:215]
    ds_read_b64_tr_b16 a[172:173], v49 offset:24576
    v_mfma_f32_16x16x32_bf16 v[220:223], a[180:183], a[208:211], v[220:223]
    ds_read_b64_tr_b16 a[174:175], v49 offset:26112
    v_mfma_f32_16x16x32_bf16 v[228:231], a[180:183], a[212:215], v[228:231]
    buffer_load_dwordx4 v11, s[8:11], s25 offen lds
    s_waitcnt lgkmcnt(11)
    v_mfma_f32_16x16x32_bf16 v[232:235], a[184:187], a[204:207], v[232:235]
    ds_read_b64_tr_b16 a[176:177], v40 offset:24704
    v_mfma_f32_16x16x32_bf16 v[240:243], a[184:187], a[208:211], v[240:243]
    ds_read_b64_tr_b16 a[178:179], v40 offset:26240
    v_mfma_f32_16x16x32_bf16 v[248:251], a[184:187], a[212:215], v[248:251]
    buffer_load_dwordx4 v12, s[8:11], s25 offen offset:1024 lds
    v_mfma_f32_16x16x32_bf16 v[236:239], a[188:191], a[204:207], v[236:239]
    ds_read_b64_tr_b16 a[180:181], v43 offset:24704
    v_mfma_f32_16x16x32_bf16 v[244:247], a[188:191], a[208:211], v[244:247]
    ds_read_b64_tr_b16 a[182:183], v43 offset:26240
    v_mfma_f32_16x16x32_bf16 v[252:255], a[188:191], a[212:215], v[252:255]
    buffer_load_dwordx4 v13, s[8:11], s25 offen offset:2048 lds
    s_waitcnt lgkmcnt(6)
    v_mfma_f32_16x16x32_bf16 v[112:115], a[160:163], a[192:195], v[112:115]
    s_add_u32 s33, s32, 3072
    ds_read_b64_tr_b16 a[184:185], v46 offset:24704
    v_mfma_f32_16x16x32_bf16 v[120:123], a[160:163], a[196:199], v[120:123]
    ds_read_b64_tr_b16 a[186:187], v46 offset:26240
    v_mfma_f32_16x16x32_bf16 v[128:131], a[160:163], a[200:203], v[128:131]
    ds_read_b128 a[204:207], v55 offset:0
    v_mfma_f32_16x16x32_bf16 v[116:119], a[164:167], a[192:195], v[116:119]
    ds_read_b64_tr_b16 a[188:189], v49 offset:24704
    v_mfma_f32_16x16x32_bf16 v[124:127], a[164:167], a[196:199], v[124:127]
    ds_read_b64_tr_b16 a[190:191], v49 offset:26240
    v_mfma_f32_16x16x32_bf16 v[132:135], a[164:167], a[200:203], v[132:135]
    ds_read_b128 a[208:211], v55 offset:2048
    s_waitcnt lgkmcnt(10)
    v_mfma_f32_16x16x32_bf16 v[136:139], a[168:171], a[192:195], v[136:139]
    ds_read_b64_tr_b16 a[160:161], v40 offset:24832
    v_mfma_f32_16x16x32_bf16 v[144:147], a[168:171], a[196:199], v[144:147]
    ds_read_b64_tr_b16 a[162:163], v40 offset:26368
    v_mfma_f32_16x16x32_bf16 v[152:155], a[168:171], a[200:203], v[152:155]
    ds_read_b128 a[212:215], v55 offset:4096
    v_mfma_f32_16x16x32_bf16 v[140:143], a[172:175], a[192:195], v[140:143]
    ds_read_b64_tr_b16 a[164:165], v43 offset:24832
    v_mfma_f32_16x16x32_bf16 v[148:151], a[172:175], a[196:199], v[148:151]
    ds_read_b64_tr_b16 a[166:167], v43 offset:26368
    v_mfma_f32_16x16x32_bf16 v[156:159], a[172:175], a[200:203], v[156:159]
    s_add_u32 s25, s25, 786432
    s_add_u32 s24, s24, 128
    s_waitcnt lgkmcnt(11)
    v_mfma_f32_16x16x32_bf16 v[160:163], a[176:179], a[192:195], v[160:163]
    ds_read_b64_tr_b16 a[168:169], v46 offset:24832
    v_mfma_f32_16x16x32_bf16 v[168:171], a[176:179], a[196:199], v[168:171]
    ds_read_b64_tr_b16 a[170:171], v46 offset:26368
    v_mfma_f32_16x16x32_bf16 v[176:179], a[176:179], a[200:203], v[176:179]
    s_cmp_eq_u32 s24, 1280
    s_cmov_b32 s24, 0
    s_cmov_b32 s25, s26
    v_mfma_f32_16x16x32_bf16 v[164:167], a[180:183], a[192:195], v[164:167]
    s_add_u32 m0, s29, 49152
    ds_read_b64_tr_b16 a[172:173], v49 offset:24832
    v_mfma_f32_16x16x32_bf16 v[172:175], a[180:183], a[196:199], v[172:175]
    ds_read_b64_tr_b16 a[174:175], v49 offset:26368
    v_mfma_f32_16x16x32_bf16 v[180:183], a[180:183], a[200:203], v[180:183]
    buffer_load_dwordx4 v2, s[4:7], s24 offen lds
    s_waitcnt lgkmcnt(10)
    v_mfma_f32_16x16x32_bf16 v[184:187], a[184:187], a[192:195], v[184:187]
    ds_read_b64_tr_b16 a[176:177], v40 offset:36864
    v_mfma_f32_16x16x32_bf16 v[192:195], a[184:187], a[196:199], v[192:195]
    ds_read_b64_tr_b16 a[178:179], v40 offset:38400
    v_mfma_f32_16x16x32_bf16 v[200:203], a[184:187], a[200:203], v[200:203]
    buffer_load_dwordx4 v3, s[4:7], s24 offen offset:1024 lds
    v_mfma_f32_16x16x32_bf16 v[188:191], a[188:191], a[192:195], v[188:191]
    ds_read_b64_tr_b16 a[180:181], v43 offset:36864
    v_mfma_f32_16x16x32_bf16 v[196:199], a[188:191], a[196:199], v[196:199]
    ds_read_b64_tr_b16 a[182:183], v43 offset:38400
    v_mfma_f32_16x16x32_bf16 v[204:207], a[188:191], a[200:203], v[204:207]
    buffer_load_dwordx4 v4, s[4:7], s24 offen offset:2048 lds
    s_waitcnt lgkmcnt(8)
    v_mfma_f32_16x16x32_bf16 v[208:211], a[160:163], a[192:195], v[208:211]
    s_add_u32 m0, s29, 61440
    ds_read_b64_tr_b16 a[184:185], v46 offset:36864
    v_mfma_f32_16x16x32_bf16 v[216:219], a[160:163], a[196:199], v[216:219]
    ds_read_b64_tr_b16 a[186:187], v46 offset:38400
    v_mfma_f32_16x16x32_bf16 v[224:227], a[160:163], a[200:203], v[224:227]
    buffer_load_dwordx4 v5, s[4:7], s24 offen lds
    v_mfma_f32_16x16x32_bf16 v[212:215], a[164:167], a[192:195], v[212:215]
    ds_read_b64_tr_b16 a[188:189], v49 offset:36864
    v_mfma_f32_16x16x32_bf16 v[220:223], a[164:167], a[196:199], v[220:223]
    ds_read_b64_tr_b16 a[190:191], v49 offset:38400
    v_mfma_f32_16x16x32_bf16 v[228:231], a[164:167], a[200:203], v[228:231]
    buffer_load_dwordx4 v6, s[4:7], s24 offen offset:1024 lds
    s_waitcnt lgkmcnt(8)
    v_mfma_f32_16x16x32_bf16 v[232:235], a[168:171], a[192:195], v[232:235]
    ds_read_b64_tr_b16 a[160:161], v40 offset:36992
    v_mfma_f32_16x16x32_bf16 v[240:243], a[168:171], a[196:199], v[240:243]
    ds_read_b64_tr_b16 a[162:163], v40 offset:38528
    v_mfma_f32_16x16x32_bf16 v[248:251], a[168:171], a[200:203], v[248:251]
    buffer_load_dwordx4 v7, s[4:7], s24 offen offset:2048 lds
    v_mfma_f32_16x16x32_bf16 v[236:239], a[172:175], a[192:195], v[236:239]
    ds_read_b64_tr_b16 a[164:165], v43 offset:36992
    v_mfma_f32_16x16x32_bf16 v[244:247], a[172:175], a[196:199], v[244:247]
    ds_read_b64_tr_b16 a[166:167], v43 offset:38528
    v_mfma_f32_16x16x32_bf16 v[252:255], a[172:175], a[200:203], v[252:255]
    s_add_u32 m0, s29, 73728
    s_waitcnt lgkmcnt(8)
    v_mfma_f32_16x16x32_bf16 v[112:115], a[176:179], a[204:207], v[112:115]
    ds_read_b64_tr_b16 a[168:169], v46 offset:36992
    v_mfma_f32_16x16x32_bf16 v[120:123], a[176:179], a[208:211], v[120:123]
    ds_read_b64_tr_b16 a[170:171], v46 offset:38528
    v_mfma_f32_16x16x32_bf16 v[128:131], a[176:179], a[212:215], v[128:131]
    buffer_store_dwordx4 a[72:75], v1, s[20:23], s33 offen sc1
    s_add_u32 s33, s32, 199680
    v_mfma_f32_16x16x32_bf16 v[116:119], a[180:183], a[204:207], v[116:119]
    ds_read_b64_tr_b16 a[172:173], v49 offset:36992
    v_mfma_f32_16x16x32_bf16 v[124:127], a[180:183], a[208:211], v[124:127]
    ds_read_b64_tr_b16 a[174:175], v49 offset:38528
    v_mfma_f32_16x16x32_bf16 v[132:135], a[180:183], a[212:215], v[132:135]
    buffer_load_dwordx4 v8, s[8:11], s25 offen lds
    s_waitcnt lgkmcnt(8)
    v_mfma_f32_16x16x32_bf16 v[136:139], a[184:187], a[204:207], v[136:139]
    ds_read_b64_tr_b16 a[176:177], v40 offset:37120
    v_mfma_f32_16x16x32_bf16 v[144:147], a[184:187], a[208:211], v[144:147]
    ds_read_b64_tr_b16 a[178:179], v40 offset:38656
    v_mfma_f32_16x16x32_bf16 v[152:155], a[184:187], a[212:215], v[152:155]
    buffer_load_dwordx4 v9, s[8:11], s25 offen offset:1024 lds
    v_mfma_f32_16x16x32_bf16 v[140:143], a[188:191], a[204:207], v[140:143]
    ds_read_b64_tr_b16 a[180:181], v43 offset:37120
    v_mfma_f32_16x16x32_bf16 v[148:151], a[188:191], a[208:211], v[148:151]
    ds_read_b64_tr_b16 a[182:183], v43 offset:38656
    v_mfma_f32_16x16x32_bf16 v[156:159], a[188:191], a[212:215], v[156:159]
    buffer_load_dwordx4 v10, s[8:11], s25 offen offset:2048 lds
    s_waitcnt lgkmcnt(8)
    v_mfma_f32_16x16x32_bf16 v[160:163], a[160:163], a[204:207], v[160:163]
    ds_read_b64_tr_b16 a[184:185], v46 offset:37120
    v_mfma_f32_16x16x32_bf16 v[168:171], a[160:163], a[208:211], v[168:171]
    ds_read_b64_tr_b16 a[186:187], v46 offset:38656
    v_mfma_f32_16x16x32_bf16 v[176:179], a[160:163], a[212:215], v[176:179]
    buffer_store_dwordx4 a[76:79], v1, s[20:23], s33 offen sc1
    s_add_u32 s33, s32, 396288
    v_mfma_f32_16x16x32_bf16 v[164:167], a[164:167], a[204:207], v[164:167]
    buffer_store_dwordx4 a[80:83], v1, s[20:23], s33 offen sc1
    v_mfma_f32_16x16x32_bf16 v[172:175], a[164:167], a[208:211], v[172:175]
    ds_read_b64_tr_b16 a[188:189], v49 offset:37120
    v_mfma_f32_16x16x32_bf16 v[180:183], a[164:167], a[212:215], v[180:183]
    s_waitcnt vmcnt(12)
    s_barrier
    s_waitcnt lgkmcnt(7)
    v_mfma_f32_16x16x32_bf16 v[184:187], a[168:171], a[204:207], v[184:187]
    s_add_u32 m0, s29, 86016
    ds_read_b64_tr_b16 a[190:191], v49 offset:38656
    v_mfma_f32_16x16x32_bf16 v[192:195], a[168:171], a[208:211], v[192:195]
    ds_read_b64_tr_b16 a[160:161], v38 offset:24576
    v_mfma_f32_16x16x32_bf16 v[200:203], a[168:171], a[212:215], v[200:203]
    ds_read_b64_tr_b16 a[162:163], v38 offset:26112
    v_mfma_f32_16x16x32_bf16 v[188:191], a[172:175], a[204:207], v[188:191]
    ds_read_b64_tr_b16 a[164:165], v41 offset:24576
    v_mfma_f32_16x16x32_bf16 v[196:199], a[172:175], a[208:211], v[196:199]
    ds_read_b64_tr_b16 a[166:167], v41 offset:26112
    v_mfma_f32_16x16x32_bf16 v[204:207], a[172:175], a[212:215], v[204:207]
    ds_read_b128 a[192:195], v50 offset:0
    s_waitcnt lgkmcnt(9)
    v_mfma_f32_16x16x32_bf16 v[208:211], a[176:179], a[204:207], v[208:211]
    ds_read_b64_tr_b16 a[168:169], v44 offset:24576
    v_mfma_f32_16x16x32_bf16 v[216:219], a[176:179], a[208:211], v[216:219]
    ds_read_b64_tr_b16 a[170:171], v44 offset:26112
    v_mfma_f32_16x16x32_bf16 v[224:227], a[176:179], a[212:215], v[224:227]
    ds_read_b128 a[196:199], v50 offset:2048
    v_mfma_f32_16x16x32_bf16 v[212:215], a[180:183], a[204:207], v[212:215]
    ds_read_b64_tr_b16 a[172:173], v47 offset:24576
    v_mfma_f32_16x16x32_bf16 v[220:223], a[180:183], a[208:211], v[220:223]
    ds_read_b128 a[200:203], v50 offset:4096
    v_mfma_f32_16x16x32_bf16 v[228:231], a[180:183], a[212:215], v[228:231]
    ds_read_b64_tr_b16 a[174:175], v47 offset:26112
    s_waitcnt lgkmcnt(11)
    v_mfma_f32_16x16x32_bf16 v[232:235], a[184:187], a[204:207], v[232:235]
    ds_read_b64_tr_b16 a[176:177], v38 offset:24704
    v_mfma_f32_16x16x32_bf16 v[240:243], a[184:187], a[208:211], v[240:243]
    ds_read_b64_tr_b16 a[178:179], v38 offset:26240
    v_mfma_f32_16x16x32_bf16 v[248:251], a[184:187], a[212:215], v[248:251]
    buffer_load_dwordx4 v11, s[8:11], s25 offen lds
    v_mfma_f32_16x16x32_bf16 v[236:239], a[188:191], a[204:207], v[236:239]
    ds_read_b64_tr_b16 a[180:181], v41 offset:24704
    v_mfma_f32_16x16x32_bf16 v[244:247], a[188:191], a[208:211], v[244:247]
    ds_read_b64_tr_b16 a[182:183], v41 offset:26240
    v_mfma_f32_16x16x32_bf16 v[252:255], a[188:191], a[212:215], v[252:255]
    buffer_load_dwordx4 v12, s[8:11], s25 offen offset:1024 lds
    s_waitcnt lgkmcnt(5)
    v_mfma_f32_16x16x32_bf16 v[112:115], a[160:163], a[192:195], v[112:115]
    ds_read_b64_tr_b16 a[184:185], v44 offset:24704
    v_mfma_f32_16x16x32_bf16 v[120:123], a[160:163], a[196:199], v[120:123]
    ds_read_b64_tr_b16 a[186:187], v44 offset:26240
    v_mfma_f32_16x16x32_bf16 v[128:131], a[160:163], a[200:203], v[128:131]
    ds_read_b128 a[204:207], v53 offset:0
    v_mfma_f32_16x16x32_bf16 v[116:119], a[164:167], a[192:195], v[116:119]
    ds_read_b64_tr_b16 a[188:189], v47 offset:24704
    v_mfma_f32_16x16x32_bf16 v[124:127], a[164:167], a[196:199], v[124:127]
    ds_read_b64_tr_b16 a[190:191], v47 offset:26240
    v_mfma_f32_16x16x32_bf16 v[132:135], a[164:167], a[200:203], v[132:135]
    ds_read_b128 a[208:211], v53 offset:2048
    s_waitcnt lgkmcnt(10)
    v_mfma_f32_16x16x32_bf16 v[136:139], a[168:171], a[192:195], v[136:139]
    ds_read_b64_tr_b16 a[160:161], v38 offset:24832
    v_mfma_f32_16x16x32_bf16 v[144:147], a[168:171], a[196:199], v[144:147]
    ds_read_b64_tr_b16 a[162:163], v38 offset:26368
    v_mfma_f32_16x16x32_bf16 v[152:155], a[168:171], a[200:203], v[152:155]
    ds_read_b128 a[212:215], v53 offset:4096
    v_mfma_f32_16x16x32_bf16 v[140:143], a[172:175], a[192:195], v[140:143]
    ds_read_b64_tr_b16 a[164:165], v41 offset:24832
    v_mfma_f32_16x16x32_bf16 v[148:151], a[172:175], a[196:199], v[148:151]
    ds_read_b64_tr_b16 a[166:167], v41 offset:26368
    v_mfma_f32_16x16x32_bf16 v[156:159], a[172:175], a[200:203], v[156:159]
    buffer_load_dwordx4 v13, s[8:11], s25 offen offset:2048 lds
    s_waitcnt lgkmcnt(11)
    v_mfma_f32_16x16x32_bf16 v[160:163], a[176:179], a[192:195], v[160:163]
    s_add_u32 s33, s32, 4096
    ds_read_b64_tr_b16 a[168:169], v44 offset:24832
    v_mfma_f32_16x16x32_bf16 v[168:171], a[176:179], a[196:199], v[168:171]
    ds_read_b64_tr_b16 a[170:171], v44 offset:26368
    v_mfma_f32_16x16x32_bf16 v[176:179], a[176:179], a[200:203], v[176:179]
    s_add_u32 s25, s25, 786432
    s_add_u32 s24, s24, 128
    v_mfma_f32_16x16x32_bf16 v[164:167], a[180:183], a[192:195], v[164:167]
    ds_read_b64_tr_b16 a[172:173], v47 offset:24832
    v_mfma_f32_16x16x32_bf16 v[172:175], a[180:183], a[196:199], v[172:175]
    ds_read_b64_tr_b16 a[174:175], v47 offset:26368
    v_mfma_f32_16x16x32_bf16 v[180:183], a[180:183], a[200:203], v[180:183]
    buffer_store_dwordx4 a[96:99], v1, s[20:23], s33 offen sc1
    s_waitcnt lgkmcnt(10)
    v_mfma_f32_16x16x32_bf16 v[184:187], a[184:187], a[192:195], v[184:187]
    s_add_u32 s33, s32, 200704
    ds_read_b64_tr_b16 a[176:177], v38 offset:36864
    v_mfma_f32_16x16x32_bf16 v[192:195], a[184:187], a[196:199], v[192:195]
    ds_read_b64_tr_b16 a[178:179], v38 offset:38400
    v_mfma_f32_16x16x32_bf16 v[200:203], a[184:187], a[200:203], v[200:203]
    s_cmp_eq_u32 s24, 1280
    s_cmov_b32 s24, 0
    s_cmov_b32 s25, s26
    v_mfma_f32_16x16x32_bf16 v[188:191], a[188:191], a[192:195], v[188:191]
    s_add_u32 m0, s29, 98304
    ds_read_b64_tr_b16 a[180:181], v41 offset:36864
    v_mfma_f32_16x16x32_bf16 v[196:199], a[188:191], a[196:199], v[196:199]
    ds_read_b64_tr_b16 a[182:183], v41 offset:38400
    v_mfma_f32_16x16x32_bf16 v[204:207], a[188:191], a[200:203], v[204:207]
    buffer_load_dwordx4 v2, s[4:7], s24 offen lds
    s_waitcnt lgkmcnt(8)
    v_mfma_f32_16x16x32_bf16 v[208:211], a[160:163], a[192:195], v[208:211]
    ds_read_b64_tr_b16 a[184:185], v44 offset:36864
    v_mfma_f32_16x16x32_bf16 v[216:219], a[160:163], a[196:199], v[216:219]
    ds_read_b64_tr_b16 a[186:187], v44 offset:38400
    v_mfma_f32_16x16x32_bf16 v[224:227], a[160:163], a[200:203], v[224:227]
    buffer_load_dwordx4 v3, s[4:7], s24 offen offset:1024 lds
    v_mfma_f32_16x16x32_bf16 v[212:215], a[164:167], a[192:195], v[212:215]
    ds_read_b64_tr_b16 a[188:189], v47 offset:36864
    v_mfma_f32_16x16x32_bf16 v[220:223], a[164:167], a[196:199], v[220:223]
    ds_read_b64_tr_b16 a[190:191], v47 offset:38400
    v_mfma_f32_16x16x32_bf16 v[228:231], a[164:167], a[200:203], v[228:231]
    buffer_load_dwordx4 v4, s[4:7], s24 offen offset:2048 lds
    s_waitcnt lgkmcnt(8)
    v_mfma_f32_16x16x32_bf16 v[232:235], a[168:171], a[192:195], v[232:235]
    s_add_u32 m0, s29, 110592
    ds_read_b64_tr_b16 a[160:161], v38 offset:36992
    v_mfma_f32_16x16x32_bf16 v[240:243], a[168:171], a[196:199], v[240:243]
    ds_read_b64_tr_b16 a[162:163], v38 offset:38528
    v_mfma_f32_16x16x32_bf16 v[248:251], a[168:171], a[200:203], v[248:251]
    buffer_load_dwordx4 v5, s[4:7], s24 offen lds
    v_mfma_f32_16x16x32_bf16 v[236:239], a[172:175], a[192:195], v[236:239]
    ds_read_b64_tr_b16 a[164:165], v41 offset:36992
    v_mfma_f32_16x16x32_bf16 v[244:247], a[172:175], a[196:199], v[244:247]
    ds_read_b64_tr_b16 a[166:167], v41 offset:38528
    v_mfma_f32_16x16x32_bf16 v[252:255], a[172:175], a[200:203], v[252:255]
    buffer_load_dwordx4 v6, s[4:7], s24 offen offset:1024 lds
    s_waitcnt lgkmcnt(8)
    v_mfma_f32_16x16x32_bf16 v[112:115], a[176:179], a[204:207], v[112:115]
    ds_read_b64_tr_b16 a[168:169], v44 offset:36992
    v_mfma_f32_16x16x32_bf16 v[120:123], a[176:179], a[208:211], v[120:123]
    ds_read_b64_tr_b16 a[170:171], v44 offset:38528
    v_mfma_f32_16x16x32_bf16 v[128:131], a[176:179], a[212:215], v[128:131]
    buffer_load_dwordx4 v7, s[4:7], s24 offen offset:2048 lds
    s_add_u32 m0, s29, 122880
    v_mfma_f32_16x16x32_bf16 v[116:119], a[180:183], a[204:207], v[116:119]
    ds_read_b64_tr_b16 a[172:173], v47 offset:36992
    v_mfma_f32_16x16x32_bf16 v[124:127], a[180:183], a[208:211], v[124:127]
    ds_read_b64_tr_b16 a[174:175], v47 offset:38528
    v_mfma_f32_16x16x32_bf16 v[132:135], a[180:183], a[212:215], v[132:135]
    buffer_load_dwordx4 v8, s[8:11], s25 offen lds
    s_waitcnt lgkmcnt(8)
    v_mfma_f32_16x16x32_bf16 v[136:139], a[184:187], a[204:207], v[136:139]
    ds_read_b64_tr_b16 a[176:177], v38 offset:37120
    v_mfma_f32_16x16x32_bf16 v[144:147], a[184:187], a[208:211], v[144:147]
    ds_read_b64_tr_b16 a[178:179], v38 offset:38656
    v_mfma_f32_16x16x32_bf16 v[152:155], a[184:187], a[212:215], v[152:155]
    buffer_load_dwordx4 v9, s[8:11], s25 offen offset:1024 lds
    v_mfma_f32_16x16x32_bf16 v[140:143], a[188:191], a[204:207], v[140:143]
    ds_read_b64_tr_b16 a[180:181], v41 offset:37120
    v_mfma_f32_16x16x32_bf16 v[148:151], a[188:191], a[208:211], v[148:151]
    ds_read_b64_tr_b16 a[182:183], v41 offset:38656
    v_mfma_f32_16x16x32_bf16 v[156:159], a[188:191], a[212:215], v[156:159]
    buffer_load_dwordx4 v10, s[8:11], s25 offen offset:2048 lds
    s_waitcnt lgkmcnt(8)
    v_mfma_f32_16x16x32_bf16 v[160:163], a[160:163], a[204:207], v[160:163]
    ds_read_b64_tr_b16 a[184:185], v44 offset:37120
    v_mfma_f32_16x16x32_bf16 v[168:171], a[160:163], a[208:211], v[168:171]
    ds_read_b64_tr_b16 a[186:187], v44 offset:38656
    v_mfma_f32_16x16x32_bf16 v[176:179], a[160:163], a[212:215], v[176:179]
    buffer_store_dwordx4 a[100:103], v1, s[20:23], s33 offen sc1
    v_mfma_f32_16x16x32_bf16 v[164:167], a[164:167], a[204:207], v[164:167]
    ds_read_b64_tr_b16 a[188:189], v47 offset:37120
    v_mfma_f32_16x16x32_bf16 v[172:175], a[164:167], a[208:211], v[172:175]
    ds_read_b64_tr_b16 a[190:191], v47 offset:38656
    v_mfma_f32_16x16x32_bf16 v[180:183], a[164:167], a[212:215], v[180:183]
    s_waitcnt vmcnt(11)
    s_barrier
    s_waitcnt lgkmcnt(8)
    v_mfma_f32_16x16x32_bf16 v[184:187], a[168:171], a[204:207], v[184:187]
    s_add_u32 m0, s29, 135168
    ds_read_b64_tr_b16 a[160:161], v39 offset:24576
    v_mfma_f32_16x16x32_bf16 v[192:195], a[168:171], a[208:211], v[192:195]
    ds_read_b64_tr_b16 a[162:163], v39 offset:26112
    v_mfma_f32_16x16x32_bf16 v[200:203], a[168:171], a[212:215], v[200:203]
    ds_read_b128 a[192:195], v51 offset:0
    v_mfma_f32_16x16x32_bf16 v[188:191], a[172:175], a[204:207], v[188:191]
    ds_read_b64_tr_b16 a[164:165], v42 offset:24576
    v_mfma_f32_16x16x32_bf16 v[196:199], a[172:175], a[208:211], v[196:199]
    ds_read_b64_tr_b16 a[166:167], v42 offset:26112
    v_mfma_f32_16x16x32_bf16 v[204:207], a[172:175], a[212:215], v[204:207]
    ds_read_b128 a[196:199], v51 offset:2048
    s_waitcnt lgkmcnt(10)
    v_mfma_f32_16x16x32_bf16 v[208:211], a[176:179], a[204:207], v[208:211]
    ds_read_b64_tr_b16 a[168:169], v45 offset:24576
    v_mfma_f32_16x16x32_bf16 v[216:219], a[176:179], a[208:211], v[216:219]
    ds_read_b64_tr_b16 a[170:171], v45 offset:26112
    v_mfma_f32_16x16x32_bf16 v[224:227], a[176:179], a[212:215], v[224:227]
    ds_read_b128 a[200:203], v51 offset:4096
    v_mfma_f32_16x16x32_bf16 v[212:215], a[180:183], a[204:207], v[212:215]
    ds_read_b64_tr_b16 a[172:173], v48 offset:24576
    v_mfma_f32_16x16x32_bf16 v[220:223], a[180:183], a[208:211], v[220:223]
    ds_read_b64_tr_b16 a[174:175], v48 offset:26112
    v_mfma_f32_16x16x32_bf16 v[228:231], a[180:183], a[212:215], v[228:231]
    buffer_load_dwordx4 v11, s[8:11], s25 offen lds
    s_waitcnt lgkmcnt(11)
    v_mfma_f32_16x16x32_bf16 v[232:235], a[184:187], a[204:207], v[232:235]
    ds_read_b64_tr_b16 a[176:177], v39 offset:24704
    v_mfma_f32_16x16x32_bf16 v[240:243], a[184:187], a[208:211], v[240:243]
    ds_read_b64_tr_b16 a[178:179], v39 offset:26240
    v_mfma_f32_16x16x32_bf16 v[248:251], a[184:187], a[212:215], v[248:251]
    buffer_load_dwordx4 v12, s[8:11], s25 offen offset:1024 lds
    v_mfma_f32_16x16x32_bf16 v[236:239], a[188:191], a[204:207], v[236:239]
    ds_read_b64_tr_b16 a[180:181], v42 offset:24704
    v_mfma_f32_16x16x32_bf16 v[244:247], a[188:191], a[208:211], v[244:247]
    ds_read_b64_tr_b16 a[182:183], v42 offset:26240
    v_mfma_f32_16x16x32_bf16 v[252:255], a[188:191], a[212:215], v[252:255]
    buffer_load_dwordx4 v13, s[8:11], s25 offen offset:2048 lds
    s_waitcnt lgkmcnt(6)
    v_mfma_f32_16x16x32_bf16 v[112:115], a[160:163], a[192:195], v[112:115]
    s_add_u32 s33, s32, 397312
    ds_read_b64_tr_b16 a[184:185], v45 offset:24704
    v_mfma_f32_16x16x32_bf16 v[120:123], a[160:163], a[196:199], v[120:123]
    ds_read_b64_tr_b16 a[186:187], v45 offset:26240
    v_mfma_f32_16x16x32_bf16 v[128:131], a[160:163], a[200:203], v[128:131]
    ds_read_b128 a[204:207], v54 offset:0
    v_mfma_f32_16x16x32_bf16 v[116:119], a[164:167], a[192:195], v[116:119]
    ds_read_b64_tr_b16 a[188:189], v48 offset:24704
    v_mfma_f32_16x16x32_bf16 v[124:127], a[164:167], a[196:199], v[124:127]
    ds_read_b64_tr_b16 a[190:191], v48 offset:26240
    v_mfma_f32_16x16x32_bf16 v[132:135], a[164:167], a[200:203], v[132:135]
    ds_read_b128 a[208:211], v54 offset:2048
    s_waitcnt lgkmcnt(10)
    v_mfma_f32_16x16x32_bf16 v[136:139], a[168:171], a[192:195], v[136:139]
    ds_read_b64_tr_b16 a[160:161], v39 offset:24832
    v_mfma_f32_16x16x32_bf16 v[144:147], a[168:171], a[196:199], v[144:147]
    ds_read_b64_tr_b16 a[162:163], v39 offset:26368
    v_mfma_f32_16x16x32_bf16 v[152:155], a[168:171], a[200:203], v[152:155]
    ds_read_b128 a[212:215], v54 offset:4096
    v_mfma_f32_16x16x32_bf16 v[140:143], a[172:175], a[192:195], v[140:143]
    ds_read_b64_tr_b16 a[164:165], v42 offset:24832
    v_mfma_f32_16x16x32_bf16 v[148:151], a[172:175], a[196:199], v[148:151]
    ds_read_b64_tr_b16 a[166:167], v42 offset:26368
    v_mfma_f32_16x16x32_bf16 v[156:159], a[172:175], a[200:203], v[156:159]
    s_add_u32 s25, s25, 786432
    s_add_u32 s24, s24, 128
    s_waitcnt lgkmcnt(11)
    v_mfma_f32_16x16x32_bf16 v[160:163], a[176:179], a[192:195], v[160:163]
    ds_read_b64_tr_b16 a[168:169], v45 offset:24832
    v_mfma_f32_16x16x32_bf16 v[168:171], a[176:179], a[196:199], v[168:171]
    ds_read_b64_tr_b16 a[170:171], v45 offset:26368
    v_mfma_f32_16x16x32_bf16 v[176:179], a[176:179], a[200:203], v[176:179]
    s_cmp_eq_u32 s24, 1280
    s_cmov_b32 s24, 0
    s_cmov_b32 s25, s26
    v_mfma_f32_16x16x32_bf16 v[164:167], a[180:183], a[192:195], v[164:167]
    s_add_u32 m0, s29, 0
    ds_read_b64_tr_b16 a[172:173], v48 offset:24832
    v_mfma_f32_16x16x32_bf16 v[172:175], a[180:183], a[196:199], v[172:175]
    ds_read_b64_tr_b16 a[174:175], v48 offset:26368
    v_mfma_f32_16x16x32_bf16 v[180:183], a[180:183], a[200:203], v[180:183]
    buffer_load_dwordx4 v2, s[4:7], s24 offen lds
    s_waitcnt lgkmcnt(10)
    v_mfma_f32_16x16x32_bf16 v[184:187], a[184:187], a[192:195], v[184:187]
    ds_read_b64_tr_b16 a[176:177], v39 offset:36864
    v_mfma_f32_16x16x32_bf16 v[192:195], a[184:187], a[196:199], v[192:195]
    ds_read_b64_tr_b16 a[178:179], v39 offset:38400
    v_mfma_f32_16x16x32_bf16 v[200:203], a[184:187], a[200:203], v[200:203]
    buffer_load_dwordx4 v3, s[4:7], s24 offen offset:1024 lds
    v_mfma_f32_16x16x32_bf16 v[188:191], a[188:191], a[192:195], v[188:191]
    ds_read_b64_tr_b16 a[180:181], v42 offset:36864
    v_mfma_f32_16x16x32_bf16 v[196:199], a[188:191], a[196:199], v[196:199]
    ds_read_b64_tr_b16 a[182:183], v42 offset:38400
    v_mfma_f32_16x16x32_bf16 v[204:207], a[188:191], a[200:203], v[204:207]
    buffer_load_dwordx4 v4, s[4:7], s24 offen offset:2048 lds
    s_waitcnt lgkmcnt(8)
    v_mfma_f32_16x16x32_bf16 v[208:211], a[160:163], a[192:195], v[208:211]
    s_add_u32 m0, s29, 12288
    ds_read_b64_tr_b16 a[184:185], v45 offset:36864
    v_mfma_f32_16x16x32_bf16 v[216:219], a[160:163], a[196:199], v[216:219]
    ds_read_b64_tr_b16 a[186:187], v45 offset:38400
    v_mfma_f32_16x16x32_bf16 v[224:227], a[160:163], a[200:203], v[224:227]
    buffer_load_dwordx4 v5, s[4:7], s24 offen lds
    v_mfma_f32_16x16x32_bf16 v[212:215], a[164:167], a[192:195], v[212:215]
    ds_read_b64_tr_b16 a[188:189], v48 offset:36864
    v_mfma_f32_16x16x32_bf16 v[220:223], a[164:167], a[196:199], v[220:223]
    ds_read_b64_tr_b16 a[190:191], v48 offset:38400
    v_mfma_f32_16x16x32_bf16 v[228:231], a[164:167], a[200:203], v[228:231]
    buffer_load_dwordx4 v6, s[4:7], s24 offen offset:1024 lds
    s_waitcnt lgkmcnt(8)
    v_mfma_f32_16x16x32_bf16 v[232:235], a[168:171], a[192:195], v[232:235]
    ds_read_b64_tr_b16 a[160:161], v39 offset:36992
    v_mfma_f32_16x16x32_bf16 v[240:243], a[168:171], a[196:199], v[240:243]
    ds_read_b64_tr_b16 a[162:163], v39 offset:38528
    v_mfma_f32_16x16x32_bf16 v[248:251], a[168:171], a[200:203], v[248:251]
    buffer_load_dwordx4 v7, s[4:7], s24 offen offset:2048 lds
    v_mfma_f32_16x16x32_bf16 v[236:239], a[172:175], a[192:195], v[236:239]
    ds_read_b64_tr_b16 a[164:165], v42 offset:36992
    v_mfma_f32_16x16x32_bf16 v[244:247], a[172:175], a[196:199], v[244:247]
    ds_read_b64_tr_b16 a[166:167], v42 offset:38528
    v_mfma_f32_16x16x32_bf16 v[252:255], a[172:175], a[200:203], v[252:255]
    s_add_u32 m0, s29, 24576
    s_waitcnt lgkmcnt(8)
    v_mfma_f32_16x16x32_bf16 v[112:115], a[176:179], a[204:207], v[112:115]
    ds_read_b64_tr_b16 a[168:169], v45 offset:36992
    v_mfma_f32_16x16x32_bf16 v[120:123], a[176:179], a[208:211], v[120:123]
    ds_read_b64_tr_b16 a[170:171], v45 offset:38528
    v_mfma_f32_16x16x32_bf16 v[128:131], a[176:179], a[212:215], v[128:131]
    buffer_store_dwordx4 a[104:107], v1, s[20:23], s33 offen sc1
    s_add_u32 s33, s32, 5120
    v_mfma_f32_16x16x32_bf16 v[116:119], a[180:183], a[204:207], v[116:119]
    ds_read_b64_tr_b16 a[172:173], v48 offset:36992
    v_mfma_f32_16x16x32_bf16 v[124:127], a[180:183], a[208:211], v[124:127]
    ds_read_b64_tr_b16 a[174:175], v48 offset:38528
    v_mfma_f32_16x16x32_bf16 v[132:135], a[180:183], a[212:215], v[132:135]
    buffer_load_dwordx4 v8, s[8:11], s25 offen lds
    s_waitcnt lgkmcnt(8)
    v_mfma_f32_16x16x32_bf16 v[136:139], a[184:187], a[204:207], v[136:139]
    ds_read_b64_tr_b16 a[176:177], v39 offset:37120
    v_mfma_f32_16x16x32_bf16 v[144:147], a[184:187], a[208:211], v[144:147]
    ds_read_b64_tr_b16 a[178:179], v39 offset:38656
    v_mfma_f32_16x16x32_bf16 v[152:155], a[184:187], a[212:215], v[152:155]
    buffer_load_dwordx4 v9, s[8:11], s25 offen offset:1024 lds
    v_mfma_f32_16x16x32_bf16 v[140:143], a[188:191], a[204:207], v[140:143]
    ds_read_b64_tr_b16 a[180:181], v42 offset:37120
    v_mfma_f32_16x16x32_bf16 v[148:151], a[188:191], a[208:211], v[148:151]
    ds_read_b64_tr_b16 a[182:183], v42 offset:38656
    v_mfma_f32_16x16x32_bf16 v[156:159], a[188:191], a[212:215], v[156:159]
    buffer_load_dwordx4 v10, s[8:11], s25 offen offset:2048 lds
    s_waitcnt lgkmcnt(8)
    v_mfma_f32_16x16x32_bf16 v[160:163], a[160:163], a[204:207], v[160:163]
    ds_read_b64_tr_b16 a[184:185], v45 offset:37120
    v_mfma_f32_16x16x32_bf16 v[168:171], a[160:163], a[208:211], v[168:171]
    ds_read_b64_tr_b16 a[186:187], v45 offset:38656
    v_mfma_f32_16x16x32_bf16 v[176:179], a[160:163], a[212:215], v[176:179]
    buffer_store_dwordx4 a[120:123], v1, s[20:23], s33 offen sc1
    v_mfma_f32_16x16x32_bf16 v[164:167], a[164:167], a[204:207], v[164:167]
    ds_read_b64_tr_b16 a[188:189], v48 offset:37120
    v_mfma_f32_16x16x32_bf16 v[172:175], a[164:167], a[208:211], v[172:175]
    ds_read_b64_tr_b16 a[190:191], v48 offset:38656
    v_mfma_f32_16x16x32_bf16 v[180:183], a[164:167], a[212:215], v[180:183]
    s_waitcnt vmcnt(11)
    s_barrier
    s_waitcnt lgkmcnt(8)
    v_mfma_f32_16x16x32_bf16 v[184:187], a[168:171], a[204:207], v[184:187]
    s_add_u32 m0, s29, 36864
    ds_read_b64_tr_b16 a[160:161], v40 offset:24576
    v_mfma_f32_16x16x32_bf16 v[192:195], a[168:171], a[208:211], v[192:195]
    ds_read_b64_tr_b16 a[162:163], v40 offset:26112
    v_mfma_f32_16x16x32_bf16 v[200:203], a[168:171], a[212:215], v[200:203]
    ds_read_b128 a[192:195], v52 offset:0
    v_mfma_f32_16x16x32_bf16 v[188:191], a[172:175], a[204:207], v[188:191]
    ds_read_b64_tr_b16 a[164:165], v43 offset:24576
    v_mfma_f32_16x16x32_bf16 v[196:199], a[172:175], a[208:211], v[196:199]
    ds_read_b64_tr_b16 a[166:167], v43 offset:26112
    v_mfma_f32_16x16x32_bf16 v[204:207], a[172:175], a[212:215], v[204:207]
    ds_read_b128 a[196:199], v52 offset:2048
    s_waitcnt lgkmcnt(10)
    v_mfma_f32_16x16x32_bf16 v[208:211], a[176:179], a[204:207], v[208:211]
    ds_read_b64_tr_b16 a[168:169], v46 offset:24576
    v_mfma_f32_16x16x32_bf16 v[216:219], a[176:179], a[208:211], v[216:219]
    ds_read_b64_tr_b16 a[170:171], v46 offset:26112
    v_mfma_f32_16x16x32_bf16 v[224:227], a[176:179], a[212:215], v[224:227]
    ds_read_b128 a[200:203], v52 offset:4096
    v_mfma_f32_16x16x32_bf16 v[212:215], a[180:183], a[204:207], v[212:215]
    ds_read_b64_tr_b16 a[172:173], v49 offset:24576
    v_mfma_f32_16x16x32_bf16 v[220:223], a[180:183], a[208:211], v[220:223]
    ds_read_b64_tr_b16 a[174:175], v49 offset:26112
    v_mfma_f32_16x16x32_bf16 v[228:231], a[180:183], a[212:215], v[228:231]
    buffer_load_dwordx4 v11, s[8:11], s25 offen lds
    s_waitcnt lgkmcnt(11)
    v_mfma_f32_16x16x32_bf16 v[232:235], a[184:187], a[204:207], v[232:235]
    ds_read_b64_tr_b16 a[176:177], v40 offset:24704
    v_mfma_f32_16x16x32_bf16 v[240:243], a[184:187], a[208:211], v[240:243]
    ds_read_b64_tr_b16 a[178:179], v40 offset:26240
    v_mfma_f32_16x16x32_bf16 v[248:251], a[184:187], a[212:215], v[248:251]
    buffer_load_dwordx4 v12, s[8:11], s25 offen offset:1024 lds
    v_mfma_f32_16x16x32_bf16 v[236:239], a[188:191], a[204:207], v[236:239]
    ds_read_b64_tr_b16 a[180:181], v43 offset:24704
    v_mfma_f32_16x16x32_bf16 v[244:247], a[188:191], a[208:211], v[244:247]
    ds_read_b64_tr_b16 a[182:183], v43 offset:26240
    v_mfma_f32_16x16x32_bf16 v[252:255], a[188:191], a[212:215], v[252:255]
    buffer_load_dwordx4 v13, s[8:11], s25 offen offset:2048 lds
    s_waitcnt lgkmcnt(6)
    v_mfma_f32_16x16x32_bf16 v[112:115], a[160:163], a[192:195], v[112:115]
    s_add_u32 s33, s32, 201728
    ds_read_b64_tr_b16 a[184:185], v46 offset:24704
    v_mfma_f32_16x16x32_bf16 v[120:123], a[160:163], a[196:199], v[120:123]
    ds_read_b64_tr_b16 a[186:187], v46 offset:26240
    v_mfma_f32_16x16x32_bf16 v[128:131], a[160:163], a[200:203], v[128:131]
    ds_read_b128 a[204:207], v55 offset:0
    v_mfma_f32_16x16x32_bf16 v[116:119], a[164:167], a[192:195], v[116:119]
    ds_read_b64_tr_b16 a[188:189], v49 offset:24704
    v_mfma_f32_16x16x32_bf16 v[124:127], a[164:167], a[196:199], v[124:127]
    ds_read_b64_tr_b16 a[190:191], v49 offset:26240
    v_mfma_f32_16x16x32_bf16 v[132:135], a[164:167], a[200:203], v[132:135]
    ds_read_b128 a[208:211], v55 offset:2048
    s_waitcnt lgkmcnt(10)
    v_mfma_f32_16x16x32_bf16 v[136:139], a[168:171], a[192:195], v[136:139]
    ds_read_b64_tr_b16 a[160:161], v40 offset:24832
    v_mfma_f32_16x16x32_bf16 v[144:147], a[168:171], a[196:199], v[144:147]
    ds_read_b64_tr_b16 a[162:163], v40 offset:26368
    v_mfma_f32_16x16x32_bf16 v[152:155], a[168:171], a[200:203], v[152:155]
    ds_read_b128 a[212:215], v55 offset:4096
    v_mfma_f32_16x16x32_bf16 v[140:143], a[172:175], a[192:195], v[140:143]
    ds_read_b64_tr_b16 a[164:165], v43 offset:24832
    v_mfma_f32_16x16x32_bf16 v[148:151], a[172:175], a[196:199], v[148:151]
    ds_read_b64_tr_b16 a[166:167], v43 offset:26368
    v_mfma_f32_16x16x32_bf16 v[156:159], a[172:175], a[200:203], v[156:159]
    s_add_u32 s25, s25, 786432
    s_add_u32 s24, s24, 128
    s_waitcnt lgkmcnt(11)
    v_mfma_f32_16x16x32_bf16 v[160:163], a[176:179], a[192:195], v[160:163]
    ds_read_b64_tr_b16 a[168:169], v46 offset:24832
    v_mfma_f32_16x16x32_bf16 v[168:171], a[176:179], a[196:199], v[168:171]
    ds_read_b64_tr_b16 a[170:171], v46 offset:26368
    v_mfma_f32_16x16x32_bf16 v[176:179], a[176:179], a[200:203], v[176:179]
    s_cmp_eq_u32 s24, 1280
    s_cmov_b32 s24, 0
    s_cmov_b32 s25, s26
    v_mfma_f32_16x16x32_bf16 v[164:167], a[180:183], a[192:195], v[164:167]
    s_add_u32 m0, s29, 49152
    ds_read_b64_tr_b16 a[172:173], v49 offset:24832
    v_mfma_f32_16x16x32_bf16 v[172:175], a[180:183], a[196:199], v[172:175]
    ds_read_b64_tr_b16 a[174:175], v49 offset:26368
    v_mfma_f32_16x16x32_bf16 v[180:183], a[180:183], a[200:203], v[180:183]
    buffer_load_dwordx4 v14, s[12:15], s27 offen nt lds
    s_waitcnt lgkmcnt(10)
    v_mfma_f32_16x16x32_bf16 v[184:187], a[184:187], a[192:195], v[184:187]
    ds_read_b64_tr_b16 a[176:177], v40 offset:36864
    v_mfma_f32_16x16x32_bf16 v[192:195], a[184:187], a[196:199], v[192:195]
    ds_read_b64_tr_b16 a[178:179], v40 offset:38400
    v_mfma_f32_16x16x32_bf16 v[200:203], a[184:187], a[200:203], v[200:203]
    buffer_load_dwordx4 v15, s[12:15], s27 offen offset:1024 nt lds
    v_mfma_f32_16x16x32_bf16 v[188:191], a[188:191], a[192:195], v[188:191]
    ds_read_b64_tr_b16 a[180:181], v43 offset:36864
    v_mfma_f32_16x16x32_bf16 v[196:199], a[188:191], a[196:199], v[196:199]
    ds_read_b64_tr_b16 a[182:183], v43 offset:38400
    v_mfma_f32_16x16x32_bf16 v[204:207], a[188:191], a[200:203], v[204:207]
    buffer_load_dwordx4 v16, s[12:15], s27 offen offset:2048 nt lds
    s_waitcnt lgkmcnt(8)
    v_mfma_f32_16x16x32_bf16 v[208:211], a[160:163], a[192:195], v[208:211]
    s_add_u32 s27, s27, 12288
    ds_read_b64_tr_b16 a[184:185], v46 offset:36864
    v_mfma_f32_16x16x32_bf16 v[216:219], a[160:163], a[196:199], v[216:219]
    s_add_u32 m0, s29, 61440
    ds_read_b64_tr_b16 a[186:187], v46 offset:38400
    v_mfma_f32_16x16x32_bf16 v[224:227], a[160:163], a[200:203], v[224:227]
    buffer_load_dwordx4 v14, s[12:15], s27 offen nt lds
    v_mfma_f32_16x16x32_bf16 v[212:215], a[164:167], a[192:195], v[212:215]
    ds_read_b64_tr_b16 a[188:189], v49 offset:36864
    v_mfma_f32_16x16x32_bf16 v[220:223], a[164:167], a[196:199], v[220:223]
    ds_read_b64_tr_b16 a[190:191], v49 offset:38400
    v_mfma_f32_16x16x32_bf16 v[228:231], a[164:167], a[200:203], v[228:231]
    buffer_load_dwordx4 v15, s[12:15], s27 offen offset:1024 nt lds
    s_waitcnt lgkmcnt(8)
    v_mfma_f32_16x16x32_bf16 v[232:235], a[168:171], a[192:195], v[232:235]
    ds_read_b64_tr_b16 a[160:161], v40 offset:36992
    v_mfma_f32_16x16x32_bf16 v[240:243], a[168:171], a[196:199], v[240:243]
    ds_read_b64_tr_b16 a[162:163], v40 offset:38528
    v_mfma_f32_16x16x32_bf16 v[248:251], a[168:171], a[200:203], v[248:251]
    buffer_load_dwordx4 v16, s[12:15], s27 offen offset:2048 nt lds
    s_add_u32 s27, s27, 12288
    v_mfma_f32_16x16x32_bf16 v[236:239], a[172:175], a[192:195], v[236:239]
    ds_read_b64_tr_b16 a[164:165], v43 offset:36992
    v_mfma_f32_16x16x32_bf16 v[244:247], a[172:175], a[196:199], v[244:247]
    s_add_u32 m0, s29, 73728
    ds_read_b64_tr_b16 a[166:167], v43 offset:38528
    v_mfma_f32_16x16x32_bf16 v[252:255], a[172:175], a[200:203], v[252:255]
    buffer_store_dwordx4 a[124:127], v1, s[20:23], s33 offen sc1
    s_waitcnt lgkmcnt(8)
    v_mfma_f32_16x16x32_bf16 v[112:115], a[176:179], a[204:207], v[112:115]
    s_add_u32 s33, s32, 398336
    ds_read_b64_tr_b16 a[168:169], v46 offset:36992
    v_mfma_f32_16x16x32_bf16 v[120:123], a[176:179], a[208:211], v[120:123]
    ds_read_b64_tr_b16 a[170:171], v46 offset:38528
    v_mfma_f32_16x16x32_bf16 v[128:131], a[176:179], a[212:215], v[128:131]
    buffer_load_dwordx4 v17, s[16:19], s28 offen nt lds
    v_mfma_f32_16x16x32_bf16 v[116:119], a[180:183], a[204:207], v[116:119]
    ds_read_b64_tr_b16 a[172:173], v49 offset:36992
    v_mfma_f32_16x16x32_bf16 v[124:127], a[180:183], a[208:211], v[124:127]
    ds_read_b64_tr_b16 a[174:175], v49 offset:38528
    v_mfma_f32_16x16x32_bf16 v[132:135], a[180:183], a[212:215], v[132:135]
    buffer_load_dwordx4 v18, s[16:19], s28 offen offset:1024 nt lds
    s_waitcnt lgkmcnt(8)
    v_mfma_f32_16x16x32_bf16 v[136:139], a[184:187], a[204:207], v[136:139]
    ds_read_b64_tr_b16 a[176:177], v40 offset:37120
    v_mfma_f32_16x16x32_bf16 v[144:147], a[184:187], a[208:211], v[144:147]
    ds_read_b64_tr_b16 a[178:179], v40 offset:38656
    v_mfma_f32_16x16x32_bf16 v[152:155], a[184:187], a[212:215], v[152:155]
    buffer_load_dwordx4 v19, s[16:19], s28 offen offset:2048 nt lds
    v_mfma_f32_16x16x32_bf16 v[140:143], a[188:191], a[204:207], v[140:143]
    ds_read_b64_tr_b16 a[180:181], v43 offset:37120
    v_mfma_f32_16x16x32_bf16 v[148:151], a[188:191], a[208:211], v[148:151]
    ds_read_b64_tr_b16 a[182:183], v43 offset:38656
    v_mfma_f32_16x16x32_bf16 v[156:159], a[188:191], a[212:215], v[156:159]
    s_add_u32 s28, s28, 12288
    s_waitcnt lgkmcnt(8)
    v_mfma_f32_16x16x32_bf16 v[160:163], a[160:163], a[204:207], v[160:163]
    ds_read_b64_tr_b16 a[184:185], v46 offset:37120
    v_mfma_f32_16x16x32_bf16 v[168:171], a[160:163], a[208:211], v[168:171]
    ds_read_b64_tr_b16 a[186:187], v46 offset:38656
    v_mfma_f32_16x16x32_bf16 v[176:179], a[160:163], a[212:215], v[176:179]
    buffer_store_dwordx4 a[128:131], v1, s[20:23], s33 offen sc1
    v_mfma_f32_16x16x32_bf16 v[164:167], a[164:167], a[204:207], v[164:167]
    ds_read_b64_tr_b16 a[188:189], v49 offset:37120
    v_mfma_f32_16x16x32_bf16 v[172:175], a[164:167], a[208:211], v[172:175]
    ds_read_b64_tr_b16 a[190:191], v49 offset:38656
    v_mov_b32 v62, 0x3dd53b94
    v_mfma_f32_16x16x32_bf16 v[180:183], a[164:167], a[212:215], v[180:183]
    s_waitcnt vmcnt(11)
    s_barrier
    s_waitcnt lgkmcnt(8)
    v_mfma_f32_16x16x32_bf16 v[184:187], a[168:171], a[204:207], v[184:187]
    ds_read_b64_tr_b16 a[160:161], v38 offset:24576
    v_mov_b32 v61, v62
    v_mfma_f32_16x16x32_bf16 v[192:195], a[168:171], a[208:211], v[192:195]
    ds_read_b64_tr_b16 a[162:163], v38 offset:26112
    v_mov_b32 v60, v62
    v_mfma_f32_16x16x32_bf16 v[200:203], a[168:171], a[212:215], v[200:203]
    s_add_u32 m0, s29, 86016
    ds_read_b128 a[192:195], v50 offset:0
    v_mfma_f32_16x16x32_bf16 v[188:191], a[172:175], a[204:207], v[188:191]
    ds_read_b64_tr_b16 a[164:165], v38 offset:36864
    v_mfma_f32_16x16x32_bf16 v[196:199], a[172:175], a[208:211], v[196:199]
    ds_read_b64_tr_b16 a[166:167], v38 offset:38400
    v_mfma_f32_16x16x32_bf16 v[204:207], a[172:175], a[212:215], v[204:207]
    ds_read_b128 a[196:199], v50 offset:2048
    s_waitcnt lgkmcnt(10)
    v_mfma_f32_16x16x32_bf16 v[208:211], a[176:179], a[204:207], v[208:211]
    ds_read_b64_tr_b16 a[168:169], v41 offset:24576
    v_mfma_f32_16x16x32_bf16 v[216:219], a[176:179], a[208:211], v[216:219]
    ds_read_b64_tr_b16 a[170:171], v41 offset:26112
    v_mfma_f32_16x16x32_bf16 v[224:227], a[176:179], a[212:215], v[224:227]
    ds_read_b128 a[200:203], v50 offset:4096
    v_mfma_f32_16x16x32_bf16 v[212:215], a[180:183], a[204:207], v[212:215]
    ds_read_b64_tr_b16 a[172:173], v41 offset:36864
    v_mfma_f32_16x16x32_bf16 v[220:223], a[180:183], a[208:211], v[220:223]
    ds_read_b64_tr_b16 a[174:175], v41 offset:38400
    v_mfma_f32_16x16x32_bf16 v[228:231], a[180:183], a[212:215], v[228:231]
    s_waitcnt lgkmcnt(14)
    ds_read_b128 a[216:219], v53 offset:0
    s_waitcnt lgkmcnt(12)
    v_mfma_f32_16x16x32_bf16 v[232:235], a[184:187], a[204:207], v[232:235]
    ds_read_b128 a[220:223], v53 offset:2048
    v_mfma_f32_16x16x32_bf16 v[240:243], a[184:187], a[208:211], v[240:243]
    ds_read_b128 a[224:227], v53 offset:4096
    v_mfma_f32_16x16x32_bf16 v[248:251], a[184:187], a[212:215], v[248:251]
    ds_read_b64_tr_b16 a[176:177], v44 offset:24576
    v_mfma_f32_16x16x32_bf16 v[236:239], a[188:191], a[204:207], v[236:239]
    s_waitcnt lgkmcnt(14)
    ds_read_b64_tr_b16 a[178:179], v44 offset:26112
    v_mfma_f32_16x16x32_bf16 v[244:247], a[188:191], a[208:211], v[244:247]
    s_waitcnt lgkmcnt(14)
    ds_read_b64_tr_b16 a[180:181], v44 offset:36864
    v_mfma_f32_16x16x32_bf16 v[252:255], a[188:191], a[212:215], v[252:255]
    s_waitcnt lgkmcnt(14)
    ds_read_b64_tr_b16 a[182:183], v44 offset:38400
    s_waitcnt lgkmcnt(4)
    v_mfma_f32_16x16x32_bf16 v[112:115], a[160:163], a[192:195], v[112:115]
    ds_read_b64_tr_b16 a[184:185], v47 offset:24576
    v_mfma_f32_16x16x32_bf16 v[120:123], a[160:163], a[196:199], v[120:123]
    ds_read_b64_tr_b16 a[186:187], v47 offset:26112
    v_mfma_f32_16x16x32_bf16 v[128:131], a[160:163], a[200:203], v[128:131]
    s_add_u32 s32, s32, 6144
    s_mov_b32 s22, 37748736
    v_mfma_f32_16x16x32_bf16 v[112:115], a[164:167], a[216:219], v[112:115]
    ds_read_b64_tr_b16 a[188:189], v47 offset:36864
    v_mfma_f32_16x16x32_bf16 v[120:123], a[164:167], a[220:223], v[120:123]
    ds_read_b64_tr_b16 a[190:191], v47 offset:38400
    v_mfma_f32_16x16x32_bf16 v[128:131], a[164:167], a[224:227], v[128:131]
    buffer_load_dwordx4 v14, s[12:15], s27 offen nt lds
    v_mfma_f32_16x16x32_bf16 v[116:119], a[168:171], a[192:195], v[116:119]
    ds_read_b64_tr_b16 a[160:161], v38 offset:24704
    v_mfma_f32_16x16x32_bf16 v[124:127], a[168:171], a[196:199], v[124:127]
    ds_read_b64_tr_b16 a[162:163], v38 offset:26240
    v_mfma_f32_16x16x32_bf16 v[132:135], a[168:171], a[200:203], v[132:135]
    buffer_load_dwordx4 v15, s[12:15], s27 offen offset:1024 nt lds
    v_mul_f32 v112, v62, v112
    v_mfma_f32_16x16x32_bf16 v[116:119], a[172:175], a[216:219], v[116:119]
    ds_read_b64_tr_b16 a[164:165], v38 offset:36992
    v_mul_f32 v113, v62, v113
    v_mfma_f32_16x16x32_bf16 v[124:127], a[172:175], a[220:223], v[124:127]
    ds_read_b64_tr_b16 a[166:167], v38 offset:38528
    v_mul_f32 v114, v62, v114
    v_mfma_f32_16x16x32_bf16 v[132:135], a[172:175], a[224:227], v[132:135]
    buffer_load_dwordx4 v16, s[12:15], s27 offen offset:2048 nt lds
    s_waitcnt lgkmcnt(8)
    v_mfma_f32_16x16x32_bf16 v[136:139], a[176:179], a[192:195], v[136:139]
    s_add_u32 s27, s27, 12288
    ds_read_b64_tr_b16 a[168:169], v41 offset:24704
    v_mfma_f32_16x16x32_bf16 v[144:147], a[176:179], a[196:199], v[144:147]
    s_add_u32 m0, s29, 98304
    ds_read_b64_tr_b16 a[170:171], v41 offset:26240
    v_mfma_f32_16x16x32_bf16 v[152:155], a[176:179], a[200:203], v[152:155]
    buffer_load_dwordx4 v17, s[16:19], s28 offen nt lds
    v_mul_f32 v115, v62, v115
    v_mfma_f32_16x16x32_bf16 v[136:139], a[180:183], a[216:219], v[136:139]
    ds_read_b64_tr_b16 a[172:173], v41 offset:36992
    v_mul_f32 v116, v62, v116
    v_mfma_f32_16x16x32_bf16 v[144:147], a[180:183], a[220:223], v[144:147]
    ds_read_b64_tr_b16 a[174:175], v41 offset:38528
    v_mul_f32 v117, v62, v117
    v_mfma_f32_16x16x32_bf16 v[152:155], a[180:183], a[224:227], v[152:155]
    buffer_load_dwordx4 v18, s[16:19], s28 offen offset:1024 nt lds
    s_waitcnt lgkmcnt(8)
    v_mfma_f32_16x16x32_bf16 v[140:143], a[184:187], a[192:195], v[140:143]
    ds_read_b64_tr_b16 a[176:177], v44 offset:24704
    v_mul_f32 v118, v62, v118
    v_mfma_f32_16x16x32_bf16 v[148:151], a[184:187], a[196:199], v[148:151]
    ds_read_b64_tr_b16 a[178:179], v44 offset:26240
    v_mul_f32 v119, v62, v119
    v_mfma_f32_16x16x32_bf16 v[156:159], a[184:187], a[200:203], v[156:159]
    buffer_load_dwordx4 v19, s[16:19], s28 offen offset:2048 nt lds
    s_add_u32 s28, s28, 12288
    v_mfma_f32_16x16x32_bf16 v[140:143], a[188:191], a[216:219], v[140:143]
    s_add_u32 m0, s29, 110592
    ds_read_b64_tr_b16 a[180:181], v44 offset:36992
    v_mfma_f32_16x16x32_bf16 v[148:151], a[188:191], a[220:223], v[148:151]
    ds_read_b64_tr_b16 a[182:183], v44 offset:38528
    v_cvt_pk_bf16_f32 v112, v112, v113
    v_mfma_f32_16x16x32_bf16 v[156:159], a[188:191], a[224:227], v[156:159]
    buffer_load_dwordx4 v14, s[12:15], s27 offen nt lds
    s_waitcnt lgkmcnt(8)
    v_mfma_f32_16x16x32_bf16 v[160:163], a[160:163], a[192:195], v[160:163]
    ds_read_b64_tr_b16 a[184:185], v47 offset:24704
    v_cvt_pk_bf16_f32 v113, v114, v115
    v_mfma_f32_16x16x32_bf16 v[168:171], a[160:163], a[196:199], v[168:171]
    ds_read_b64_tr_b16 a[186:187], v47 offset:26240
    v_cvt_pk_bf16_f32 v114, v116, v117
    v_mfma_f32_16x16x32_bf16 v[176:179], a[160:163], a[200:203], v[176:179]
    buffer_load_dwordx4 v15, s[12:15], s27 offen offset:1024 nt lds
    v_cvt_pk_bf16_f32 v115, v118, v119
    v_mfma_f32_16x16x32_bf16 v[160:163], a[164:167], a[216:219], v[160:163]
    ds_read_b64_tr_b16 a[188:189], v47 offset:36992
    v_mul_f32 v120, v62, v120
    v_mfma_f32_16x16x32_bf16 v[168:171], a[164:167], a[220:223], v[168:171]
    ds_read_b64_tr_b16 a[190:191], v47 offset:38528
    v_mul_f32 v121, v62, v121
    v_mfma_f32_16x16x32_bf16 v[176:179], a[164:167], a[224:227], v[176:179]
    buffer_load_dwordx4 v16, s[12:15], s27 offen offset:2048 nt lds
    s_waitcnt lgkmcnt(8)
    v_mfma_f32_16x16x32_bf16 v[164:167], a[168:171], a[192:195], v[164:167]
    s_add_u32 s27, s27, 12288
    ds_read_b64_tr_b16 a[160:161], v38 offset:24832
    v_mfma_f32_16x16x32_bf16 v[172:175], a[168:171], a[196:199], v[172:175]
    ds_read_b64_tr_b16 a[162:163], v38 offset:26368
    v_mul_f32 v122, v62, v122
    v_mfma_f32_16x16x32_bf16 v[180:183], a[168:171], a[200:203], v[180:183]
    v_mul_f32 v123, v62, v123
    v_mfma_f32_16x16x32_bf16 v[164:167], a[172:175], a[216:219], v[164:167]
    s_add_u32 m0, s29, 122880
    ds_read_b64_tr_b16 a[164:165], v38 offset:37120
    v_mfma_f32_16x16x32_bf16 v[172:175], a[172:175], a[220:223], v[172:175]
    ds_read_b64_tr_b16 a[166:167], v38 offset:38656
    v_mul_f32 v124, v62, v124
    v_mfma_f32_16x16x32_bf16 v[180:183], a[172:175], a[224:227], v[180:183]
    v_mul_f32 v125, v62, v125
    s_waitcnt lgkmcnt(8)
    v_mfma_f32_16x16x32_bf16 v[184:187], a[176:179], a[192:195], v[184:187]
    ds_read_b64_tr_b16 a[168:169], v41 offset:24832
    v_mul_f32 v126, v62, v126
    v_mfma_f32_16x16x32_bf16 v[192:195], a[176:179], a[196:199], v[192:195]
    ds_read_b64_tr_b16 a[170:171], v41 offset:26368
    v_mul_f32 v127, v62, v127
    v_mfma_f32_16x16x32_bf16 v[200:203], a[176:179], a[200:203], v[200:203]
    buffer_load_dwordx4 v17, s[16:19], s28 offen nt lds
    v_cvt_pk_bf16_f32 v120, v120, v121
    v_mfma_f32_16x16x32_bf16 v[184:187], a[180:183], a[216:219], v[184:187]
    ds_read_b64_tr_b16 a[172:173], v41 offset:37120
    v_cvt_pk_bf16_f32 v121, v122, v123
    v_mfma_f32_16x16x32_bf16 v[192:195], a[180:183], a[220:223], v[192:195]
    ds_read_b64_tr_b16 a[174:175], v41 offset:38656
    v_cvt_pk_bf16_f32 v122, v124, v125
    v_mfma_f32_16x16x32_bf16 v[200:203], a[180:183], a[224:227], v[200:203]
    buffer_load_dwordx4 v18, s[16:19], s28 offen offset:1024 nt lds
    s_waitcnt lgkmcnt(8)
    v_mfma_f32_16x16x32_bf16 v[188:191], a[184:187], a[192:195], v[188:191]
    ds_read_b64_tr_b16 a[176:177], v44 offset:24832
    v_cvt_pk_bf16_f32 v123, v126, v127
    v_mfma_f32_16x16x32_bf16 v[196:199], a[184:187], a[196:199], v[196:199]
    ds_read_b64_tr_b16 a[178:179], v44 offset:26368
    v_mul_f32 v128, v62, v128
    v_mfma_f32_16x16x32_bf16 v[204:207], a[184:187], a[200:203], v[204:207]
    buffer_load_dwordx4 v19, s[16:19], s28 offen offset:2048 nt lds
    v_mul_f32 v129, v62, v129
    v_mfma_f32_16x16x32_bf16 v[188:191], a[188:191], a[216:219], v[188:191]
    ds_read_b64_tr_b16 a[180:181], v44 offset:37120
    v_mul_f32 v130, v62, v130
    v_mfma_f32_16x16x32_bf16 v[196:199], a[188:191], a[220:223], v[196:199]
    ds_read_b64_tr_b16 a[182:183], v44 offset:38656
    v_mul_f32 v131, v62, v131
    v_mfma_f32_16x16x32_bf16 v[204:207], a[188:191], a[224:227], v[204:207]
    s_add_u32 s28, s28, 12288
    v_mul_f32 v132, v62, v132
    s_waitcnt lgkmcnt(8)
    v_mfma_f32_16x16x32_bf16 v[208:211], a[160:163], a[192:195], v[208:211]
    ds_read_b64_tr_b16 a[184:185], v47 offset:24832
    v_mul_f32 v133, v62, v133
    v_mfma_f32_16x16x32_bf16 v[216:219], a[160:163], a[196:199], v[216:219]
    ds_read_b64_tr_b16 a[186:187], v47 offset:26368
    v_mul_f32 v134, v62, v134
    v_mfma_f32_16x16x32_bf16 v[224:227], a[160:163], a[200:203], v[224:227]
    v_mul_f32 v135, v62, v135
    v_mfma_f32_16x16x32_bf16 v[208:211], a[164:167], a[216:219], v[208:211]
    ds_read_b64_tr_b16 a[188:189], v47 offset:37120
    v_cvt_pk_bf16_f32 v128, v128, v129
    v_mfma_f32_16x16x32_bf16 v[216:219], a[164:167], a[220:223], v[216:219]
    ds_read_b64_tr_b16 a[190:191], v47 offset:38656
    v_cvt_pk_bf16_f32 v129, v130, v131
    v_mfma_f32_16x16x32_bf16 v[224:227], a[164:167], a[224:227], v[224:227]
    s_waitcnt vmcnt(12)
    s_waitcnt vmcnt(12)
    s_barrier
    s_cmp_eq_u32 s30, 1
    s_cbranch_scc1 L_ool6
L_ool6_r:
    s_waitcnt lgkmcnt(8)
    v_mfma_f32_16x16x32_bf16 v[212:215], a[168:171], a[192:195], v[212:215]
    ds_read_b128 a[160:163], v21 offset:0
    v_cvt_pk_bf16_f32 v130, v132, v133
    v_mfma_f32_16x16x32_bf16 v[220:223], a[168:171], a[196:199], v[220:223]
    s_add_u32 m0, s29, 135168
    v_cvt_pk_bf16_f32 v131, v134, v135
    v_mfma_f32_16x16x32_bf16 v[228:231], a[168:171], a[200:203], v[228:231]
    buffer_load_dwordx4 v14, s[12:15], s27 offen nt lds
    v_mul_f32 v136, v62, v136
    v_mfma_f32_16x16x32_bf16 v[212:215], a[172:175], a[216:219], v[212:215]
    ds_read_b128 a[164:167], v24 offset:0
    v_mul_f32 v137, v62, v137
    v_mfma_f32_16x16x32_bf16 v[220:223], a[172:175], a[220:223], v[220:223]
    buffer_load_dwordx4 v15, s[12:15], s27 offen offset:1024 nt lds
    v_mul_f32 v138, v62, v138
    v_mfma_f32_16x16x32_bf16 v[228:231], a[172:175], a[224:227], v[228:231]
    v_mul_f32 v139, v62, v139
    s_waitcnt lgkmcnt(6)
    v_mfma_f32_16x16x32_bf16 v[232:235], a[176:179], a[192:195], v[232:235]
    ds_read_b128 a[168:171], v21 offset:128
    v_mul_f32 v140, v62, v140
    v_mfma_f32_16x16x32_bf16 v[240:243], a[176:179], a[196:199], v[240:243]
    buffer_load_dwordx4 v16, s[12:15], s27 offen offset:2048 nt lds
    v_mul_f32 v141, v62, v141
    v_mfma_f32_16x16x32_bf16 v[248:251], a[176:179], a[200:203], v[248:251]
    s_add_u32 s27, s27, 12288
    v_mul_f32 v142, v62, v142
    v_mfma_f32_16x16x32_bf16 v[232:235], a[180:183], a[216:219], v[232:235]
    ds_read_b128 a[172:175], v24 offset:128
    v_mul_f32 v143, v62, v143
    v_mfma_f32_16x16x32_bf16 v[240:243], a[180:183], a[220:223], v[240:243]
    s_add_u32 m0, s29, 0
    v_cvt_pk_bf16_f32 v136, v136, v137
    v_mfma_f32_16x16x32_bf16 v[248:251], a[180:183], a[224:227], v[248:251]
    v_cvt_pk_bf16_f32 v137, v138, v139
    s_waitcnt lgkmcnt(4)
    v_mfma_f32_16x16x32_bf16 v[236:239], a[184:187], a[192:195], v[236:239]
    ds_read_b128 a[176:179], v21 offset:256
    v_cvt_pk_bf16_f32 v138, v140, v141
    v_mfma_f32_16x16x32_bf16 v[244:247], a[184:187], a[196:199], v[244:247]
    buffer_load_dwordx4 v17, s[16:19], s28 offen nt lds
    v_cvt_pk_bf16_f32 v139, v142, v143
    v_mfma_f32_16x16x32_bf16 v[252:255], a[184:187], a[200:203], v[252:255]
    buffer_load_dwordx4 v18, s[16:19], s28 offen offset:1024 nt lds
    v_mul_f32 v144, v62, v144
    v_mfma_f32_16x16x32_bf16 v[236:239], a[188:191], a[216:219], v[236:239]
    ds_read_b128 a[180:183], v24 offset:256
    v_mul_f32 v145, v62, v145
    v_mfma_f32_16x16x32_bf16 v[244:247], a[188:191], a[220:223], v[244:247]
    v_mul_f32 v146, v62, v146
    v_mul_f32 v147, v62, v147
    v_mul_f32 v148, v62, v148
    v_mul_f32 v149, v62, v149
    v_mul_f32 v150, v62, v150
    v_mul_f32 v151, v62, v151
    v_cvt_pk_bf16_f32 v144, v144, v145
    v_cvt_pk_bf16_f32 v145, v146, v147
    v_cvt_pk_bf16_f32 v146, v148, v149
    v_cvt_pk_bf16_f32 v147, v150, v151
    v_mul_f32 v152, v62, v152
    v_mul_f32 v153, v62, v153
    v_mul_f32 v154, v62, v154
    v_mul_f32 v155, v62, v155
    v_mul_f32 v156, v62, v156
    v_mul_f32 v157, v62, v157
    v_mul_f32 v158, v62, v158
    v_mul_f32 v159, v62, v159
    v_cvt_pk_bf16_f32 v152, v152, v153
    v_cvt_pk_bf16_f32 v153, v154, v155
    v_cvt_pk_bf16_f32 v154, v156, v157
    v_cvt_pk_bf16_f32 v155, v158, v159
    v_mfma_f32_16x16x32_bf16 v[252:255], a[188:191], a[224:227], v[252:255]
    v_pk_mul_f32 v[160:161], v[160:161], v[60:61]
    v_pk_mul_f32 v[162:163], v[162:163], v[60:61]
    v_pk_mul_f32 v[164:165], v[164:165], v[60:61]
    v_pk_mul_f32 v[166:167], v[166:167], v[60:61]
    v_pk_mul_f32 v[168:169], v[168:169], v[60:61]
    v_pk_mul_f32 v[170:171], v[170:171], v[60:61]
    v_pk_mul_f32 v[172:173], v[172:173], v[60:61]
    v_pk_mul_f32 v[174:175], v[174:175], v[60:61]
    v_pk_mul_f32 v[176:177], v[176:177], v[60:61]
    v_pk_mul_f32 v[178:179], v[178:179], v[60:61]
    v_pk_mul_f32 v[180:181], v[180:181], v[60:61]
    v_pk_mul_f32 v[182:183], v[182:183], v[60:61]
    v_pk_mul_f32 v[184:185], v[184:185], v[60:61]
    v_pk_mul_f32 v[186:187], v[186:187], v[60:61]
    v_pk_mul_f32 v[188:189], v[188:189], v[60:61]
    v_pk_mul_f32 v[190:191], v[190:191], v[60:61]
    v_pk_mul_f32 v[192:193], v[192:193], v[60:61]
    v_pk_mul_f32 v[194:195], v[194:195], v[60:61]
    v_pk_mul_f32 v[196:197], v[196:197], v[60:61]
    v_pk_mul_f32 v[198:199], v[198:199], v[60:61]
    v_pk_mul_f32 v[200:201], v[200:201], v[60:61]
    v_pk_mul_f32 v[202:203], v[202:203], v[60:61]
    v_pk_mul_f32 v[204:205], v[204:205], v[60:61]
    v_pk_mul_f32 v[206:207], v[206:207], v[60:61]
    v_pk_mul_f32 v[208:209], v[208:209], v[60:61]
    v_pk_mul_f32 v[210:211], v[210:211], v[60:61]
    v_pk_mul_f32 v[212:213], v[212:213], v[60:61]
    v_pk_mul_f32 v[214:215], v[214:215], v[60:61]
    v_pk_mul_f32 v[216:217], v[216:217], v[60:61]
    v_pk_mul_f32 v[218:219], v[218:219], v[60:61]
    v_pk_mul_f32 v[220:221], v[220:221], v[60:61]
    v_pk_mul_f32 v[222:223], v[222:223], v[60:61]
    v_pk_mul_f32 v[224:225], v[224:225], v[60:61]
    v_pk_mul_f32 v[226:227], v[226:227], v[60:61]
    v_pk_mul_f32 v[228:229], v[228:229], v[60:61]
    v_pk_mul_f32 v[230:231], v[230:231], v[60:61]
    v_pk_mul_f32 v[232:233], v[232:233], v[60:61]
    v_pk_mul_f32 v[234:235], v[234:235], v[60:61]
    v_pk_mul_f32 v[236:237], v[236:237], v[60:61]
    v_pk_mul_f32 v[238:239], v[238:239], v[60:61]
    v_pk_mul_f32 v[240:241], v[240:241], v[60:61]
    v_pk_mul_f32 v[242:243], v[242:243], v[60:61]
    v_pk_mul_f32 v[244:245], v[244:245], v[60:61]
    v_pk_mul_f32 v[246:247], v[246:247], v[60:61]
    v_pk_mul_f32 v[248:249], v[248:249], v[60:61]
    v_pk_mul_f32 v[250:251], v[250:251], v[60:61]
    v_pk_mul_f32 v[252:253], v[252:253], v[60:61]
    v_pk_mul_f32 v[254:255], v[254:255], v[60:61]
    v_cvt_pk_bf16_f32 v160, v160, v161
    v_cvt_pk_bf16_f32 v161, v162, v163
    v_cvt_pk_bf16_f32 v162, v164, v165
    v_cvt_pk_bf16_f32 v163, v166, v167
    v_cvt_pk_bf16_f32 v168, v168, v169
    v_cvt_pk_bf16_f32 v169, v170, v171
    v_cvt_pk_bf16_f32 v170, v172, v173
    v_cvt_pk_bf16_f32 v171, v174, v175
    v_cvt_pk_bf16_f32 v176, v176, v177
    v_cvt_pk_bf16_f32 v177, v178, v179
    v_cvt_pk_bf16_f32 v178, v180, v181
    v_cvt_pk_bf16_f32 v179, v182, v183
    v_cvt_pk_bf16_f32 v184, v184, v185
    v_cvt_pk_bf16_f32 v185, v186, v187
    v_cvt_pk_bf16_f32 v186, v188, v189
    v_cvt_pk_bf16_f32 v187, v190, v191
    v_cvt_pk_bf16_f32 v192, v192, v193
    v_cvt_pk_bf16_f32 v193, v194, v195
    v_cvt_pk_bf16_f32 v194, v196, v197
    v_cvt_pk_bf16_f32 v195, v198, v199
    v_cvt_pk_bf16_f32 v200, v200, v201
    v_cvt_pk_bf16_f32 v201, v202, v203
    v_cvt_pk_bf16_f32 v202, v204, v205
    v_cvt_pk_bf16_f32 v203, v206, v207
    v_cvt_pk_bf16_f32 v208, v208, v209
    v_cvt_pk_bf16_f32 v209, v210, v211
    v_cvt_pk_bf16_f32 v210, v212, v213
    v_cvt_pk_bf16_f32 v211, v214, v215
    v_cvt_pk_bf16_f32 v216, v216, v217
    v_cvt_pk_bf16_f32 v217, v218, v219
    v_cvt_pk_bf16_f32 v218, v220, v221
    v_cvt_pk_bf16_f32 v219, v222, v223
    v_cvt_pk_bf16_f32 v224, v224, v225
    v_cvt_pk_bf16_f32 v225, v226, v227
    v_cvt_pk_bf16_f32 v226, v228, v229
    v_cvt_pk_bf16_f32 v227, v230, v231
    v_cvt_pk_bf16_f32 v232, v232, v233
    v_cvt_pk_bf16_f32 v233, v234, v235
    v_cvt_pk_bf16_f32 v234, v236, v237
    v_cvt_pk_bf16_f32 v235, v238, v239
    v_cvt_pk_bf16_f32 v240, v240, v241
    v_cvt_pk_bf16_f32 v241, v242, v243
    v_cvt_pk_bf16_f32 v242, v244, v245
    v_cvt_pk_bf16_f32 v243, v246, v247
    v_cvt_pk_bf16_f32 v248, v248, v249
    v_cvt_pk_bf16_f32 v249, v250, v251
    v_cvt_pk_bf16_f32 v250, v252, v253
    v_cvt_pk_bf16_f32 v251, v254, v255
    v_permlane16_swap_b32 v112, v114
    v_permlane16_swap_b32 v113, v115
    v_permlane16_swap_b32 v120, v122
    v_permlane16_swap_b32 v121, v123
    v_permlane16_swap_b32 v128, v130
    v_permlane16_swap_b32 v129, v131
    v_permlane16_swap_b32 v136, v138
    v_permlane16_swap_b32 v137, v139
    v_permlane16_swap_b32 v144, v146
    v_permlane16_swap_b32 v145, v147
    v_permlane16_swap_b32 v152, v154
    v_permlane16_swap_b32 v153, v155
    v_permlane16_swap_b32 v160, v162
    v_permlane16_swap_b32 v161, v163
    v_permlane16_swap_b32 v168, v170
    v_permlane16_swap_b32 v169, v171
    v_permlane16_swap_b32 v176, v178
    v_permlane16_swap_b32 v177, v179
    v_permlane16_swap_b32 v184, v186
    v_permlane16_swap_b32 v185, v187
    v_permlane16_swap_b32 v192, v194
    v_permlane16_swap_b32 v193, v195
    v_permlane16_swap_b32 v200, v202
    v_permlane16_swap_b32 v201, v203
    v_permlane16_swap_b32 v208, v210
    v_permlane16_swap_b32 v209, v211
    v_permlane16_swap_b32 v216, v218
    v_permlane16_swap_b32 v217, v219
    v_permlane16_swap_b32 v224, v226
    v_permlane16_swap_b32 v225, v227
    v_permlane16_swap_b32 v232, v234
    v_permlane16_swap_b32 v233, v235
    v_permlane16_swap_b32 v240, v242
    v_permlane16_swap_b32 v241, v243
    v_permlane16_swap_b32 v248, v250
    v_permlane16_swap_b32 v249, v251
    s_waitcnt lgkmcnt(4)
    v_mfma_f32_16x16x32_bf16 v[64:67], a[160:163], v[112:115], 0
    ds_read_b128 a[184:187], v21 offset:6144
    v_mfma_f32_16x16x32_bf16 v[68:71], a[160:163], v[120:123], 0
    buffer_load_dwordx4 v19, s[16:19], s28 offen offset:2048 nt lds
    s_add_u32 s28, s28, 12288
    v_mfma_f32_16x16x32_bf16 v[72:75], a[160:163], v[128:131], 0
    v_mfma_f32_16x16x32_bf16 v[64:67], a[164:167], v[136:139], v[64:67]
    s_add_u32 m0, s29, 12288
    ds_read_b128 a[188:191], v24 offset:6144
    v_mfma_f32_16x16x32_bf16 v[68:71], a[164:167], v[144:147], v[68:71]
    v_mfma_f32_16x16x32_bf16 v[72:75], a[164:167], v[152:155], v[72:75]
    buffer_load_dwordx4 v14, s[12:15], s27 offen nt lds
    s_waitcnt lgkmcnt(4)
    v_mfma_f32_16x16x32_bf16 v[64:67], a[168:171], v[160:163], v[64:67]
    ds_read_b128 a[160:163], v21 offset:6272
    v_mfma_f32_16x16x32_bf16 v[68:71], a[168:171], v[168:171], v[68:71]
    v_mfma_f32_16x16x32_bf16 v[72:75], a[168:171], v[176:179], v[72:75]
    buffer_load_dwordx4 v15, s[12:15], s27 offen offset:1024 nt lds
    v_mfma_f32_16x16x32_bf16 v[64:67], a[172:175], v[184:187], v[64:67]
    ds_read_b128 a[164:167], v24 offset:6272
    v_mfma_f32_16x16x32_bf16 v[68:71], a[172:175], v[192:195], v[68:71]
    buffer_load_dwordx4 v16, s[12:15], s27 offen offset:2048 nt lds
    v_mfma_f32_16x16x32_bf16 v[72:75], a[172:175], v[200:203], v[72:75]
    s_waitcnt lgkmcnt(4)
    v_mfma_f32_16x16x32_bf16 v[64:67], a[176:179], v[208:211], v[64:67]
    s_add_u32 s27, s27, 12288
    ds_read_b128 a[168:171], v21 offset:6400
    v_mfma_f32_16x16x32_bf16 v[68:71], a[176:179], v[216:219], v[68:71]
    v_mfma_f32_16x16x32_bf16 v[72:75], a[176:179], v[224:227], v[72:75]
    v_mfma_f32_16x16x32_bf16 v[64:67], a[180:183], v[232:235], v[64:67]
    ds_read_b128 a[172:175], v24 offset:6400
    v_mfma_f32_16x16x32_bf16 v[68:71], a[180:183], v[240:243], v[68:71]
    v_mfma_f32_16x16x32_bf16 v[72:75], a[180:183], v[248:251], v[72:75]
    s_waitcnt vmcnt(21)
    s_barrier
    s_waitcnt lgkmcnt(4)
    v_mfma_f32_16x16x32_bf16 v[76:79], a[184:187], v[112:115], 0
    s_add_u32 m0, s29, 24576
    ds_read_b128 a[176:179], v21 offset:12288
    v_mfma_f32_16x16x32_bf16 v[80:83], a[184:187], v[120:123], 0
    v_mfma_f32_16x16x32_bf16 v[84:87], a[184:187], v[128:131], 0
    v_mfma_f32_16x16x32_bf16 v[76:79], a[188:191], v[136:139], v[76:79]
    ds_read_b128 a[180:183], v24 offset:12288
    v_max3_f32 v96, v64, v65, v66
    v_mfma_f32_16x16x32_bf16 v[80:83], a[188:191], v[144:147], v[80:83]
    v_max3_f32 v97, v68, v69, v70
    v_mfma_f32_16x16x32_bf16 v[84:87], a[188:191], v[152:155], v[84:87]
    v_max3_f32 v98, v72, v73, v74
    s_waitcnt lgkmcnt(4)
    v_mfma_f32_16x16x32_bf16 v[76:79], a[160:163], v[160:163], v[76:79]
    ds_read_b128 a[184:187], v21 offset:12416
    v_max_f32 v96, v96, v67
    v_mfma_f32_16x16x32_bf16 v[80:83], a[160:163], v[168:171], v[80:83]
    buffer_load_dwordx4 v17, s[16:19], s28 offen nt lds
    v_max_f32 v97, v97, v71
    v_mfma_f32_16x16x32_bf16 v[84:87], a[160:163], v[176:179], v[84:87]
    v_max_f32 v98, v98, v75
    v_mfma_f32_16x16x32_bf16 v[76:79], a[164:167], v[184:187], v[76:79]
    ds_read_b128 a[188:191], v24 offset:12416
    v_mov_b32 v100, v96
    v_mfma_f32_16x16x32_bf16 v[80:83], a[164:167], v[192:195], v[80:83]
    v_mov_b32 v101, v97
    v_mfma_f32_16x16x32_bf16 v[84:87], a[164:167], v[200:203], v[84:87]
    v_mov_b32 v102, v98
    s_waitcnt lgkmcnt(4)
    v_mfma_f32_16x16x32_bf16 v[76:79], a[168:171], v[208:211], v[76:79]
    ds_read_b128 a[160:163], v21 offset:12544
    v_mfma_f32_16x16x32_bf16 v[80:83], a[168:171], v[216:219], v[80:83]
    v_permlane16_swap_b32 v96, v100
    v_mfma_f32_16x16x32_bf16 v[84:87], a[168:171], v[224:227], v[84:87]
    v_permlane16_swap_b32 v97, v101
    v_mfma_f32_16x16x32_bf16 v[76:79], a[172:175], v[232:235], v[76:79]
    v_permlane16_swap_b32 v98, v102
    v_mfma_f32_16x16x32_bf16 v[80:83], a[172:175], v[240:243], v[80:83]
    ds_read_b128 a[164:167], v24 offset:12544
    v_max_f32 v96, v96, v100
    v_mfma_f32_16x16x32_bf16 v[84:87], a[172:175], v[248:251], v[84:87]
    v_max_f32 v97, v97, v101
    v_max_f32 v98, v98, v102
    v_mov_b32 v100, v96
    v_mov_b32 v101, v97
    v_mov_b32 v102, v98
    v_permlane32_swap_b32 v96, v100
    v_permlane32_swap_b32 v97, v101
    v_permlane32_swap_b32 v98, v102
    v_max_f32 v96, v96, v100
    v_max_f32 v97, v97, v101
    v_max_f32 v98, v98, v102
    v_sub_f32 v212, 0, v96
    v_sub_f32 v213, 0, v96
    v_sub_f32 v214, 0, v96
    v_sub_f32 v215, 0, v96
    v_sub_f32 v220, 0, v97
    v_sub_f32 v221, 0, v97
    v_sub_f32 v222, 0, v97
    v_sub_f32 v223, 0, v97
    v_sub_f32 v228, 0, v98
    v_sub_f32 v229, 0, v98
    v_sub_f32 v230, 0, v98
    v_sub_f32 v231, 0, v98
    s_waitcnt lgkmcnt(4)
    v_mfma_f32_16x16x32_bf16 v[116:119], a[176:179], v[112:115], v[212:215]
    ds_read_b128 a[168:171], v21 offset:18432
    v_add_f32 v64, v64, v212
    v_mfma_f32_16x16x32_bf16 v[124:127], a[176:179], v[120:123], v[220:223]
    buffer_load_dwordx4 v18, s[16:19], s28 offen offset:1024 nt lds
    v_add_f32 v65, v65, v213
    v_mfma_f32_16x16x32_bf16 v[132:135], a[176:179], v[128:131], v[228:231]
    buffer_load_dwordx4 v19, s[16:19], s28 offen offset:2048 nt lds
    v_add_f32 v66, v66, v214
    v_mfma_f32_16x16x32_bf16 v[116:119], a[180:183], v[136:139], v[116:119]
    ds_read_b128 a[172:175], v24 offset:18432
    v_add_f32 v67, v67, v215
    v_mfma_f32_16x16x32_bf16 v[124:127], a[180:183], v[144:147], v[124:127]
    v_add_f32 v76, v76, v212
    v_mfma_f32_16x16x32_bf16 v[132:135], a[180:183], v[152:155], v[132:135]
    v_add_f32 v77, v77, v213
    s_waitcnt lgkmcnt(4)
    v_mfma_f32_16x16x32_bf16 v[116:119], a[184:187], v[160:163], v[116:119]
    ds_read_b128 a[176:179], v21 offset:18560
    v_add_f32 v78, v78, v214
    v_mfma_f32_16x16x32_bf16 v[124:127], a[184:187], v[168:171], v[124:127]
    v_add_f32 v79, v79, v215
    v_mfma_f32_16x16x32_bf16 v[132:135], a[184:187], v[176:179], v[132:135]
    v_add_f32 v68, v68, v220
    v_mfma_f32_16x16x32_bf16 v[116:119], a[188:191], v[184:187], v[116:119]
    ds_read_b128 a[180:183], v24 offset:18560
    v_add_f32 v69, v69, v221
    v_mfma_f32_16x16x32_bf16 v[124:127], a[188:191], v[192:195], v[124:127]
    s_add_u32 s28, s28, 12288
    v_add_f32 v70, v70, v222
    v_mfma_f32_16x16x32_bf16 v[132:135], a[188:191], v[200:203], v[132:135]
    v_add_f32 v71, v71, v223
    s_waitcnt lgkmcnt(4)
    v_mfma_f32_16x16x32_bf16 v[116:119], a[160:163], v[208:211], v[116:119]
    ds_read_b128 a[184:187], v21 offset:18688
    v_add_f32 v80, v80, v220
    v_mfma_f32_16x16x32_bf16 v[124:127], a[160:163], v[216:219], v[124:127]
    v_add_f32 v81, v81, v221
    v_mfma_f32_16x16x32_bf16 v[132:135], a[160:163], v[224:227], v[132:135]
    v_add_f32 v82, v82, v222
    v_mfma_f32_16x16x32_bf16 v[116:119], a[164:167], v[232:235], v[116:119]
    ds_read_b128 a[188:191], v24 offset:18688
    v_add_f32 v83, v83, v223
    v_mfma_f32_16x16x32_bf16 v[124:127], a[164:167], v[240:243], v[124:127]
    v_add_f32 v72, v72, v228
    v_mfma_f32_16x16x32_bf16 v[132:135], a[164:167], v[248:251], v[132:135]
    s_add_u32 m0, s29, 36864
    v_add_f32 v73, v73, v229
    s_waitcnt lgkmcnt(4)
    v_mfma_f32_16x16x32_bf16 v[140:143], a[168:171], v[112:115], v[212:215]
    ds_read_b64_tr_b16 a[160:161], v27 offset:24576
    v_add_f32 v74, v74, v230
    v_mfma_f32_16x16x32_bf16 v[148:151], a[168:171], v[120:123], v[220:223]
    ds_read_b64_tr_b16 a[162:163], v27 offset:30720
    v_add_f32 v75, v75, v231
    v_mfma_f32_16x16x32_bf16 v[156:159], a[168:171], v[128:131], v[228:231]
    v_add_f32 v84, v84, v228
    v_mfma_f32_16x16x32_bf16 v[140:143], a[172:175], v[136:139], v[140:143]
    ds_read_b64_tr_b16 a[164:165], v30 offset:24576
    v_add_f32 v85, v85, v229
    v_mfma_f32_16x16x32_bf16 v[148:151], a[172:175], v[144:147], v[148:151]
    ds_read_b64_tr_b16 a[166:167], v30 offset:30720
    v_add_f32 v86, v86, v230
    v_mfma_f32_16x16x32_bf16 v[156:159], a[172:175], v[152:155], v[156:159]
    v_add_f32 v87, v87, v231
    s_waitcnt lgkmcnt(6)
    v_mfma_f32_16x16x32_bf16 v[140:143], a[176:179], v[160:163], v[140:143]
    ds_read_b64_tr_b16 a[168:169], v33 offset:24576
    v_mfma_f32_16x16x32_bf16 v[148:151], a[176:179], v[168:171], v[148:151]
    ds_read_b64_tr_b16 a[170:171], v33 offset:30720
    v_mfma_f32_16x16x32_bf16 v[156:159], a[176:179], v[176:179], v[156:159]
    v_exp_f32 v64, v64
    v_mfma_f32_16x16x32_bf16 v[140:143], a[180:183], v[184:187], v[140:143]
    ds_read_b64_tr_b16 a[172:173], v36 offset:24576
    v_mfma_f32_16x16x32_bf16 v[148:151], a[180:183], v[192:195], v[148:151]
    ds_read_b64_tr_b16 a[174:175], v36 offset:30720
    v_mfma_f32_16x16x32_bf16 v[156:159], a[180:183], v[200:203], v[156:159]
    buffer_load_dwordx4 v14, s[12:15], s27 offen nt lds
    s_waitcnt lgkmcnt(8)
    v_mfma_f32_16x16x32_bf16 v[140:143], a[184:187], v[208:211], v[140:143]
    ds_read_b64_tr_b16 a[176:177], v27 offset:24704
    v_mfma_f32_16x16x32_bf16 v[148:151], a[184:187], v[216:219], v[148:151]
    ds_read_b64_tr_b16 a[178:179], v27 offset:30848
    v_mfma_f32_16x16x32_bf16 v[156:159], a[184:187], v[224:227], v[156:159]
    v_exp_f32 v65, v65
    v_mfma_f32_16x16x32_bf16 v[140:143], a[188:191], v[232:235], v[140:143]
    v_exp_f32 v66, v66
    v_mfma_f32_16x16x32_bf16 v[148:151], a[188:191], v[240:243], v[148:151]
    v_exp_f32 v67, v67
    v_exp_f32 v76, v76
    v_exp_f32 v77, v77
    v_exp_f32 v78, v78
    v_exp_f32 v79, v79
    v_exp_f32 v68, v68
    v_exp_f32 v69, v69
    v_exp_f32 v70, v70
    v_exp_f32 v71, v71
    v_exp_f32 v80, v80
    v_exp_f32 v81, v81
    v_exp_f32 v82, v82
    v_exp_f32 v83, v83
    v_exp_f32 v72, v72
    v_exp_f32 v73, v73
    v_exp_f32 v74, v74
    v_exp_f32 v75, v75
    v_exp_f32 v84, v84
    v_exp_f32 v85, v85
    v_exp_f32 v86, v86
    v_exp_f32 v87, v87
    v_mfma_f32_16x16x32_bf16 v[156:159], a[188:191], v[248:251], v[156:159]
    v_cvt_pk_bf16_f32 v164, v64, v65
    v_cvt_pk_bf16_f32 v165, v66, v67
    v_cvt_pk_bf16_f32 v166, v76, v77
    v_cvt_pk_bf16_f32 v167, v78, v79
    v_cvt_pk_bf16_f32 v172, v68, v69
    v_cvt_pk_bf16_f32 v173, v70, v71
    v_cvt_pk_bf16_f32 v174, v80, v81
    v_cvt_pk_bf16_f32 v175, v82, v83
    v_cvt_pk_bf16_f32 v180, v72, v73
    v_cvt_pk_bf16_f32 v181, v74, v75
    v_cvt_pk_bf16_f32 v182, v84, v85
    v_cvt_pk_bf16_f32 v183, v86, v87
    s_waitcnt lgkmcnt(6)
    v_mfma_f32_16x16x32_bf16 a[0:3], a[160:163], v[164:167], 0
    ds_read_b64_tr_b16 a[180:181], v30 offset:24704
    v_mfma_f32_16x16x32_bf16 a[4:7], a[160:163], v[172:175], 0
    ds_read_b64_tr_b16 a[182:183], v30 offset:30848
    v_mfma_f32_16x16x32_bf16 a[8:11], a[160:163], v[180:183], 0
    ds_read_b64_tr_b16 a[184:185], v33 offset:24704
    v_mfma_f32_16x16x32_bf16 a[12:15], a[164:167], v[164:167], 0
    ds_read_b64_tr_b16 a[186:187], v33 offset:30848
    v_mfma_f32_16x16x32_bf16 a[16:19], a[164:167], v[172:175], 0
    ds_read_b64_tr_b16 a[188:189], v36 offset:24704
    v_mfma_f32_16x16x32_bf16 a[20:23], a[164:167], v[180:183], 0
    ds_read_b64_tr_b16 a[190:191], v36 offset:30848
    s_waitcnt lgkmcnt(8)
    v_mfma_f32_16x16x32_bf16 a[24:27], a[168:171], v[164:167], 0
    ds_read_b64_tr_b16 a[160:161], v27 offset:24832
    v_mfma_f32_16x16x32_bf16 a[28:31], a[168:171], v[172:175], 0
    ds_read_b64_tr_b16 a[162:163], v27 offset:30976
    v_mfma_f32_16x16x32_bf16 a[32:35], a[168:171], v[180:183], 0
    buffer_load_dwordx4 v15, s[12:15], s27 offen offset:1024 nt lds
    v_mfma_f32_16x16x32_bf16 a[36:39], a[172:175], v[164:167], 0
    ds_read_b64_tr_b16 a[164:165], v30 offset:24832
    v_mfma_f32_16x16x32_bf16 a[40:43], a[172:175], v[172:175], 0
    ds_read_b64_tr_b16 a[166:167], v30 offset:30976
    v_mfma_f32_16x16x32_bf16 a[44:47], a[172:175], v[180:183], 0
    buffer_load_dwordx4 v16, s[12:15], s27 offen offset:2048 nt lds
    s_waitcnt lgkmcnt(8)
    v_mfma_f32_16x16x32_bf16 a[48:51], a[176:179], v[164:167], 0
    s_add_u32 s27, s27, 12288
    ds_read_b64_tr_b16 a[168:169], v33 offset:24832
    v_mfma_f32_16x16x32_bf16 a[52:55], a[176:179], v[172:175], 0
    ds_read_b64_tr_b16 a[170:171], v33 offset:30976
    v_mfma_f32_16x16x32_bf16 a[56:59], a[176:179], v[180:183], 0
    v_exp_f32 v116, v116
    v_mfma_f32_16x16x32_bf16 a[60:63], a[180:183], v[164:167], 0
    ds_read_b64_tr_b16 a[172:173], v36 offset:24832
    v_mfma_f32_16x16x32_bf16 a[64:67], a[180:183], v[172:175], 0
    ds_read_b64_tr_b16 a[174:175], v36 offset:30976
    v_mfma_f32_16x16x32_bf16 a[68:71], a[180:183], v[180:183], 0
    v_exp_f32 v117, v117
    v_mfma_f32_16x16x32_bf16 a[144:147], a[156:159], v[164:167], 0
    v_exp_f32 v118, v118
    v_mfma_f32_16x16x32_bf16 a[148:151], a[156:159], v[172:175], 0
    v_exp_f32 v119, v119
    v_mfma_f32_16x16x32_bf16 a[152:155], a[156:159], v[180:183], 0
    s_waitcnt vmcnt(21)
    s_barrier
    s_waitcnt lgkmcnt(8)
    v_mfma_f32_16x16x32_bf16 a[72:75], a[184:187], v[164:167], 0
    ds_read_b128 a[176:179], v21 offset:36864
    v_cvt_pk_bf16_f32 v188, v116, v117
    v_mfma_f32_16x16x32_bf16 a[76:79], a[184:187], v[172:175], 0
    s_add_u32 m0, s29, 49152
    v_exp_f32 v124, v124
    v_mfma_f32_16x16x32_bf16 a[80:83], a[184:187], v[180:183], 0
    v_exp_f32 v125, v125
    v_mfma_f32_16x16x32_bf16 a[84:87], a[188:191], v[164:167], 0
    ds_read_b128 a[180:183], v24 offset:36864
    v_cvt_pk_bf16_f32 v189, v118, v119
    v_mfma_f32_16x16x32_bf16 a[88:91], a[188:191], v[172:175], 0
    v_exp_f32 v126, v126
    v_mfma_f32_16x16x32_bf16 a[92:95], a[188:191], v[180:183], 0
    v_cvt_pk_bf16_f32 v196, v124, v125
    s_waitcnt lgkmcnt(6)
    v_mfma_f32_16x16x32_bf16 a[96:99], a[160:163], v[164:167], 0
    ds_read_b128 a[184:187], v21 offset:36992
    v_mfma_f32_16x16x32_bf16 a[100:103], a[160:163], v[172:175], 0
    v_exp_f32 v127, v127
    v_mfma_f32_16x16x32_bf16 a[104:107], a[160:163], v[180:183], 0
    v_exp_f32 v132, v132
    v_mfma_f32_16x16x32_bf16 a[108:111], a[164:167], v[164:167], 0
    ds_read_b128 a[188:191], v24 offset:36992
    v_cvt_pk_bf16_f32 v197, v126, v127
    v_mfma_f32_16x16x32_bf16 a[112:115], a[164:167], v[172:175], 0
    v_exp_f32 v133, v133
    v_mfma_f32_16x16x32_bf16 a[116:119], a[164:167], v[180:183], 0
    v_cvt_pk_bf16_f32 v204, v132, v133
    s_waitcnt lgkmcnt(4)
    v_mfma_f32_16x16x32_bf16 a[120:123], a[168:171], v[164:167], 0
    ds_read_b128 a[160:163], v21 offset:37120
    v_accvgpr_read_b32 v100, a242
    v_mfma_f32_16x16x32_bf16 a[124:127], a[168:171], v[172:175], 0
    v_exp_f32 v134, v134
    v_mfma_f32_16x16x32_bf16 a[128:131], a[168:171], v[180:183], 0
    v_exp_f32 v135, v135
    v_mfma_f32_16x16x32_bf16 a[132:135], a[172:175], v[164:167], 0
    ds_read_b128 a[164:167], v24 offset:37120
    v_cvt_pk_bf16_f32 v205, v134, v135
    v_mfma_f32_16x16x32_bf16 a[136:139], a[172:175], v[172:175], 0
    v_exp_f32 v140, v140
    v_mfma_f32_16x16x32_bf16 a[140:143], a[172:175], v[180:183], 0
    buffer_load_dwordx4 v17, s[16:19], s28 offen nt lds
    s_waitcnt lgkmcnt(4)
    v_mfma_f32_16x16x32_bf16 v[116:119], a[176:179], v[112:115], v[212:215]
    ds_read_b128 a[168:171], v21 offset:43008
    v_mfma_f32_16x16x32_bf16 v[124:127], a[176:179], v[120:123], v[220:223]
    v_exp_f32 v141, v141
    v_mfma_f32_16x16x32_bf16 v[132:135], a[176:179], v[128:131], v[228:231]
    v_exp_f32 v142, v142
    v_mfma_f32_16x16x32_bf16 v[116:119], a[180:183], v[136:139], v[116:119]
    ds_read_b128 a[172:175], v24 offset:43008
    v_cvt_pk_bf16_f32 v190, v140, v141
    v_mfma_f32_16x16x32_bf16 v[124:127], a[180:183], v[144:147], v[124:127]
    v_exp_f32 v143, v143
    v_mfma_f32_16x16x32_bf16 v[132:135], a[180:183], v[152:155], v[132:135]
    v_cvt_pk_bf16_f32 v191, v142, v143
    s_waitcnt lgkmcnt(4)
    v_mfma_f32_16x16x32_bf16 v[116:119], a[184:187], v[160:163], v[116:119]
    ds_read_b128 a[176:179], v21 offset:43136
    v_mfma_f32_16x16x32_bf16 v[124:127], a[184:187], v[168:171], v[124:127]
    v_exp_f32 v148, v148
    v_mfma_f32_16x16x32_bf16 v[132:135], a[184:187], v[176:179], v[132:135]
    v_exp_f32 v149, v149
    v_mfma_f32_16x16x32_bf16 v[116:119], a[188:191], v[184:187], v[116:119]
    ds_read_b128 a[180:183], v24 offset:43136
    v_cvt_pk_bf16_f32 v198, v148, v149
    v_mfma_f32_16x16x32_bf16 v[124:127], a[188:191], v[192:195], v[124:127]
    v_exp_f32 v150, v150
    v_mfma_f32_16x16x32_bf16 v[132:135], a[188:191], v[200:203], v[132:135]
    buffer_load_dwordx4 v18, s[16:19], s28 offen offset:1024 nt lds
    s_waitcnt lgkmcnt(4)
    v_mfma_f32_16x16x32_bf16 v[116:119], a[160:163], v[208:211], v[116:119]
    v_exp_f32 v151, v151
    v_mfma_f32_16x16x32_bf16 v[124:127], a[160:163], v[216:219], v[124:127]
    v_exp_f32 v156, v156
    v_mfma_f32_16x16x32_bf16 v[132:135], a[160:163], v[224:227], v[132:135]
    v_exp_f32 v157, v157
    v_exp_f32 v158, v158
    v_exp_f32 v159, v159
    v_mfma_f32_16x16x32_bf16 v[116:119], a[164:167], v[232:235], v[116:119]
    ds_read_b128 a[184:187], v21 offset:43264
    v_cvt_pk_bf16_f32 v199, v150, v151
    v_mfma_f32_16x16x32_bf16 v[124:127], a[164:167], v[240:243], v[124:127]
    v_cvt_pk_bf16_f32 v206, v156, v157
    v_cvt_pk_bf16_f32 v207, v158, v159
    v_mfma_f32_16x16x32_bf16 v[132:135], a[164:167], v[248:251], v[132:135]
    ds_read_b128 a[188:191], v24 offset:43264
    s_waitcnt lgkmcnt(4)
    v_mfma_f32_16x16x32_bf16 v[140:143], a[168:171], v[112:115], v[212:215]
    ds_read_b64_tr_b16 a[160:161], v28 offset:0
    v_mfma_f32_16x16x32_bf16 v[148:151], a[168:171], v[120:123], v[220:223]
    ds_read_b64_tr_b16 a[162:163], v28 offset:6144
    v_mfma_f32_16x16x32_bf16 v[156:159], a[168:171], v[128:131], v[228:231]
    s_add_u32 s34, s80, 0
    s_cmp_eq_u32 s31, 0
    s_cselect_b32 s34, s34, 0x7ff00000
    v_mfma_f32_16x16x32_bf16 v[140:143], a[172:175], v[136:139], v[140:143]
    ds_read_b64_tr_b16 a[164:165], v31 offset:0
    v_mfma_f32_16x16x32_bf16 v[148:151], a[172:175], v[144:147], v[148:151]
    ds_read_b64_tr_b16 a[166:167], v31 offset:6144
    v_mfma_f32_16x16x32_bf16 v[156:159], a[172:175], v[152:155], v[156:159]
    buffer_load_dword v103, v100, s[68:71], s34 offen
    s_waitcnt lgkmcnt(6)
    v_mfma_f32_16x16x32_bf16 v[140:143], a[176:179], v[160:163], v[140:143]
    ds_read_b64_tr_b16 a[168:169], v34 offset:0
    v_mfma_f32_16x16x32_bf16 v[148:151], a[176:179], v[168:171], v[148:151]
    ds_read_b64_tr_b16 a[170:171], v34 offset:6144
    v_mfma_f32_16x16x32_bf16 v[156:159], a[176:179], v[176:179], v[156:159]
    buffer_load_dwordx4 v19, s[16:19], s28 offen offset:2048 nt lds
    s_add_u32 s28, s28, 12288
    v_mfma_f32_16x16x32_bf16 v[140:143], a[180:183], v[184:187], v[140:143]
    s_add_u32 m0, s29, 61440
    ds_read_b64_tr_b16 a[172:173], v37 offset:0
    v_mfma_f32_16x16x32_bf16 v[148:151], a[180:183], v[192:195], v[148:151]
    ds_read_b64_tr_b16 a[174:175], v37 offset:6144
    v_mfma_f32_16x16x32_bf16 v[156:159], a[180:183], v[200:203], v[156:159]
    buffer_load_dwordx4 v14, s[12:15], s27 offen nt lds
    s_waitcnt lgkmcnt(8)
    v_mfma_f32_16x16x32_bf16 v[140:143], a[184:187], v[208:211], v[140:143]
    ds_read_b64_tr_b16 a[176:177], v28 offset:128
    v_mfma_f32_16x16x32_bf16 v[148:151], a[184:187], v[216:219], v[148:151]
    ds_read_b64_tr_b16 a[178:179], v28 offset:6272
    v_mfma_f32_16x16x32_bf16 v[156:159], a[184:187], v[224:227], v[156:159]
    buffer_load_dwordx4 v15, s[12:15], s27 offen offset:1024 nt lds
    v_mfma_f32_16x16x32_bf16 v[140:143], a[188:191], v[232:235], v[140:143]
    ds_read_b64_tr_b16 a[180:181], v31 offset:128
    v_mfma_f32_16x16x32_bf16 v[148:151], a[188:191], v[240:243], v[148:151]
    ds_read_b64_tr_b16 a[182:183], v31 offset:6272
    v_mfma_f32_16x16x32_bf16 v[156:159], a[188:191], v[248:251], v[156:159]
    s_waitcnt lgkmcnt(8)
    v_mfma_f32_16x16x32_bf16 a[0:3], a[160:163], v[188:191], a[0:3]
    ds_read_b64_tr_b16 a[184:185], v34 offset:128
    v_mfma_f32_16x16x32_bf16 a[4:7], a[160:163], v[196:199], a[4:7]
    ds_read_b64_tr_b16 a[186:187], v34 offset:6272
    v_mfma_f32_16x16x32_bf16 a[8:11], a[160:163], v[204:207], a[8:11]
    v_exp_f32 v116, v116
    v_mfma_f32_16x16x32_bf16 a[12:15], a[164:167], v[188:191], a[12:15]
    ds_read_b64_tr_b16 a[188:189], v37 offset:128
    v_mfma_f32_16x16x32_bf16 a[16:19], a[164:167], v[196:199], a[16:19]
    ds_read_b64_tr_b16 a[190:191], v37 offset:6272
    v_mfma_f32_16x16x32_bf16 a[20:23], a[164:167], v[204:207], a[20:23]
    buffer_load_dwordx4 v16, s[12:15], s27 offen offset:2048 nt lds
    s_waitcnt lgkmcnt(8)
    v_mfma_f32_16x16x32_bf16 a[24:27], a[168:171], v[188:191], a[24:27]
    ds_read_b64_tr_b16 a[160:161], v28 offset:256
    v_mfma_f32_16x16x32_bf16 a[28:31], a[168:171], v[196:199], a[28:31]
    ds_read_b64_tr_b16 a[162:163], v28 offset:6400
    v_mfma_f32_16x16x32_bf16 a[32:35], a[168:171], v[204:207], a[32:35]
    v_exp_f32 v117, v117
    v_mfma_f32_16x16x32_bf16 a[36:39], a[172:175], v[188:191], a[36:39]
    ds_read_b64_tr_b16 a[164:165], v31 offset:256
    v_cvt_pk_bf16_f32 v164, v116, v117
    v_mfma_f32_16x16x32_bf16 a[40:43], a[172:175], v[196:199], a[40:43]
    s_add_u32 s27, s27, 12288
    ds_read_b64_tr_b16 a[166:167], v31 offset:6400
    v_mfma_f32_16x16x32_bf16 a[44:47], a[172:175], v[204:207], a[44:47]
    s_waitcnt lgkmcnt(8)
    v_mfma_f32_16x16x32_bf16 a[48:51], a[176:179], v[188:191], a[48:51]
    ds_read_b64_tr_b16 a[168:169], v34 offset:256
    v_mfma_f32_16x16x32_bf16 a[52:55], a[176:179], v[196:199], a[52:55]
    ds_read_b64_tr_b16 a[170:171], v34 offset:6400
    v_mfma_f32_16x16x32_bf16 a[56:59], a[176:179], v[204:207], a[56:59]
    v_exp_f32 v118, v118
    v_mfma_f32_16x16x32_bf16 a[60:63], a[180:183], v[188:191], a[60:63]
    ds_read_b64_tr_b16 a[172:173], v37 offset:256
    v_mfma_f32_16x16x32_bf16 a[64:67], a[180:183], v[196:199], a[64:67]
    ds_read_b64_tr_b16 a[174:175], v37 offset:6400
    v_mfma_f32_16x16x32_bf16 a[68:71], a[180:183], v[204:207], a[68:71]
    v_exp_f32 v119, v119
    v_mfma_f32_16x16x32_bf16 a[144:147], a[156:159], v[188:191], a[144:147]
    v_exp_f32 v124, v124
    v_mfma_f32_16x16x32_bf16 a[148:151], a[156:159], v[196:199], a[148:151]
    v_exp_f32 v125, v125
    v_mfma_f32_16x16x32_bf16 a[152:155], a[156:159], v[204:207], a[152:155]
    s_waitcnt vmcnt(22)
    s_barrier
    s_waitcnt lgkmcnt(8)
    v_mfma_f32_16x16x32_bf16 a[72:75], a[184:187], v[188:191], a[72:75]
    ds_read_b128 a[176:179], v22 offset:12288
    v_cvt_pk_bf16_f32 v165, v118, v119
    v_mfma_f32_16x16x32_bf16 a[76:79], a[184:187], v[196:199], a[76:79]
    s_add_u32 m0, s29, 73728
    v_exp_f32 v126, v126
    v_mfma_f32_16x16x32_bf16 a[80:83], a[184:187], v[204:207], a[80:83]
    v_exp_f32 v127, v127
    v_mfma_f32_16x16x32_bf16 a[84:87], a[188:191], v[188:191], a[84:87]
    ds_read_b128 a[180:183], v25 offset:12288
    v_cvt_pk_bf16_f32 v172, v124, v125
    v_mfma_f32_16x16x32_bf16 a[88:91], a[188:191], v[196:199], a[88:91]
    v_exp_f32 v132, v132
    v_mfma_f32_16x16x32_bf16 a[92:95], a[188:191], v[204:207], a[92:95]
    v_cvt_pk_bf16_f32 v173, v126, v127
    s_waitcnt lgkmcnt(6)
    v_mfma_f32_16x16x32_bf16 a[96:99], a[160:163], v[188:191], a[96:99]
    ds_read_b128 a[184:187], v22 offset:12416
    v_mfma_f32_16x16x32_bf16 a[100:103], a[160:163], v[196:199], a[100:103]
    v_exp_f32 v133, v133
    v_mfma_f32_16x16x32_bf16 a[104:107], a[160:163], v[204:207], a[104:107]
    v_exp_f32 v134, v134
    v_mfma_f32_16x16x32_bf16 a[108:111], a[164:167], v[188:191], a[108:111]
    ds_read_b128 a[188:191], v25 offset:12416
    v_cvt_pk_bf16_f32 v180, v132, v133
    v_mfma_f32_16x16x32_bf16 a[112:115], a[164:167], v[196:199], a[112:115]
    v_exp_f32 v135, v135
    v_mfma_f32_16x16x32_bf16 a[116:119], a[164:167], v[204:207], a[116:119]
    v_cvt_pk_bf16_f32 v181, v134, v135
    s_waitcnt lgkmcnt(4)
    v_mfma_f32_16x16x32_bf16 a[120:123], a[168:171], v[188:191], a[120:123]
    ds_read_b128 a[160:163], v22 offset:12544
    v_mfma_f32_16x16x32_bf16 a[124:127], a[168:171], v[196:199], a[124:127]
    v_exp_f32 v140, v140
    v_mfma_f32_16x16x32_bf16 a[128:131], a[168:171], v[204:207], a[128:131]
    v_exp_f32 v141, v141
    v_mfma_f32_16x16x32_bf16 a[132:135], a[172:175], v[188:191], a[132:135]
    ds_read_b128 a[164:167], v25 offset:12544
    v_cvt_pk_bf16_f32 v166, v140, v141
    v_mfma_f32_16x16x32_bf16 a[136:139], a[172:175], v[196:199], a[136:139]
    v_exp_f32 v142, v142
    v_mfma_f32_16x16x32_bf16 a[140:143], a[172:175], v[204:207], a[140:143]
    buffer_load_dwordx4 v17, s[16:19], s28 offen nt lds
    s_waitcnt lgkmcnt(4)
    v_mfma_f32_16x16x32_bf16 v[116:119], a[176:179], v[112:115], v[212:215]
    ds_read_b128 a[168:171], v22 offset:18432
    v_mfma_f32_16x16x32_bf16 v[124:127], a[176:179], v[120:123], v[220:223]
    v_exp_f32 v143, v143
    v_mfma_f32_16x16x32_bf16 v[132:135], a[176:179], v[128:131], v[228:231]
    v_exp_f32 v148, v148
    v_mfma_f32_16x16x32_bf16 v[116:119], a[180:183], v[136:139], v[116:119]
    ds_read_b128 a[172:175], v25 offset:18432
    v_cvt_pk_bf16_f32 v167, v142, v143
    v_mfma_f32_16x16x32_bf16 v[124:127], a[180:183], v[144:147], v[124:127]
    v_exp_f32 v149, v149
    v_mfma_f32_16x16x32_bf16 v[132:135], a[180:183], v[152:155], v[132:135]
    v_cvt_pk_bf16_f32 v174, v148, v149
    s_waitcnt lgkmcnt(4)
    v_mfma_f32_16x16x32_bf16 v[116:119], a[184:187], v[160:163], v[116:119]
    ds_read_b128 a[176:179], v22 offset:18560
    v_mfma_f32_16x16x32_bf16 v[124:127], a[184:187], v[168:171], v[124:127]
    v_exp_f32 v150, v150
    v_mfma_f32_16x16x32_bf16 v[132:135], a[184:187], v[176:179], v[132:135]
    v_exp_f32 v151, v151
    v_mfma_f32_16x16x32_bf16 v[116:119], a[188:191], v[184:187], v[116:119]
    ds_read_b128 a[180:183], v25 offset:18560
    v_cvt_pk_bf16_f32 v175, v150, v151
    v_mfma_f32_16x16x32_bf16 v[124:127], a[188:191], v[192:195], v[124:127]
    v_exp_f32 v156, v156
    v_mfma_f32_16x16x32_bf16 v[132:135], a[188:191], v[200:203], v[132:135]
    buffer_load_dwordx4 v18, s[16:19], s28 offen offset:1024 nt lds
    s_waitcnt lgkmcnt(4)
    v_mfma_f32_16x16x32_bf16 v[116:119], a[160:163], v[208:211], v[116:119]
    v_exp_f32 v157, v157
    v_mfma_f32_16x16x32_bf16 v[124:127], a[160:163], v[216:219], v[124:127]
    v_exp_f32 v158, v158
    v_mfma_f32_16x16x32_bf16 v[132:135], a[160:163], v[224:227], v[132:135]
    v_exp_f32 v159, v159
    v_mfma_f32_16x16x32_bf16 v[116:119], a[164:167], v[232:235], v[116:119]
    ds_read_b128 a[184:187], v22 offset:18688
    v_cvt_pk_bf16_f32 v182, v156, v157
    v_mfma_f32_16x16x32_bf16 v[124:127], a[164:167], v[240:243], v[124:127]
    ds_read_b128 a[188:191], v25 offset:18688
    v_cvt_pk_bf16_f32 v183, v158, v159
    v_mfma_f32_16x16x32_bf16 v[132:135], a[164:167], v[248:251], v[132:135]
    buffer_load_dwordx4 v19, s[16:19], s28 offen offset:2048 nt lds
    s_waitcnt lgkmcnt(4)
    v_mfma_f32_16x16x32_bf16 v[140:143], a[168:171], v[112:115], v[212:215]
    s_add_u32 s28, s28, 12288
    ds_read_b64_tr_b16 a[160:161], v28 offset:24576
    v_mfma_f32_16x16x32_bf16 v[148:151], a[168:171], v[120:123], v[220:223]
    s_add_u32 m0, s29, 86016
    ds_read_b64_tr_b16 a[162:163], v28 offset:30720
    v_mfma_f32_16x16x32_bf16 v[156:159], a[168:171], v[128:131], v[228:231]
    s_add_u32 s34, s80, 26880
    s_cmp_eq_u32 s31, 1
    s_cselect_b32 s34, s34, 0x7ff00000
    v_mfma_f32_16x16x32_bf16 v[140:143], a[172:175], v[136:139], v[140:143]
    ds_read_b64_tr_b16 a[164:165], v31 offset:24576
    v_mfma_f32_16x16x32_bf16 v[148:151], a[172:175], v[144:147], v[148:151]
    ds_read_b64_tr_b16 a[166:167], v31 offset:30720
    v_mfma_f32_16x16x32_bf16 v[156:159], a[172:175], v[152:155], v[156:159]
    buffer_load_dword v103, v100, s[68:71], s34 offen
    s_waitcnt lgkmcnt(6)
    v_mfma_f32_16x16x32_bf16 v[140:143], a[176:179], v[160:163], v[140:143]
    ds_read_b64_tr_b16 a[168:169], v34 offset:24576
    v_mfma_f32_16x16x32_bf16 v[148:151], a[176:179], v[168:171], v[148:151]
    ds_read_b64_tr_b16 a[170:171], v34 offset:30720
    v_mfma_f32_16x16x32_bf16 v[156:159], a[176:179], v[176:179], v[156:159]
    buffer_load_dwordx4 v14, s[12:15], s27 offen nt lds
    v_mfma_f32_16x16x32_bf16 v[140:143], a[180:183], v[184:187], v[140:143]
    ds_read_b64_tr_b16 a[172:173], v37 offset:24576
    v_mfma_f32_16x16x32_bf16 v[148:151], a[180:183], v[192:195], v[148:151]
    ds_read_b64_tr_b16 a[174:175], v37 offset:30720
    v_mfma_f32_16x16x32_bf16 v[156:159], a[180:183], v[200:203], v[156:159]
    s_waitcnt lgkmcnt(8)
    v_mfma_f32_16x16x32_bf16 v[140:143], a[184:187], v[208:211], v[140:143]
    ds_read_b64_tr_b16 a[176:177], v28 offset:24704
    v_mfma_f32_16x16x32_bf16 v[148:151], a[184:187], v[216:219], v[148:151]
    ds_read_b64_tr_b16 a[178:179], v28 offset:30848
    v_mfma_f32_16x16x32_bf16 v[156:159], a[184:187], v[224:227], v[156:159]
    buffer_load_dwordx4 v15, s[12:15], s27 offen offset:1024 nt lds
    v_mfma_f32_16x16x32_bf16 v[140:143], a[188:191], v[232:235], v[140:143]
    ds_read_b64_tr_b16 a[180:181], v31 offset:24704
    v_mfma_f32_16x16x32_bf16 v[148:151], a[188:191], v[240:243], v[148:151]
    ds_read_b64_tr_b16 a[182:183], v31 offset:30848
    v_mfma_f32_16x16x32_bf16 v[156:159], a[188:191], v[248:251], v[156:159]
    s_waitcnt lgkmcnt(8)
    v_mfma_f32_16x16x32_bf16 a[0:3], a[160:163], v[164:167], a[0:3]
    ds_read_b64_tr_b16 a[184:185], v34 offset:24704
    v_mfma_f32_16x16x32_bf16 a[4:7], a[160:163], v[172:175], a[4:7]
    ds_read_b64_tr_b16 a[186:187], v34 offset:30848
    v_mfma_f32_16x16x32_bf16 a[8:11], a[160:163], v[180:183], a[8:11]
    v_exp_f32 v116, v116
    v_mfma_f32_16x16x32_bf16 a[12:15], a[164:167], v[164:167], a[12:15]
    ds_read_b64_tr_b16 a[188:189], v37 offset:24704
    v_mfma_f32_16x16x32_bf16 a[16:19], a[164:167], v[172:175], a[16:19]
    ds_read_b64_tr_b16 a[190:191], v37 offset:30848
    v_mfma_f32_16x16x32_bf16 a[20:23], a[164:167], v[180:183], a[20:23]
    buffer_load_dwordx4 v16, s[12:15], s27 offen offset:2048 nt lds
    s_waitcnt lgkmcnt(8)
    v_mfma_f32_16x16x32_bf16 a[24:27], a[168:171], v[164:167], a[24:27]
    ds_read_b64_tr_b16 a[160:161], v28 offset:24832
    v_mfma_f32_16x16x32_bf16 a[28:31], a[168:171], v[172:175], a[28:31]
    ds_read_b64_tr_b16 a[162:163], v28 offset:30976
    v_mfma_f32_16x16x32_bf16 a[32:35], a[168:171], v[180:183], a[32:35]
    v_exp_f32 v117, v117
    v_mfma_f32_16x16x32_bf16 a[36:39], a[172:175], v[164:167], a[36:39]
    ds_read_b64_tr_b16 a[164:165], v31 offset:24832
    v_cvt_pk_bf16_f32 v188, v116, v117
    v_mfma_f32_16x16x32_bf16 a[40:43], a[172:175], v[172:175], a[40:43]
    s_add_u32 s27, s27, 12288
    ds_read_b64_tr_b16 a[166:167], v31 offset:30976
    v_mfma_f32_16x16x32_bf16 a[44:47], a[172:175], v[180:183], a[44:47]
    s_waitcnt lgkmcnt(8)
    v_mfma_f32_16x16x32_bf16 a[48:51], a[176:179], v[164:167], a[48:51]
    ds_read_b64_tr_b16 a[168:169], v34 offset:24832
    v_mfma_f32_16x16x32_bf16 a[52:55], a[176:179], v[172:175], a[52:55]
    ds_read_b64_tr_b16 a[170:171], v34 offset:30976
    v_mfma_f32_16x16x32_bf16 a[56:59], a[176:179], v[180:183], a[56:59]
    v_exp_f32 v118, v118
    v_mfma_f32_16x16x32_bf16 a[60:63], a[180:183], v[164:167], a[60:63]
    ds_read_b64_tr_b16 a[172:173], v37 offset:24832
    v_mfma_f32_16x16x32_bf16 a[64:67], a[180:183], v[172:175], a[64:67]
    ds_read_b64_tr_b16 a[174:175], v37 offset:30976
    v_mfma_f32_16x16x32_bf16 a[68:71], a[180:183], v[180:183], a[68:71]
    v_exp_f32 v119, v119
    v_mfma_f32_16x16x32_bf16 a[144:147], a[156:159], v[164:167], a[144:147]
    v_exp_f32 v124, v124
    v_mfma_f32_16x16x32_bf16 a[148:151], a[156:159], v[172:175], a[148:151]
    v_exp_f32 v125, v125
    v_mfma_f32_16x16x32_bf16 a[152:155], a[156:159], v[180:183], a[152:155]
    s_waitcnt vmcnt(23)
    s_barrier
    s_waitcnt lgkmcnt(8)
    v_mfma_f32_16x16x32_bf16 a[72:75], a[184:187], v[164:167], a[72:75]
    ds_read_b128 a[176:179], v22 offset:36864
    v_cvt_pk_bf16_f32 v189, v118, v119
    v_mfma_f32_16x16x32_bf16 a[76:79], a[184:187], v[172:175], a[76:79]
    s_add_u32 m0, s29, 98304
    v_exp_f32 v126, v126
    v_mfma_f32_16x16x32_bf16 a[80:83], a[184:187], v[180:183], a[80:83]
    v_exp_f32 v127, v127
    v_mfma_f32_16x16x32_bf16 a[84:87], a[188:191], v[164:167], a[84:87]
    ds_read_b128 a[180:183], v25 offset:36864
    v_cvt_pk_bf16_f32 v196, v124, v125
    v_mfma_f32_16x16x32_bf16 a[88:91], a[188:191], v[172:175], a[88:91]
    v_exp_f32 v132, v132
    v_mfma_f32_16x16x32_bf16 a[92:95], a[188:191], v[180:183], a[92:95]
    v_cvt_pk_bf16_f32 v197, v126, v127
    s_waitcnt lgkmcnt(6)
    v_mfma_f32_16x16x32_bf16 a[96:99], a[160:163], v[164:167], a[96:99]
    ds_read_b128 a[184:187], v22 offset:36992
    v_mfma_f32_16x16x32_bf16 a[100:103], a[160:163], v[172:175], a[100:103]
    v_exp_f32 v133, v133
    v_mfma_f32_16x16x32_bf16 a[104:107], a[160:163], v[180:183], a[104:107]
    v_exp_f32 v134, v134
    v_mfma_f32_16x16x32_bf16 a[108:111], a[164:167], v[164:167], a[108:111]
    ds_read_b128 a[188:191], v25 offset:36992
    v_cvt_pk_bf16_f32 v204, v132, v133
    v_mfma_f32_16x16x32_bf16 a[112:115], a[164:167], v[172:175], a[112:115]
    v_exp_f32 v135, v135
    v_mfma_f32_16x16x32_bf16 a[116:119], a[164:167], v[180:183], a[116:119]
    v_cvt_pk_bf16_f32 v205, v134, v135
    s_waitcnt lgkmcnt(4)
    v_mfma_f32_16x16x32_bf16 a[120:123], a[168:171], v[164:167], a[120:123]
    ds_read_b128 a[160:163], v22 offset:37120
    v_mfma_f32_16x16x32_bf16 a[124:127], a[168:171], v[172:175], a[124:127]
    v_exp_f32 v140, v140
    v_mfma_f32_16x16x32_bf16 a[128:131], a[168:171], v[180:183], a[128:131]
    v_exp_f32 v141, v141
    v_mfma_f32_16x16x32_bf16 a[132:135], a[172:175], v[164:167], a[132:135]
    ds_read_b128 a[164:167], v25 offset:37120
    v_cvt_pk_bf16_f32 v190, v140, v141
    v_mfma_f32_16x16x32_bf16 a[136:139], a[172:175], v[172:175], a[136:139]
    v_exp_f32 v142, v142
    v_mfma_f32_16x16x32_bf16 a[140:143], a[172:175], v[180:183], a[140:143]
    buffer_load_dwordx4 v17, s[16:19], s28 offen nt lds
    s_waitcnt lgkmcnt(4)
    v_mfma_f32_16x16x32_bf16 v[116:119], a[176:179], v[112:115], v[212:215]
    ds_read_b128 a[168:171], v22 offset:43008
    v_mfma_f32_16x16x32_bf16 v[124:127], a[176:179], v[120:123], v[220:223]
    v_exp_f32 v143, v143
    v_mfma_f32_16x16x32_bf16 v[132:135], a[176:179], v[128:131], v[228:231]
    v_exp_f32 v148, v148
    v_mfma_f32_16x16x32_bf16 v[116:119], a[180:183], v[136:139], v[116:119]
    ds_read_b128 a[172:175], v25 offset:43008
    v_cvt_pk_bf16_f32 v191, v142, v143
    v_mfma_f32_16x16x32_bf16 v[124:127], a[180:183], v[144:147], v[124:127]
    v_exp_f32 v149, v149
    v_mfma_f32_16x16x32_bf16 v[132:135], a[180:183], v[152:155], v[132:135]
    v_cvt_pk_bf16_f32 v198, v148, v149
    s_waitcnt lgkmcnt(4)
    v_mfma_f32_16x16x32_bf16 v[116:119], a[184:187], v[160:163], v[116:119]
    ds_read_b128 a[176:179], v22 offset:43136
    v_mfma_f32_16x16x32_bf16 v[124:127], a[184:187], v[168:171], v[124:127]
    v_exp_f32 v150, v150
    v_mfma_f32_16x16x32_bf16 v[132:135], a[184:187], v[176:179], v[132:135]
    v_exp_f32 v151, v151
    v_mfma_f32_16x16x32_bf16 v[116:119], a[188:191], v[184:187], v[116:119]
    ds_read_b128 a[180:183], v25 offset:43136
    v_cvt_pk_bf16_f32 v199, v150, v151
    v_mfma_f32_16x16x32_bf16 v[124:127], a[188:191], v[192:195], v[124:127]
    v_exp_f32 v156, v156
    v_mfma_f32_16x16x32_bf16 v[132:135], a[188:191], v[200:203], v[132:135]
    buffer_load_dwordx4 v18, s[16:19], s28 offen offset:1024 nt lds
    s_waitcnt lgkmcnt(4)
    v_mfma_f32_16x16x32_bf16 v[116:119], a[160:163], v[208:211], v[116:119]
    v_exp_f32 v157, v157
    v_mfma_f32_16x16x32_bf16 v[124:127], a[160:163], v[216:219], v[124:127]
    v_exp_f32 v158, v158
    v_mfma_f32_16x16x32_bf16 v[132:135], a[160:163], v[224:227], v[132:135]
    v_exp_f32 v159, v159
    v_mfma_f32_16x16x32_bf16 v[116:119], a[164:167], v[232:235], v[116:119]
    ds_read_b128 a[184:187], v22 offset:43264
    v_cvt_pk_bf16_f32 v206, v156, v157
    v_mfma_f32_16x16x32_bf16 v[124:127], a[164:167], v[240:243], v[124:127]
    ds_read_b128 a[188:191], v25 offset:43264
    v_cvt_pk_bf16_f32 v207, v158, v159
    v_mfma_f32_16x16x32_bf16 v[132:135], a[164:167], v[248:251], v[132:135]
    buffer_load_dwordx4 v19, s[16:19], s28 offen offset:2048 nt lds
    s_waitcnt lgkmcnt(4)
    v_mfma_f32_16x16x32_bf16 v[140:143], a[168:171], v[112:115], v[212:215]
    s_add_u32 s28, s28, 12288
    ds_read_b64_tr_b16 a[160:161], v26 offset:0
    v_mfma_f32_16x16x32_bf16 v[148:151], a[168:171], v[120:123], v[220:223]
    s_add_u32 m0, s29, 110592
    ds_read_b64_tr_b16 a[162:163], v26 offset:6144
    v_mfma_f32_16x16x32_bf16 v[156:159], a[168:171], v[128:131], v[228:231]
    s_add_u32 s34, s80, 53760
    s_cmp_eq_u32 s31, 2
    s_cselect_b32 s34, s34, 0x7ff00000
    v_mfma_f32_16x16x32_bf16 v[140:143], a[172:175], v[136:139], v[140:143]
    ds_read_b64_tr_b16 a[164:165], v29 offset:0
    v_mfma_f32_16x16x32_bf16 v[148:151], a[172:175], v[144:147], v[148:151]
    ds_read_b64_tr_b16 a[166:167], v29 offset:6144
    v_mfma_f32_16x16x32_bf16 v[156:159], a[172:175], v[152:155], v[156:159]
    buffer_load_dword v103, v100, s[68:71], s34 offen
    s_waitcnt lgkmcnt(6)
    v_mfma_f32_16x16x32_bf16 v[140:143], a[176:179], v[160:163], v[140:143]
    ds_read_b64_tr_b16 a[168:169], v32 offset:0
    v_mfma_f32_16x16x32_bf16 v[148:151], a[176:179], v[168:171], v[148:151]
    ds_read_b64_tr_b16 a[170:171], v32 offset:6144
    v_mfma_f32_16x16x32_bf16 v[156:159], a[176:179], v[176:179], v[156:159]
    buffer_load_dwordx4 v14, s[12:15], s27 offen nt lds
    v_mfma_f32_16x16x32_bf16 v[140:143], a[180:183], v[184:187], v[140:143]
    ds_read_b64_tr_b16 a[172:173], v35 offset:0
    v_mfma_f32_16x16x32_bf16 v[148:151], a[180:183], v[192:195], v[148:151]
    ds_read_b64_tr_b16 a[174:175], v35 offset:6144
    v_mfma_f32_16x16x32_bf16 v[156:159], a[180:183], v[200:203], v[156:159]
    s_waitcnt lgkmcnt(8)
    v_mfma_f32_16x16x32_bf16 v[140:143], a[184:187], v[208:211], v[140:143]
    ds_read_b64_tr_b16 a[176:177], v26 offset:128
    v_mfma_f32_16x16x32_bf16 v[148:151], a[184:187], v[216:219], v[148:151]
    ds_read_b64_tr_b16 a[178:179], v26 offset:6272
    v_mfma_f32_16x16x32_bf16 v[156:159], a[184:187], v[224:227], v[156:159]
    buffer_load_dwordx4 v15, s[12:15], s27 offen offset:1024 nt lds
    v_mfma_f32_16x16x32_bf16 v[140:143], a[188:191], v[232:235], v[140:143]
    ds_read_b64_tr_b16 a[180:181], v29 offset:128
    v_mfma_f32_16x16x32_bf16 v[148:151], a[188:191], v[240:243], v[148:151]
    ds_read_b64_tr_b16 a[182:183], v29 offset:6272
    v_mfma_f32_16x16x32_bf16 v[156:159], a[188:191], v[248:251], v[156:159]
    s_waitcnt lgkmcnt(8)
    v_mfma_f32_16x16x32_bf16 a[0:3], a[160:163], v[188:191], a[0:3]
    ds_read_b64_tr_b16 a[184:185], v32 offset:128
    v_mfma_f32_16x16x32_bf16 a[4:7], a[160:163], v[196:199], a[4:7]
    ds_read_b64_tr_b16 a[186:187], v32 offset:6272
    v_mfma_f32_16x16x32_bf16 a[8:11], a[160:163], v[204:207], a[8:11]
    v_exp_f32 v116, v116
    v_mfma_f32_16x16x32_bf16 a[12:15], a[164:167], v[188:191], a[12:15]
    ds_read_b64_tr_b16 a[188:189], v35 offset:128
    v_mfma_f32_16x16x32_bf16 a[16:19], a[164:167], v[196:199], a[16:19]
    ds_read_b64_tr_b16 a[190:191], v35 offset:6272
    v_mfma_f32_16x16x32_bf16 a[20:23], a[164:167], v[204:207], a[20:23]
    buffer_load_dwordx4 v16, s[12:15], s27 offen offset:2048 nt lds
    s_waitcnt lgkmcnt(8)
    v_mfma_f32_16x16x32_bf16 a[24:27], a[168:171], v[188:191], a[24:27]
    ds_read_b64_tr_b16 a[160:161], v26 offset:256
    v_mfma_f32_16x16x32_bf16 a[28:31], a[168:171], v[196:199], a[28:31]
    ds_read_b64_tr_b16 a[162:163], v26 offset:6400
    v_mfma_f32_16x16x32_bf16 a[32:35], a[168:171], v[204:207], a[32:35]
    v_exp_f32 v117, v117
    v_mfma_f32_16x16x32_bf16 a[36:39], a[172:175], v[188:191], a[36:39]
    ds_read_b64_tr_b16 a[164:165], v29 offset:256
    v_cvt_pk_bf16_f32 v164, v116, v117
    v_mfma_f32_16x16x32_bf16 a[40:43], a[172:175], v[196:199], a[40:43]
    s_add_u32 s27, s27, 12288
    ds_read_b64_tr_b16 a[166:167], v29 offset:6400
    v_mfma_f32_16x16x32_bf16 a[44:47], a[172:175], v[204:207], a[44:47]
    s_waitcnt lgkmcnt(8)
    v_mfma_f32_16x16x32_bf16 a[48:51], a[176:179], v[188:191], a[48:51]
    ds_read_b64_tr_b16 a[168:169], v32 offset:256
    v_mfma_f32_16x16x32_bf16 a[52:55], a[176:179], v[196:199], a[52:55]
    ds_read_b64_tr_b16 a[170:171], v32 offset:6400
    v_mfma_f32_16x16x32_bf16 a[56:59], a[176:179], v[204:207], a[56:59]
    v_exp_f32 v118, v118
    v_mfma_f32_16x16x32_bf16 a[60:63], a[180:183], v[188:191], a[60:63]
    ds_read_b64_tr_b16 a[172:173], v35 offset:256
    v_mfma_f32_16x16x32_bf16 a[64:67], a[180:183], v[196:199], a[64:67]
    ds_read_b64_tr_b16 a[174:175], v35 offset:6400
    v_mfma_f32_16x16x32_bf16 a[68:71], a[180:183], v[204:207], a[68:71]
    v_exp_f32 v119, v119
    v_mfma_f32_16x16x32_bf16 a[144:147], a[156:159], v[188:191], a[144:147]
    v_exp_f32 v124, v124
    v_mfma_f32_16x16x32_bf16 a[148:151], a[156:159], v[196:199], a[148:151]
    v_exp_f32 v125, v125
    v_mfma_f32_16x16x32_bf16 a[152:155], a[156:159], v[204:207], a[152:155]
    s_waitcnt vmcnt(24)
    s_barrier
    s_waitcnt lgkmcnt(8)
    v_mfma_f32_16x16x32_bf16 a[72:75], a[184:187], v[188:191], a[72:75]
    ds_read_b128 a[176:179], v20 offset:12288
    v_cvt_pk_bf16_f32 v165, v118, v119
    v_mfma_f32_16x16x32_bf16 a[76:79], a[184:187], v[196:199], a[76:79]
    s_add_u32 m0, s29, 122880
    v_exp_f32 v126, v126
    v_mfma_f32_16x16x32_bf16 a[80:83], a[184:187], v[204:207], a[80:83]
    v_exp_f32 v127, v127
    v_mfma_f32_16x16x32_bf16 a[84:87], a[188:191], v[188:191], a[84:87]
    ds_read_b128 a[180:183], v23 offset:12288
    v_cvt_pk_bf16_f32 v172, v124, v125
    v_mfma_f32_16x16x32_bf16 a[88:91], a[188:191], v[196:199], a[88:91]
    v_exp_f32 v132, v132
    v_mfma_f32_16x16x32_bf16 a[92:95], a[188:191], v[204:207], a[92:95]
    v_cvt_pk_bf16_f32 v173, v126, v127
    s_waitcnt lgkmcnt(6)
    v_mfma_f32_16x16x32_bf16 a[96:99], a[160:163], v[188:191], a[96:99]
    ds_read_b128 a[184:187], v20 offset:12416
    v_mfma_f32_16x16x32_bf16 a[100:103], a[160:163], v[196:199], a[100:103]
    v_exp_f32 v133, v133
    v_mfma_f32_16x16x32_bf16 a[104:107], a[160:163], v[204:207], a[104:107]
    v_exp_f32 v134, v134
    v_mfma_f32_16x16x32_bf16 a[108:111], a[164:167], v[188:191], a[108:111]
    ds_read_b128 a[188:191], v23 offset:12416
    v_cvt_pk_bf16_f32 v180, v132, v133
    v_mfma_f32_16x16x32_bf16 a[112:115], a[164:167], v[196:199], a[112:115]
    v_exp_f32 v135, v135
    v_mfma_f32_16x16x32_bf16 a[116:119], a[164:167], v[204:207], a[116:119]
    v_cvt_pk_bf16_f32 v181, v134, v135
    s_waitcnt lgkmcnt(4)
    v_mfma_f32_16x16x32_bf16 a[120:123], a[168:171], v[188:191], a[120:123]
    ds_read_b128 a[160:163], v20 offset:12544
    v_mfma_f32_16x16x32_bf16 a[124:127], a[168:171], v[196:199], a[124:127]
    v_exp_f32 v140, v140
    v_mfma_f32_16x16x32_bf16 a[128:131], a[168:171], v[204:207], a[128:131]
    v_exp_f32 v141, v141
    v_mfma_f32_16x16x32_bf16 a[132:135], a[172:175], v[188:191], a[132:135]
    ds_read_b128 a[164:167], v23 offset:12544
    v_cvt_pk_bf16_f32 v166, v140, v141
    v_mfma_f32_16x16x32_bf16 a[136:139], a[172:175], v[196:199], a[136:139]
    v_exp_f32 v142, v142
    v_mfma_f32_16x16x32_bf16 a[140:143], a[172:175], v[204:207], a[140:143]
    buffer_load_dwordx4 v17, s[16:19], s28 offen nt lds
    s_waitcnt lgkmcnt(4)
    v_mfma_f32_16x16x32_bf16 v[116:119], a[176:179], v[112:115], v[212:215]
    ds_read_b128 a[168:171], v20 offset:18432
    v_mfma_f32_16x16x32_bf16 v[124:127], a[176:179], v[120:123], v[220:223]
    v_exp_f32 v143, v143
    v_mfma_f32_16x16x32_bf16 v[132:135], a[176:179], v[128:131], v[228:231]
    v_exp_f32 v148, v148
    v_mfma_f32_16x16x32_bf16 v[116:119], a[180:183], v[136:139], v[116:119]
    ds_read_b128 a[172:175], v23 offset:18432
    v_cvt_pk_bf16_f32 v167, v142, v143
    v_mfma_f32_16x16x32_bf16 v[124:127], a[180:183], v[144:147], v[124:127]
    v_exp_f32 v149, v149
    v_mfma_f32_16x16x32_bf16 v[132:135], a[180:183], v[152:155], v[132:135]
    v_cvt_pk_bf16_f32 v174, v148, v149
    s_waitcnt lgkmcnt(4)
    v_mfma_f32_16x16x32_bf16 v[116:119], a[184:187], v[160:163], v[116:119]
    ds_read_b128 a[176:179], v20 offset:18560
    v_mfma_f32_16x16x32_bf16 v[124:127], a[184:187], v[168:171], v[124:127]
    v_exp_f32 v150, v150
    v_mfma_f32_16x16x32_bf16 v[132:135], a[184:187], v[176:179], v[132:135]
    v_exp_f32 v151, v151
    v_mfma_f32_16x16x32_bf16 v[116:119], a[188:191], v[184:187], v[116:119]
    ds_read_b128 a[180:183], v23 offset:18560
    v_cvt_pk_bf16_f32 v175, v150, v151
    v_mfma_f32_16x16x32_bf16 v[124:127], a[188:191], v[192:195], v[124:127]
    v_exp_f32 v156, v156
    v_mfma_f32_16x16x32_bf16 v[132:135], a[188:191], v[200:203], v[132:135]
    buffer_load_dwordx4 v18, s[16:19], s28 offen offset:1024 nt lds
    s_waitcnt lgkmcnt(4)
    v_mfma_f32_16x16x32_bf16 v[116:119], a[160:163], v[208:211], v[116:119]
    v_exp_f32 v157, v157
    v_mfma_f32_16x16x32_bf16 v[124:127], a[160:163], v[216:219], v[124:127]
    v_exp_f32 v158, v158
    v_mfma_f32_16x16x32_bf16 v[132:135], a[160:163], v[224:227], v[132:135]
    v_exp_f32 v159, v159
    v_mfma_f32_16x16x32_bf16 v[116:119], a[164:167], v[232:235], v[116:119]
    ds_read_b128 a[184:187], v20 offset:18688
    v_cvt_pk_bf16_f32 v182, v156, v157
    v_mfma_f32_16x16x32_bf16 v[124:127], a[164:167], v[240:243], v[124:127]
    ds_read_b128 a[188:191], v23 offset:18688
    v_cvt_pk_bf16_f32 v183, v158, v159
    v_mfma_f32_16x16x32_bf16 v[132:135], a[164:167], v[248:251], v[132:135]
    buffer_load_dwordx4 v19, s[16:19], s28 offen offset:2048 nt lds
    s_waitcnt lgkmcnt(4)
    v_mfma_f32_16x16x32_bf16 v[140:143], a[168:171], v[112:115], v[212:215]
    s_add_u32 s28, s28, 12288
    ds_read_b64_tr_b16 a[160:161], v26 offset:24576
    v_mfma_f32_16x16x32_bf16 v[148:151], a[168:171], v[120:123], v[220:223]
    s_add_u32 m0, s29, 135168
    ds_read_b64_tr_b16 a[162:163], v26 offset:30720
    v_mfma_f32_16x16x32_bf16 v[156:159], a[168:171], v[128:131], v[228:231]
    s_add_u32 s34, s80, 80640
    s_cmp_eq_u32 s31, 3
    s_cselect_b32 s34, s34, 0x7ff00000
    v_mfma_f32_16x16x32_bf16 v[140:143], a[172:175], v[136:139], v[140:143]
    ds_read_b64_tr_b16 a[164:165], v29 offset:24576
    v_mfma_f32_16x16x32_bf16 v[148:151], a[172:175], v[144:147], v[148:151]
    ds_read_b64_tr_b16 a[166:167], v29 offset:30720
    v_mfma_f32_16x16x32_bf16 v[156:159], a[172:175], v[152:155], v[156:159]
    buffer_load_dword v103, v100, s[68:71], s34 offen
    s_waitcnt lgkmcnt(6)
    v_mfma_f32_16x16x32_bf16 v[140:143], a[176:179], v[160:163], v[140:143]
    ds_read_b64_tr_b16 a[168:169], v32 offset:24576
    v_mfma_f32_16x16x32_bf16 v[148:151], a[176:179], v[168:171], v[148:151]
    ds_read_b64_tr_b16 a[170:171], v32 offset:30720
    v_mfma_f32_16x16x32_bf16 v[156:159], a[176:179], v[176:179], v[156:159]
    buffer_load_dwordx4 v14, s[12:15], s27 offen nt lds
    v_mfma_f32_16x16x32_bf16 v[140:143], a[180:183], v[184:187], v[140:143]
    ds_read_b64_tr_b16 a[172:173], v35 offset:24576
    v_mfma_f32_16x16x32_bf16 v[148:151], a[180:183], v[192:195], v[148:151]
    ds_read_b64_tr_b16 a[174:175], v35 offset:30720
    v_mfma_f32_16x16x32_bf16 v[156:159], a[180:183], v[200:203], v[156:159]
    s_waitcnt lgkmcnt(8)
    v_mfma_f32_16x16x32_bf16 v[140:143], a[184:187], v[208:211], v[140:143]
    ds_read_b64_tr_b16 a[176:177], v26 offset:24704
    v_mfma_f32_16x16x32_bf16 v[148:151], a[184:187], v[216:219], v[148:151]
    ds_read_b64_tr_b16 a[178:179], v26 offset:30848
    v_mfma_f32_16x16x32_bf16 v[156:159], a[184:187], v[224:227], v[156:159]
    buffer_load_dwordx4 v15, s[12:15], s27 offen offset:1024 nt lds
    v_mfma_f32_16x16x32_bf16 v[140:143], a[188:191], v[232:235], v[140:143]
    ds_read_b64_tr_b16 a[180:181], v29 offset:24704
    v_mfma_f32_16x16x32_bf16 v[148:151], a[188:191], v[240:243], v[148:151]
    ds_read_b64_tr_b16 a[182:183], v29 offset:30848
    v_mfma_f32_16x16x32_bf16 v[156:159], a[188:191], v[248:251], v[156:159]
    s_waitcnt lgkmcnt(8)
    v_mfma_f32_16x16x32_bf16 a[0:3], a[160:163], v[164:167], a[0:3]
    ds_read_b64_tr_b16 a[184:185], v32 offset:24704
    v_mfma_f32_16x16x32_bf16 a[4:7], a[160:163], v[172:175], a[4:7]
    ds_read_b64_tr_b16 a[186:187], v32 offset:30848
    v_mfma_f32_16x16x32_bf16 a[8:11], a[160:163], v[180:183], a[8:11]
    v_exp_f32 v116, v116
    v_mfma_f32_16x16x32_bf16 a[12:15], a[164:167], v[164:167], a[12:15]
    ds_read_b64_tr_b16 a[188:189], v35 offset:24704
    v_mfma_f32_16x16x32_bf16 a[16:19], a[164:167], v[172:175], a[16:19]
    ds_read_b64_tr_b16 a[190:191], v35 offset:30848
    v_mfma_f32_16x16x32_bf16 a[20:23], a[164:167], v[180:183], a[20:23]
    buffer_load_dwordx4 v16, s[12:15], s27 offen offset:2048 nt lds
    s_waitcnt lgkmcnt(8)
    v_mfma_f32_16x16x32_bf16 a[24:27], a[168:171], v[164:167], a[24:27]
    ds_read_b64_tr_b16 a[160:161], v26 offset:24832
    v_mfma_f32_16x16x32_bf16 a[28:31], a[168:171], v[172:175], a[28:31]
    ds_read_b64_tr_b16 a[162:163], v26 offset:30976
    v_mfma_f32_16x16x32_bf16 a[32:35], a[168:171], v[180:183], a[32:35]
    v_exp_f32 v117, v117
    v_mfma_f32_16x16x32_bf16 a[36:39], a[172:175], v[164:167], a[36:39]
    ds_read_b64_tr_b16 a[164:165], v29 offset:24832
    v_cvt_pk_bf16_f32 v188, v116, v117
    v_mfma_f32_16x16x32_bf16 a[40:43], a[172:175], v[172:175], a[40:43]
    s_add_u32 s27, s27, 12288
    ds_read_b64_tr_b16 a[166:167], v29 offset:30976
    v_mfma_f32_16x16x32_bf16 a[44:47], a[172:175], v[180:183], a[44:47]
    s_waitcnt lgkmcnt(8)
    v_mfma_f32_16x16x32_bf16 a[48:51], a[176:179], v[164:167], a[48:51]
    ds_read_b64_tr_b16 a[168:169], v32 offset:24832
    v_mfma_f32_16x16x32_bf16 a[52:55], a[176:179], v[172:175], a[52:55]
    ds_read_b64_tr_b16 a[170:171], v32 offset:30976
    v_mfma_f32_16x16x32_bf16 a[56:59], a[176:179], v[180:183], a[56:59]
    v_exp_f32 v118, v118
    v_mfma_f32_16x16x32_bf16 a[60:63], a[180:183], v[164:167], a[60:63]
    ds_read_b64_tr_b16 a[172:173], v35 offset:24832
    v_mfma_f32_16x16x32_bf16 a[64:67], a[180:183], v[172:175], a[64:67]
    ds_read_b64_tr_b16 a[174:175], v35 offset:30976
    v_mfma_f32_16x16x32_bf16 a[68:71], a[180:183], v[180:183], a[68:71]
    v_exp_f32 v119, v119
    v_mfma_f32_16x16x32_bf16 a[144:147], a[156:159], v[164:167], a[144:147]
    v_exp_f32 v124, v124
    v_mfma_f32_16x16x32_bf16 a[148:151], a[156:159], v[172:175], a[148:151]
    v_exp_f32 v125, v125
    v_mfma_f32_16x16x32_bf16 a[152:155], a[156:159], v[180:183], a[152:155]
    s_waitcnt vmcnt(24)
    s_barrier
    s_waitcnt lgkmcnt(8)
    v_mfma_f32_16x16x32_bf16 a[72:75], a[184:187], v[164:167], a[72:75]
    ds_read_b128 a[176:179], v20 offset:36864
    v_cvt_pk_bf16_f32 v189, v118, v119
    v_mfma_f32_16x16x32_bf16 a[76:79], a[184:187], v[172:175], a[76:79]
    s_add_u32 m0, s29, 0
    v_exp_f32 v126, v126
    v_mfma_f32_16x16x32_bf16 a[80:83], a[184:187], v[180:183], a[80:83]
    v_exp_f32 v127, v127
    v_mfma_f32_16x16x32_bf16 a[84:87], a[188:191], v[164:167], a[84:87]
    ds_read_b128 a[180:183], v23 offset:36864
    v_cvt_pk_bf16_f32 v196, v124, v125
    v_mfma_f32_16x16x32_bf16 a[88:91], a[188:191], v[172:175], a[88:91]
    v_exp_f32 v132, v132
    v_mfma_f32_16x16x32_bf16 a[92:95], a[188:191], v[180:183], a[92:95]
    v_cvt_pk_bf16_f32 v197, v126, v127
    s_waitcnt lgkmcnt(6)
    v_mfma_f32_16x16x32_bf16 a[96:99], a[160:163], v[164:167], a[96:99]
    ds_read_b128 a[184:187], v20 offset:36992
    v_mfma_f32_16x16x32_bf16 a[100:103], a[160:163], v[172:175], a[100:103]
    v_exp_f32 v133, v133
    v_mfma_f32_16x16x32_bf16 a[104:107], a[160:163], v[180:183], a[104:107]
    v_exp_f32 v134, v134
    v_mfma_f32_16x16x32_bf16 a[108:111], a[164:167], v[164:167], a[108:111]
    ds_read_b128 a[188:191], v23 offset:36992
    v_cvt_pk_bf16_f32 v204, v132, v133
    v_mfma_f32_16x16x32_bf16 a[112:115], a[164:167], v[172:175], a[112:115]
    v_exp_f32 v135, v135
    v_mfma_f32_16x16x32_bf16 a[116:119], a[164:167], v[180:183], a[116:119]
    v_cvt_pk_bf16_f32 v205, v134, v135
    s_waitcnt lgkmcnt(4)
    v_mfma_f32_16x16x32_bf16 a[120:123], a[168:171], v[164:167], a[120:123]
    ds_read_b128 a[160:163], v20 offset:37120
    v_mfma_f32_16x16x32_bf16 a[124:127], a[168:171], v[172:175], a[124:127]
    v_exp_f32 v140, v140
    v_mfma_f32_16x16x32_bf16 a[128:131], a[168:171], v[180:183], a[128:131]
    v_exp_f32 v141, v141
    v_mfma_f32_16x16x32_bf16 a[132:135], a[172:175], v[164:167], a[132:135]
    ds_read_b128 a[164:167], v23 offset:37120
    v_cvt_pk_bf16_f32 v190, v140, v141
    v_mfma_f32_16x16x32_bf16 a[136:139], a[172:175], v[172:175], a[136:139]
    v_exp_f32 v142, v142
    v_mfma_f32_16x16x32_bf16 a[140:143], a[172:175], v[180:183], a[140:143]
    buffer_load_dwordx4 v17, s[16:19], s28 offen nt lds
    s_waitcnt lgkmcnt(4)
    v_mfma_f32_16x16x32_bf16 v[116:119], a[176:179], v[112:115], v[212:215]
    ds_read_b128 a[168:171], v20 offset:43008
    v_mfma_f32_16x16x32_bf16 v[124:127], a[176:179], v[120:123], v[220:223]
    v_exp_f32 v143, v143
    v_mfma_f32_16x16x32_bf16 v[132:135], a[176:179], v[128:131], v[228:231]
    v_exp_f32 v148, v148
    v_mfma_f32_16x16x32_bf16 v[116:119], a[180:183], v[136:139], v[116:119]
    ds_read_b128 a[172:175], v23 offset:43008
    v_cvt_pk_bf16_f32 v191, v142, v143
    v_mfma_f32_16x16x32_bf16 v[124:127], a[180:183], v[144:147], v[124:127]
    v_exp_f32 v149, v149
    v_mfma_f32_16x16x32_bf16 v[132:135], a[180:183], v[152:155], v[132:135]
    v_cvt_pk_bf16_f32 v198, v148, v149
    s_waitcnt lgkmcnt(4)
    v_mfma_f32_16x16x32_bf16 v[116:119], a[184:187], v[160:163], v[116:119]
    ds_read_b128 a[176:179], v20 offset:43136
    v_mfma_f32_16x16x32_bf16 v[124:127], a[184:187], v[168:171], v[124:127]
    v_exp_f32 v150, v150
    v_mfma_f32_16x16x32_bf16 v[132:135], a[184:187], v[176:179], v[132:135]
    v_exp_f32 v151, v151
    v_mfma_f32_16x16x32_bf16 v[116:119], a[188:191], v[184:187], v[116:119]
    ds_read_b128 a[180:183], v23 offset:43136
    v_cvt_pk_bf16_f32 v199, v150, v151
    v_mfma_f32_16x16x32_bf16 v[124:127], a[188:191], v[192:195], v[124:127]
    v_exp_f32 v156, v156
    v_mfma_f32_16x16x32_bf16 v[132:135], a[188:191], v[200:203], v[132:135]
    buffer_load_dwordx4 v18, s[16:19], s28 offen offset:1024 nt lds
    s_waitcnt lgkmcnt(4)
    v_mfma_f32_16x16x32_bf16 v[116:119], a[160:163], v[208:211], v[116:119]
    v_exp_f32 v157, v157
    v_mfma_f32_16x16x32_bf16 v[124:127], a[160:163], v[216:219], v[124:127]
    v_exp_f32 v158, v158
    v_mfma_f32_16x16x32_bf16 v[132:135], a[160:163], v[224:227], v[132:135]
    v_exp_f32 v159, v159
    v_mfma_f32_16x16x32_bf16 v[116:119], a[164:167], v[232:235], v[116:119]
    ds_read_b128 a[184:187], v20 offset:43264
    v_cvt_pk_bf16_f32 v206, v156, v157
    v_mfma_f32_16x16x32_bf16 v[124:127], a[164:167], v[240:243], v[124:127]
    ds_read_b128 a[188:191], v23 offset:43264
    v_cvt_pk_bf16_f32 v207, v158, v159
    v_mfma_f32_16x16x32_bf16 v[132:135], a[164:167], v[248:251], v[132:135]
    buffer_load_dwordx4 v19, s[16:19], s28 offen offset:2048 nt lds
    s_waitcnt lgkmcnt(4)
    v_mfma_f32_16x16x32_bf16 v[140:143], a[168:171], v[112:115], v[212:215]
    s_add_u32 s28, s28, 12288
    ds_read_b64_tr_b16 a[160:161], v27 offset:0
    v_mfma_f32_16x16x32_bf16 v[148:151], a[168:171], v[120:123], v[220:223]
    s_add_u32 m0, s29, 12288
    ds_read_b64_tr_b16 a[162:163], v27 offset:6144
    v_mfma_f32_16x16x32_bf16 v[156:159], a[168:171], v[128:131], v[228:231]
    s_add_u32 s34, s80, 107520
    s_cmp_eq_u32 s31, 0
    s_cselect_b32 s34, s34, 0x7ff00000
    v_mfma_f32_16x16x32_bf16 v[140:143], a[172:175], v[136:139], v[140:143]
    ds_read_b64_tr_b16 a[164:165], v30 offset:0
    v_mfma_f32_16x16x32_bf16 v[148:151], a[172:175], v[144:147], v[148:151]
    ds_read_b64_tr_b16 a[166:167], v30 offset:6144
    v_mfma_f32_16x16x32_bf16 v[156:159], a[172:175], v[152:155], v[156:159]
    buffer_load_dword v103, v100, s[68:71], s34 offen
    s_waitcnt lgkmcnt(6)
    v_mfma_f32_16x16x32_bf16 v[140:143], a[176:179], v[160:163], v[140:143]
    ds_read_b64_tr_b16 a[168:169], v33 offset:0
    v_mfma_f32_16x16x32_bf16 v[148:151], a[176:179], v[168:171], v[148:151]
    ds_read_b64_tr_b16 a[170:171], v33 offset:6144
    v_mfma_f32_16x16x32_bf16 v[156:159], a[176:179], v[176:179], v[156:159]
    buffer_load_dwordx4 v14, s[12:15], s27 offen nt lds
    v_mfma_f32_16x16x32_bf16 v[140:143], a[180:183], v[184:187], v[140:143]
    ds_read_b64_tr_b16 a[172:173], v36 offset:0
    v_mfma_f32_16x16x32_bf16 v[148:151], a[180:183], v[192:195], v[148:151]
    ds_read_b64_tr_b16 a[174:175], v36 offset:6144
    v_mfma_f32_16x16x32_bf16 v[156:159], a[180:183], v[200:203], v[156:159]
    s_waitcnt lgkmcnt(8)
    v_mfma_f32_16x16x32_bf16 v[140:143], a[184:187], v[208:211], v[140:143]
    ds_read_b64_tr_b16 a[176:177], v27 offset:128
    v_mfma_f32_16x16x32_bf16 v[148:151], a[184:187], v[216:219], v[148:151]
    ds_read_b64_tr_b16 a[178:179], v27 offset:6272
    v_mfma_f32_16x16x32_bf16 v[156:159], a[184:187], v[224:227], v[156:159]
    buffer_load_dwordx4 v15, s[12:15], s27 offen offset:1024 nt lds
    v_mfma_f32_16x16x32_bf16 v[140:143], a[188:191], v[232:235], v[140:143]
    ds_read_b64_tr_b16 a[180:181], v30 offset:128
    v_mfma_f32_16x16x32_bf16 v[148:151], a[188:191], v[240:243], v[148:151]
    ds_read_b64_tr_b16 a[182:183], v30 offset:6272
    v_mfma_f32_16x16x32_bf16 v[156:159], a[188:191], v[248:251], v[156:159]
    s_waitcnt lgkmcnt(8)
    v_mfma_f32_16x16x32_bf16 a[0:3], a[160:163], v[188:191], a[0:3]
    ds_read_b64_tr_b16 a[184:185], v33 offset:128
    v_mfma_f32_16x16x32_bf16 a[4:7], a[160:163], v[196:199], a[4:7]
    ds_read_b64_tr_b16 a[186:187], v33 offset:6272
    v_mfma_f32_16x16x32_bf16 a[8:11], a[160:163], v[204:207], a[8:11]
    v_exp_f32 v116, v116
    v_mfma_f32_16x16x32_bf16 a[12:15], a[164:167], v[188:191], a[12:15]
    ds_read_b64_tr_b16 a[188:189], v36 offset:128
    v_mfma_f32_16x16x32_bf16 a[16:19], a[164:167], v[196:199], a[16:19]
    ds_read_b64_tr_b16 a[190:191], v36 offset:6272
    v_mfma_f32_16x16x32_bf16 a[20:23], a[164:167], v[204:207], a[20:23]
    buffer_load_dwordx4 v16, s[12:15], s27 offen offset:2048 nt lds
    s_waitcnt lgkmcnt(8)
    v_mfma_f32_16x16x32_bf16 a[24:27], a[168:171], v[188:191], a[24:27]
    ds_read_b64_tr_b16 a[160:161], v27 offset:256
    v_mfma_f32_16x16x32_bf16 a[28:31], a[168:171], v[196:199], a[28:31]
    ds_read_b64_tr_b16 a[162:163], v27 offset:6400
    v_mfma_f32_16x16x32_bf16 a[32:35], a[168:171], v[204:207], a[32:35]
    v_exp_f32 v117, v117
    v_mfma_f32_16x16x32_bf16 a[36:39], a[172:175], v[188:191], a[36:39]
    ds_read_b64_tr_b16 a[164:165], v30 offset:256
    v_cvt_pk_bf16_f32 v164, v116, v117
    v_mfma_f32_16x16x32_bf16 a[40:43], a[172:175], v[196:199], a[40:43]
    s_add_u32 s27, s27, 12288
    ds_read_b64_tr_b16 a[166:167], v30 offset:6400
    v_mfma_f32_16x16x32_bf16 a[44:47], a[172:175], v[204:207], a[44:47]
    s_waitcnt lgkmcnt(8)
    v_mfma_f32_16x16x32_bf16 a[48:51], a[176:179], v[188:191], a[48:51]
    ds_read_b64_tr_b16 a[168:169], v33 offset:256
    v_mfma_f32_16x16x32_bf16 a[52:55], a[176:179], v[196:199], a[52:55]
    ds_read_b64_tr_b16 a[170:171], v33 offset:6400
    v_mfma_f32_16x16x32_bf16 a[56:59], a[176:179], v[204:207], a[56:59]
    v_exp_f32 v118, v118
    v_mfma_f32_16x16x32_bf16 a[60:63], a[180:183], v[188:191], a[60:63]
    ds_read_b64_tr_b16 a[172:173], v36 offset:256
    v_mfma_f32_16x16x32_bf16 a[64:67], a[180:183], v[196:199], a[64:67]
    ds_read_b64_tr_b16 a[174:175], v36 offset:6400
    v_mfma_f32_16x16x32_bf16 a[68:71], a[180:183], v[204:207], a[68:71]
    v_exp_f32 v119, v119
    v_mfma_f32_16x16x32_bf16 a[144:147], a[156:159], v[188:191], a[144:147]
    v_exp_f32 v124, v124
    v_mfma_f32_16x16x32_bf16 a[148:151], a[156:159], v[196:199], a[148:151]
    v_exp_f32 v125, v125
    v_mfma_f32_16x16x32_bf16 a[152:155], a[156:159], v[204:207], a[152:155]
    s_waitcnt vmcnt(25)
    s_barrier
    s_waitcnt lgkmcnt(8)
    v_mfma_f32_16x16x32_bf16 a[72:75], a[184:187], v[188:191], a[72:75]
    ds_read_b128 a[176:179], v21 offset:12288
    v_cvt_pk_bf16_f32 v165, v118, v119
    v_mfma_f32_16x16x32_bf16 a[76:79], a[184:187], v[196:199], a[76:79]
    s_add_u32 m0, s29, 24576
    v_exp_f32 v126, v126
    v_mfma_f32_16x16x32_bf16 a[80:83], a[184:187], v[204:207], a[80:83]
    v_exp_f32 v127, v127
    v_mfma_f32_16x16x32_bf16 a[84:87], a[188:191], v[188:191], a[84:87]
    ds_read_b128 a[180:183], v24 offset:12288
    v_cvt_pk_bf16_f32 v172, v124, v125
    v_mfma_f32_16x16x32_bf16 a[88:91], a[188:191], v[196:199], a[88:91]
    v_exp_f32 v132, v132
    v_mfma_f32_16x16x32_bf16 a[92:95], a[188:191], v[204:207], a[92:95]
    v_cvt_pk_bf16_f32 v173, v126, v127
    s_waitcnt lgkmcnt(6)
    v_mfma_f32_16x16x32_bf16 a[96:99], a[160:163], v[188:191], a[96:99]
    ds_read_b128 a[184:187], v21 offset:12416
    v_mfma_f32_16x16x32_bf16 a[100:103], a[160:163], v[196:199], a[100:103]
    v_exp_f32 v133, v133
    v_mfma_f32_16x16x32_bf16 a[104:107], a[160:163], v[204:207], a[104:107]
    v_exp_f32 v134, v134
    v_mfma_f32_16x16x32_bf16 a[108:111], a[164:167], v[188:191], a[108:111]
    ds_read_b128 a[188:191], v24 offset:12416
    v_cvt_pk_bf16_f32 v180, v132, v133
    v_mfma_f32_16x16x32_bf16 a[112:115], a[164:167], v[196:199], a[112:115]
    v_exp_f32 v135, v135
    v_mfma_f32_16x16x32_bf16 a[116:119], a[164:167], v[204:207], a[116:119]
    v_cvt_pk_bf16_f32 v181, v134, v135
    s_waitcnt lgkmcnt(4)
    v_mfma_f32_16x16x32_bf16 a[120:123], a[168:171], v[188:191], a[120:123]
    ds_read_b128 a[160:163], v21 offset:12544
    v_mfma_f32_16x16x32_bf16 a[124:127], a[168:171], v[196:199], a[124:127]
    v_exp_f32 v140, v140
    v_mfma_f32_16x16x32_bf16 a[128:131], a[168:171], v[204:207], a[128:131]
    v_exp_f32 v141, v141
    v_mfma_f32_16x16x32_bf16 a[132:135], a[172:175], v[188:191], a[132:135]
    ds_read_b128 a[164:167], v24 offset:12544
    v_cvt_pk_bf16_f32 v166, v140, v141
    v_mfma_f32_16x16x32_bf16 a[136:139], a[172:175], v[196:199], a[136:139]
    v_exp_f32 v142, v142
    v_mfma_f32_16x16x32_bf16 a[140:143], a[172:175], v[204:207], a[140:143]
    buffer_load_dwordx4 v17, s[16:19], s28 offen nt lds
    s_waitcnt lgkmcnt(4)
    v_mfma_f32_16x16x32_bf16 v[116:119], a[176:179], v[112:115], v[212:215]
    ds_read_b128 a[168:171], v21 offset:18432
    v_mfma_f32_16x16x32_bf16 v[124:127], a[176:179], v[120:123], v[220:223]
    v_exp_f32 v143, v143
    v_mfma_f32_16x16x32_bf16 v[132:135], a[176:179], v[128:131], v[228:231]
    v_exp_f32 v148, v148
    v_mfma_f32_16x16x32_bf16 v[116:119], a[180:183], v[136:139], v[116:119]
    ds_read_b128 a[172:175], v24 offset:18432
    v_cvt_pk_bf16_f32 v167, v142, v143
    v_mfma_f32_16x16x32_bf16 v[124:127], a[180:183], v[144:147], v[124:127]
    v_exp_f32 v149, v149
    v_mfma_f32_16x16x32_bf16 v[132:135], a[180:183], v[152:155], v[132:135]
    v_cvt_pk_bf16_f32 v174, v148, v149
    s_waitcnt lgkmcnt(4)
    v_mfma_f32_16x16x32_bf16 v[116:119], a[184:187], v[160:163], v[116:119]
    ds_read_b128 a[176:179], v21 offset:18560
    v_mfma_f32_16x16x32_bf16 v[124:127], a[184:187], v[168:171], v[124:127]
    v_exp_f32 v150, v150
    v_mfma_f32_16x16x32_bf16 v[132:135], a[184:187], v[176:179], v[132:135]
    v_exp_f32 v151, v151
    v_mfma_f32_16x16x32_bf16 v[116:119], a[188:191], v[184:187], v[116:119]
    ds_read_b128 a[180:183], v24 offset:18560
    v_cvt_pk_bf16_f32 v175, v150, v151
    v_mfma_f32_16x16x32_bf16 v[124:127], a[188:191], v[192:195], v[124:127]
    v_exp_f32 v156, v156
    v_mfma_f32_16x16x32_bf16 v[132:135], a[188:191], v[200:203], v[132:135]
    buffer_load_dwordx4 v18, s[16:19], s28 offen offset:1024 nt lds
    s_waitcnt lgkmcnt(4)
    v_mfma_f32_16x16x32_bf16 v[116:119], a[160:163], v[208:211], v[116:119]
    v_exp_f32 v157, v157
    v_mfma_f32_16x16x32_bf16 v[124:127], a[160:163], v[216:219], v[124:127]
    v_exp_f32 v158, v158
    v_mfma_f32_16x16x32_bf16 v[132:135], a[160:163], v[224:227], v[132:135]
    v_exp_f32 v159, v159
    v_mfma_f32_16x16x32_bf16 v[116:119], a[164:167], v[232:235], v[116:119]
    ds_read_b128 a[184:187], v21 offset:18688
    v_cvt_pk_bf16_f32 v182, v156, v157
    v_mfma_f32_16x16x32_bf16 v[124:127], a[164:167], v[240:243], v[124:127]
    ds_read_b128 a[188:191], v24 offset:18688
    v_cvt_pk_bf16_f32 v183, v158, v159
    v_mfma_f32_16x16x32_bf16 v[132:135], a[164:167], v[248:251], v[132:135]
    buffer_load_dwordx4 v19, s[16:19], s28 offen offset:2048 nt lds
    s_waitcnt lgkmcnt(4)
    v_mfma_f32_16x16x32_bf16 v[140:143], a[168:171], v[112:115], v[212:215]
    s_add_u32 s28, s28, 12288
    ds_read_b64_tr_b16 a[160:161], v27 offset:24576
    v_mfma_f32_16x16x32_bf16 v[148:151], a[168:171], v[120:123], v[220:223]
    s_add_u32 m0, s29, 36864
    ds_read_b64_tr_b16 a[162:163], v27 offset:30720
    v_mfma_f32_16x16x32_bf16 v[156:159], a[168:171], v[128:131], v[228:231]
    s_add_u32 s34, s80, 134400
    s_cmp_eq_u32 s31, 1
    s_cselect_b32 s34, s34, 0x7ff00000
    v_mfma_f32_16x16x32_bf16 v[140:143], a[172:175], v[136:139], v[140:143]
    ds_read_b64_tr_b16 a[164:165], v30 offset:24576
    v_mfma_f32_16x16x32_bf16 v[148:151], a[172:175], v[144:147], v[148:151]
    ds_read_b64_tr_b16 a[166:167], v30 offset:30720
    v_mfma_f32_16x16x32_bf16 v[156:159], a[172:175], v[152:155], v[156:159]
    buffer_load_dword v103, v100, s[68:71], s34 offen
    s_waitcnt lgkmcnt(6)
    v_mfma_f32_16x16x32_bf16 v[140:143], a[176:179], v[160:163], v[140:143]
    ds_read_b64_tr_b16 a[168:169], v33 offset:24576
    v_mfma_f32_16x16x32_bf16 v[148:151], a[176:179], v[168:171], v[148:151]
    ds_read_b64_tr_b16 a[170:171], v33 offset:30720
    v_mfma_f32_16x16x32_bf16 v[156:159], a[176:179], v[176:179], v[156:159]
    buffer_load_dwordx4 v14, s[12:15], s27 offen nt lds
    v_mfma_f32_16x16x32_bf16 v[140:143], a[180:183], v[184:187], v[140:143]
    ds_read_b64_tr_b16 a[172:173], v36 offset:24576
    v_mfma_f32_16x16x32_bf16 v[148:151], a[180:183], v[192:195], v[148:151]
    ds_read_b64_tr_b16 a[174:175], v36 offset:30720
    v_mfma_f32_16x16x32_bf16 v[156:159], a[180:183], v[200:203], v[156:159]
    s_waitcnt lgkmcnt(8)
    v_mfma_f32_16x16x32_bf16 v[140:143], a[184:187], v[208:211], v[140:143]
    ds_read_b64_tr_b16 a[176:177], v27 offset:24704
    v_mfma_f32_16x16x32_bf16 v[148:151], a[184:187], v[216:219], v[148:151]
    ds_read_b64_tr_b16 a[178:179], v27 offset:30848
    v_mfma_f32_16x16x32_bf16 v[156:159], a[184:187], v[224:227], v[156:159]
    buffer_load_dwordx4 v15, s[12:15], s27 offen offset:1024 nt lds
    v_mfma_f32_16x16x32_bf16 v[140:143], a[188:191], v[232:235], v[140:143]
    ds_read_b64_tr_b16 a[180:181], v30 offset:24704
    v_mfma_f32_16x16x32_bf16 v[148:151], a[188:191], v[240:243], v[148:151]
    ds_read_b64_tr_b16 a[182:183], v30 offset:30848
    v_mfma_f32_16x16x32_bf16 v[156:159], a[188:191], v[248:251], v[156:159]
    s_waitcnt lgkmcnt(8)
    v_mfma_f32_16x16x32_bf16 a[0:3], a[160:163], v[164:167], a[0:3]
    ds_read_b64_tr_b16 a[184:185], v33 offset:24704
    v_mfma_f32_16x16x32_bf16 a[4:7], a[160:163], v[172:175], a[4:7]
    ds_read_b64_tr_b16 a[186:187], v33 offset:30848
    v_mfma_f32_16x16x32_bf16 a[8:11], a[160:163], v[180:183], a[8:11]
    v_exp_f32 v116, v116
    v_mfma_f32_16x16x32_bf16 a[12:15], a[164:167], v[164:167], a[12:15]
    ds_read_b64_tr_b16 a[188:189], v36 offset:24704
    v_mfma_f32_16x16x32_bf16 a[16:19], a[164:167], v[172:175], a[16:19]
    ds_read_b64_tr_b16 a[190:191], v36 offset:30848
    v_mfma_f32_16x16x32_bf16 a[20:23], a[164:167], v[180:183], a[20:23]
    buffer_load_dwordx4 v16, s[12:15], s27 offen offset:2048 nt lds
    s_waitcnt lgkmcnt(8)
    v_mfma_f32_16x16x32_bf16 a[24:27], a[168:171], v[164:167], a[24:27]
    ds_read_b64_tr_b16 a[160:161], v27 offset:24832
    v_mfma_f32_16x16x32_bf16 a[28:31], a[168:171], v[172:175], a[28:31]
    ds_read_b64_tr_b16 a[162:163], v27 offset:30976
    v_mfma_f32_16x16x32_bf16 a[32:35], a[168:171], v[180:183], a[32:35]
    v_exp_f32 v117, v117
    v_mfma_f32_16x16x32_bf16 a[36:39], a[172:175], v[164:167], a[36:39]
    ds_read_b64_tr_b16 a[164:165], v30 offset:24832
    v_cvt_pk_bf16_f32 v188, v116, v117
    v_mfma_f32_16x16x32_bf16 a[40:43], a[172:175], v[172:175], a[40:43]
    s_add_u32 s27, s27, 12288
    ds_read_b64_tr_b16 a[166:167], v30 offset:30976
    v_mfma_f32_16x16x32_bf16 a[44:47], a[172:175], v[180:183], a[44:47]
    s_waitcnt lgkmcnt(8)
    v_mfma_f32_16x16x32_bf16 a[48:51], a[176:179], v[164:167], a[48:51]
    ds_read_b64_tr_b16 a[168:169], v33 offset:24832
    v_mfma_f32_16x16x32_bf16 a[52:55], a[176:179], v[172:175], a[52:55]
    ds_read_b64_tr_b16 a[170:171], v33 offset:30976
    v_mfma_f32_16x16x32_bf16 a[56:59], a[176:179], v[180:183], a[56:59]
    v_exp_f32 v118, v118
    v_mfma_f32_16x16x32_bf16 a[60:63], a[180:183], v[164:167], a[60:63]
    ds_read_b64_tr_b16 a[172:173], v36 offset:24832
    v_mfma_f32_16x16x32_bf16 a[64:67], a[180:183], v[172:175], a[64:67]
    ds_read_b64_tr_b16 a[174:175], v36 offset:30976
    v_mfma_f32_16x16x32_bf16 a[68:71], a[180:183], v[180:183], a[68:71]
    v_exp_f32 v119, v119
    v_mfma_f32_16x16x32_bf16 a[144:147], a[156:159], v[164:167], a[144:147]
    v_exp_f32 v124, v124
    v_mfma_f32_16x16x32_bf16 a[148:151], a[156:159], v[172:175], a[148:151]
    v_exp_f32 v125, v125
    v_mfma_f32_16x16x32_bf16 a[152:155], a[156:159], v[180:183], a[152:155]
    s_waitcnt vmcnt(25)
    s_barrier
    s_waitcnt lgkmcnt(8)
    v_mfma_f32_16x16x32_bf16 a[72:75], a[184:187], v[164:167], a[72:75]
    ds_read_b128 a[176:179], v21 offset:36864
    v_cvt_pk_bf16_f32 v189, v118, v119
    v_mfma_f32_16x16x32_bf16 a[76:79], a[184:187], v[172:175], a[76:79]
    s_add_u32 m0, s29, 49152
    v_exp_f32 v126, v126
    v_mfma_f32_16x16x32_bf16 a[80:83], a[184:187], v[180:183], a[80:83]
    v_exp_f32 v127, v127
    v_mfma_f32_16x16x32_bf16 a[84:87], a[188:191], v[164:167], a[84:87]
    ds_read_b128 a[180:183], v24 offset:36864
    v_cvt_pk_bf16_f32 v196, v124, v125
    v_mfma_f32_16x16x32_bf16 a[88:91], a[188:191], v[172:175], a[88:91]
    v_exp_f32 v132, v132
    v_mfma_f32_16x16x32_bf16 a[92:95], a[188:191], v[180:183], a[92:95]
    v_cvt_pk_bf16_f32 v197, v126, v127
    s_waitcnt lgkmcnt(6)
    v_mfma_f32_16x16x32_bf16 a[96:99], a[160:163], v[164:167], a[96:99]
    ds_read_b128 a[184:187], v21 offset:36992
    v_mfma_f32_16x16x32_bf16 a[100:103], a[160:163], v[172:175], a[100:103]
    v_exp_f32 v133, v133
    v_mfma_f32_16x16x32_bf16 a[104:107], a[160:163], v[180:183], a[104:107]
    v_exp_f32 v134, v134
    v_mfma_f32_16x16x32_bf16 a[108:111], a[164:167], v[164:167], a[108:111]
    ds_read_b128 a[188:191], v24 offset:36992
    v_cvt_pk_bf16_f32 v204, v132, v133
    v_mfma_f32_16x16x32_bf16 a[112:115], a[164:167], v[172:175], a[112:115]
    v_exp_f32 v135, v135
    v_mfma_f32_16x16x32_bf16 a[116:119], a[164:167], v[180:183], a[116:119]
    v_cvt_pk_bf16_f32 v205, v134, v135
    s_waitcnt lgkmcnt(4)
    v_mfma_f32_16x16x32_bf16 a[120:123], a[168:171], v[164:167], a[120:123]
    ds_read_b128 a[160:163], v21 offset:37120
    v_mfma_f32_16x16x32_bf16 a[124:127], a[168:171], v[172:175], a[124:127]
    v_exp_f32 v140, v140
    v_mfma_f32_16x16x32_bf16 a[128:131], a[168:171], v[180:183], a[128:131]
    v_exp_f32 v141, v141
    v_mfma_f32_16x16x32_bf16 a[132:135], a[172:175], v[164:167], a[132:135]
    ds_read_b128 a[164:167], v24 offset:37120
    v_cvt_pk_bf16_f32 v190, v140, v141
    v_mfma_f32_16x16x32_bf16 a[136:139], a[172:175], v[172:175], a[136:139]
    v_exp_f32 v142, v142
    v_mfma_f32_16x16x32_bf16 a[140:143], a[172:175], v[180:183], a[140:143]
    buffer_load_dwordx4 v17, s[16:19], s28 offen nt lds
    s_waitcnt lgkmcnt(4)
    v_mfma_f32_16x16x32_bf16 v[116:119], a[176:179], v[112:115], v[212:215]
    ds_read_b128 a[168:171], v21 offset:43008
    v_mfma_f32_16x16x32_bf16 v[124:127], a[176:179], v[120:123], v[220:223]
    v_exp_f32 v143, v143
    v_mfma_f32_16x16x32_bf16 v[132:135], a[176:179], v[128:131], v[228:231]
    v_exp_f32 v148, v148
    v_mfma_f32_16x16x32_bf16 v[116:119], a[180:183], v[136:139], v[116:119]
    ds_read_b128 a[172:175], v24 offset:43008
    v_cvt_pk_bf16_f32 v191, v142, v143
    v_mfma_f32_16x16x32_bf16 v[124:127], a[180:183], v[144:147], v[124:127]
    v_exp_f32 v149, v149
    v_mfma_f32_16x16x32_bf16 v[132:135], a[180:183], v[152:155], v[132:135]
    v_cvt_pk_bf16_f32 v198, v148, v149
    s_waitcnt lgkmcnt(4)
    v_mfma_f32_16x16x32_bf16 v[116:119], a[184:187], v[160:163], v[116:119]
    ds_read_b128 a[176:179], v21 offset:43136
    v_mfma_f32_16x16x32_bf16 v[124:127], a[184:187], v[168:171], v[124:127]
    v_exp_f32 v150, v150
    v_mfma_f32_16x16x32_bf16 v[132:135], a[184:187], v[176:179], v[132:135]
    v_exp_f32 v151, v151
    v_mfma_f32_16x16x32_bf16 v[116:119], a[188:191], v[184:187], v[116:119]
    ds_read_b128 a[180:183], v24 offset:43136
    v_cvt_pk_bf16_f32 v199, v150, v151
    v_mfma_f32_16x16x32_bf16 v[124:127], a[188:191], v[192:195], v[124:127]
    v_exp_f32 v156, v156
    v_mfma_f32_16x16x32_bf16 v[132:135], a[188:191], v[200:203], v[132:135]
    buffer_load_dwordx4 v18, s[16:19], s28 offen offset:1024 nt lds
    s_waitcnt lgkmcnt(4)
    v_mfma_f32_16x16x32_bf16 v[116:119], a[160:163], v[208:211], v[116:119]
    v_exp_f32 v157, v157
    v_mfma_f32_16x16x32_bf16 v[124:127], a[160:163], v[216:219], v[124:127]
    v_exp_f32 v158, v158
    v_mfma_f32_16x16x32_bf16 v[132:135], a[160:163], v[224:227], v[132:135]
    v_exp_f32 v159, v159
    v_mfma_f32_16x16x32_bf16 v[116:119], a[164:167], v[232:235], v[116:119]
    ds_read_b128 a[184:187], v21 offset:43264
    v_cvt_pk_bf16_f32 v206, v156, v157
    v_mfma_f32_16x16x32_bf16 v[124:127], a[164:167], v[240:243], v[124:127]
    ds_read_b128 a[188:191], v24 offset:43264
    v_cvt_pk_bf16_f32 v207, v158, v159
    v_mfma_f32_16x16x32_bf16 v[132:135], a[164:167], v[248:251], v[132:135]
    buffer_load_dwordx4 v19, s[16:19], s28 offen offset:2048 nt lds
    s_waitcnt lgkmcnt(4)
    v_mfma_f32_16x16x32_bf16 v[140:143], a[168:171], v[112:115], v[212:215]
    s_add_u32 s28, s28, 12288
    ds_read_b64_tr_b16 a[160:161], v28 offset:0
    v_mfma_f32_16x16x32_bf16 v[148:151], a[168:171], v[120:123], v[220:223]
    s_add_u32 m0, s29, 61440
    ds_read_b64_tr_b16 a[162:163], v28 offset:6144
    v_mfma_f32_16x16x32_bf16 v[156:159], a[168:171], v[128:131], v[228:231]
    s_add_u32 s34, s80, 161280
    s_cmp_eq_u32 s31, 2
    s_cselect_b32 s34, s34, 0x7ff00000
    v_mfma_f32_16x16x32_bf16 v[140:143], a[172:175], v[136:139], v[140:143]
    ds_read_b64_tr_b16 a[164:165], v31 offset:0
    v_mfma_f32_16x16x32_bf16 v[148:151], a[172:175], v[144:147], v[148:151]
    ds_read_b64_tr_b16 a[166:167], v31 offset:6144
    v_mfma_f32_16x16x32_bf16 v[156:159], a[172:175], v[152:155], v[156:159]
    buffer_load_dword v103, v100, s[68:71], s34 offen
    s_waitcnt lgkmcnt(6)
    v_mfma_f32_16x16x32_bf16 v[140:143], a[176:179], v[160:163], v[140:143]
    ds_read_b64_tr_b16 a[168:169], v34 offset:0
    v_mfma_f32_16x16x32_bf16 v[148:151], a[176:179], v[168:171], v[148:151]
    ds_read_b64_tr_b16 a[170:171], v34 offset:6144
    v_mfma_f32_16x16x32_bf16 v[156:159], a[176:179], v[176:179], v[156:159]
    buffer_load_dwordx4 v14, s[12:15], s27 offen nt lds
    v_mfma_f32_16x16x32_bf16 v[140:143], a[180:183], v[184:187], v[140:143]
    ds_read_b64_tr_b16 a[172:173], v37 offset:0
    v_mfma_f32_16x16x32_bf16 v[148:151], a[180:183], v[192:195], v[148:151]
    ds_read_b64_tr_b16 a[174:175], v37 offset:6144
    v_mfma_f32_16x16x32_bf16 v[156:159], a[180:183], v[200:203], v[156:159]
    s_waitcnt lgkmcnt(8)
    v_mfma_f32_16x16x32_bf16 v[140:143], a[184:187], v[208:211], v[140:143]
    ds_read_b64_tr_b16 a[176:177], v28 offset:128
    v_mfma_f32_16x16x32_bf16 v[148:151], a[184:187], v[216:219], v[148:151]
    ds_read_b64_tr_b16 a[178:179], v28 offset:6272
    v_mfma_f32_16x16x32_bf16 v[156:159], a[184:187], v[224:227], v[156:159]
    buffer_load_dwordx4 v15, s[12:15], s27 offen offset:1024 nt lds
    v_mfma_f32_16x16x32_bf16 v[140:143], a[188:191], v[232:235], v[140:143]
    ds_read_b64_tr_b16 a[180:181], v31 offset:128
    v_mfma_f32_16x16x32_bf16 v[148:151], a[188:191], v[240:243], v[148:151]
    ds_read_b64_tr_b16 a[182:183], v31 offset:6272
    v_mfma_f32_16x16x32_bf16 v[156:159], a[188:191], v[248:251], v[156:159]
    s_waitcnt lgkmcnt(8)
    v_mfma_f32_16x16x32_bf16 a[0:3], a[160:163], v[188:191], a[0:3]
    ds_read_b64_tr_b16 a[184:185], v34 offset:128
    v_mfma_f32_16x16x32_bf16 a[4:7], a[160:163], v[196:199], a[4:7]
    ds_read_b64_tr_b16 a[186:187], v34 offset:6272
    v_mfma_f32_16x16x32_bf16 a[8:11], a[160:163], v[204:207], a[8:11]
    v_exp_f32 v116, v116
    v_mfma_f32_16x16x32_bf16 a[12:15], a[164:167], v[188:191], a[12:15]
    ds_read_b64_tr_b16 a[188:189], v37 offset:128
    v_mfma_f32_16x16x32_bf16 a[16:19], a[164:167], v[196:199], a[16:19]
    ds_read_b64_tr_b16 a[190:191], v37 offset:6272
    v_mfma_f32_16x16x32_bf16 a[20:23], a[164:167], v[204:207], a[20:23]
    buffer_load_dwordx4 v16, s[12:15], s27 offen offset:2048 nt lds
    s_waitcnt lgkmcnt(8)
    v_mfma_f32_16x16x32_bf16 a[24:27], a[168:171], v[188:191], a[24:27]
    ds_read_b64_tr_b16 a[160:161], v28 offset:256
    v_mfma_f32_16x16x32_bf16 a[28:31], a[168:171], v[196:199], a[28:31]
    ds_read_b64_tr_b16 a[162:163], v28 offset:6400
    v_mfma_f32_16x16x32_bf16 a[32:35], a[168:171], v[204:207], a[32:35]
    v_exp_f32 v117, v117
    v_mfma_f32_16x16x32_bf16 a[36:39], a[172:175], v[188:191], a[36:39]
    ds_read_b64_tr_b16 a[164:165], v31 offset:256
    v_cvt_pk_bf16_f32 v164, v116, v117
    v_mfma_f32_16x16x32_bf16 a[40:43], a[172:175], v[196:199], a[40:43]
    s_add_u32 s27, s27, 12288
    ds_read_b64_tr_b16 a[166:167], v31 offset:6400
    v_mfma_f32_16x16x32_bf16 a[44:47], a[172:175], v[204:207], a[44:47]
    s_waitcnt lgkmcnt(8)
    v_mfma_f32_16x16x32_bf16 a[48:51], a[176:179], v[188:191], a[48:51]
    ds_read_b64_tr_b16 a[168:169], v34 offset:256
    v_mfma_f32_16x16x32_bf16 a[52:55], a[176:179], v[196:199], a[52:55]
    ds_read_b64_tr_b16 a[170:171], v34 offset:6400
    v_mfma_f32_16x16x32_bf16 a[56:59], a[176:179], v[204:207], a[56:59]
    v_exp_f32 v118, v118
    v_mfma_f32_16x16x32_bf16 a[60:63], a[180:183], v[188:191], a[60:63]
    ds_read_b64_tr_b16 a[172:173], v37 offset:256
    v_mfma_f32_16x16x32_bf16 a[64:67], a[180:183], v[196:199], a[64:67]
    ds_read_b64_tr_b16 a[174:175], v37 offset:6400
    v_mfma_f32_16x16x32_bf16 a[68:71], a[180:183], v[204:207], a[68:71]
    v_exp_f32 v119, v119
    v_mfma_f32_16x16x32_bf16 a[144:147], a[156:159], v[188:191], a[144:147]
    v_exp_f32 v124, v124
    v_mfma_f32_16x16x32_bf16 a[148:151], a[156:159], v[196:199], a[148:151]
    v_exp_f32 v125, v125
    v_mfma_f32_16x16x32_bf16 a[152:155], a[156:159], v[204:207], a[152:155]
    s_waitcnt vmcnt(25)
    s_barrier
    s_waitcnt lgkmcnt(8)
    v_mfma_f32_16x16x32_bf16 a[72:75], a[184:187], v[188:191], a[72:75]
    ds_read_b128 a[176:179], v22 offset:12288
    v_cvt_pk_bf16_f32 v165, v118, v119
    v_mfma_f32_16x16x32_bf16 a[76:79], a[184:187], v[196:199], a[76:79]
    s_add_u32 m0, s29, 73728
    v_exp_f32 v126, v126
    v_mfma_f32_16x16x32_bf16 a[80:83], a[184:187], v[204:207], a[80:83]
    v_exp_f32 v127, v127
    v_mfma_f32_16x16x32_bf16 a[84:87], a[188:191], v[188:191], a[84:87]
    ds_read_b128 a[180:183], v25 offset:12288
    v_cvt_pk_bf16_f32 v172, v124, v125
    v_mfma_f32_16x16x32_bf16 a[88:91], a[188:191], v[196:199], a[88:91]
    v_exp_f32 v132, v132
    v_mfma_f32_16x16x32_bf16 a[92:95], a[188:191], v[204:207], a[92:95]
    v_cvt_pk_bf16_f32 v173, v126, v127
    s_waitcnt lgkmcnt(6)
    v_mfma_f32_16x16x32_bf16 a[96:99], a[160:163], v[188:191], a[96:99]
    ds_read_b128 a[184:187], v22 offset:12416
    v_mfma_f32_16x16x32_bf16 a[100:103], a[160:163], v[196:199], a[100:103]
    v_exp_f32 v133, v133
    v_mfma_f32_16x16x32_bf16 a[104:107], a[160:163], v[204:207], a[104:107]
    v_exp_f32 v134, v134
    v_mfma_f32_16x16x32_bf16 a[108:111], a[164:167], v[188:191], a[108:111]
    ds_read_b128 a[188:191], v25 offset:12416
    v_cvt_pk_bf16_f32 v180, v132, v133
    v_mfma_f32_16x16x32_bf16 a[112:115], a[164:167], v[196:199], a[112:115]
    v_exp_f32 v135, v135
    v_mfma_f32_16x16x32_bf16 a[116:119], a[164:167], v[204:207], a[116:119]
    v_cvt_pk_bf16_f32 v181, v134, v135
    s_waitcnt lgkmcnt(4)
    v_mfma_f32_16x16x32_bf16 a[120:123], a[168:171], v[188:191], a[120:123]
    ds_read_b128 a[160:163], v22 offset:12544
    v_mfma_f32_16x16x32_bf16 a[124:127], a[168:171], v[196:199], a[124:127]
    v_exp_f32 v140, v140
    v_mfma_f32_16x16x32_bf16 a[128:131], a[168:171], v[204:207], a[128:131]
    v_exp_f32 v141, v141
    v_mfma_f32_16x16x32_bf16 a[132:135], a[172:175], v[188:191], a[132:135]
    ds_read_b128 a[164:167], v25 offset:12544
    v_cvt_pk_bf16_f32 v166, v140, v141
    v_mfma_f32_16x16x32_bf16 a[136:139], a[172:175], v[196:199], a[136:139]
    v_exp_f32 v142, v142
    v_mfma_f32_16x16x32_bf16 a[140:143], a[172:175], v[204:207], a[140:143]
    buffer_load_dwordx4 v17, s[16:19], s28 offen nt lds
    s_waitcnt lgkmcnt(4)
    v_mfma_f32_16x16x32_bf16 v[116:119], a[176:179], v[112:115], v[212:215]
    ds_read_b128 a[168:171], v22 offset:18432
    v_mfma_f32_16x16x32_bf16 v[124:127], a[176:179], v[120:123], v[220:223]
    v_exp_f32 v143, v143
    v_mfma_f32_16x16x32_bf16 v[132:135], a[176:179], v[128:131], v[228:231]
    v_exp_f32 v148, v148
    v_mfma_f32_16x16x32_bf16 v[116:119], a[180:183], v[136:139], v[116:119]
    ds_read_b128 a[172:175], v25 offset:18432
    v_cvt_pk_bf16_f32 v167, v142, v143
    v_mfma_f32_16x16x32_bf16 v[124:127], a[180:183], v[144:147], v[124:127]
    v_exp_f32 v149, v149
    v_mfma_f32_16x16x32_bf16 v[132:135], a[180:183], v[152:155], v[132:135]
    v_cvt_pk_bf16_f32 v174, v148, v149
    s_waitcnt lgkmcnt(4)
    v_mfma_f32_16x16x32_bf16 v[116:119], a[184:187], v[160:163], v[116:119]
    ds_read_b128 a[176:179], v22 offset:18560
    v_mfma_f32_16x16x32_bf16 v[124:127], a[184:187], v[168:171], v[124:127]
    v_exp_f32 v150, v150
    v_mfma_f32_16x16x32_bf16 v[132:135], a[184:187], v[176:179], v[132:135]
    v_exp_f32 v151, v151
    v_mfma_f32_16x16x32_bf16 v[116:119], a[188:191], v[184:187], v[116:119]
    ds_read_b128 a[180:183], v25 offset:18560
    v_cvt_pk_bf16_f32 v175, v150, v151
    v_mfma_f32_16x16x32_bf16 v[124:127], a[188:191], v[192:195], v[124:127]
    v_exp_f32 v156, v156
    v_mfma_f32_16x16x32_bf16 v[132:135], a[188:191], v[200:203], v[132:135]
    buffer_load_dwordx4 v18, s[16:19], s28 offen offset:1024 nt lds
    s_waitcnt lgkmcnt(4)
    v_mfma_f32_16x16x32_bf16 v[116:119], a[160:163], v[208:211], v[116:119]
    v_exp_f32 v157, v157
    v_mfma_f32_16x16x32_bf16 v[124:127], a[160:163], v[216:219], v[124:127]
    v_exp_f32 v158, v158
    v_mfma_f32_16x16x32_bf16 v[132:135], a[160:163], v[224:227], v[132:135]
    v_exp_f32 v159, v159
    v_mfma_f32_16x16x32_bf16 v[116:119], a[164:167], v[232:235], v[116:119]
    ds_read_b128 a[184:187], v22 offset:18688
    v_cvt_pk_bf16_f32 v182, v156, v157
    v_mfma_f32_16x16x32_bf16 v[124:127], a[164:167], v[240:243], v[124:127]
    ds_read_b128 a[188:191], v25 offset:18688
    v_cvt_pk_bf16_f32 v183, v158, v159
    v_mfma_f32_16x16x32_bf16 v[132:135], a[164:167], v[248:251], v[132:135]
    buffer_load_dwordx4 v19, s[16:19], s28 offen offset:2048 nt lds
    s_waitcnt lgkmcnt(4)
    v_mfma_f32_16x16x32_bf16 v[140:143], a[168:171], v[112:115], v[212:215]
    s_add_u32 s28, s28, 12288
    ds_read_b64_tr_b16 a[160:161], v28 offset:24576
    v_mfma_f32_16x16x32_bf16 v[148:151], a[168:171], v[120:123], v[220:223]
    s_add_u32 m0, s29, 86016
    ds_read_b64_tr_b16 a[162:163], v28 offset:30720
    v_mfma_f32_16x16x32_bf16 v[156:159], a[168:171], v[128:131], v[228:231]
    s_add_u32 s34, s80, 188160
    s_cmp_eq_u32 s31, 3
    s_cselect_b32 s34, s34, 0x7ff00000
    v_mfma_f32_16x16x32_bf16 v[140:143], a[172:175], v[136:139], v[140:143]
    ds_read_b64_tr_b16 a[164:165], v31 offset:24576
    v_mfma_f32_16x16x32_bf16 v[148:151], a[172:175], v[144:147], v[148:151]
    ds_read_b64_tr_b16 a[166:167], v31 offset:30720
    v_mfma_f32_16x16x32_bf16 v[156:159], a[172:175], v[152:155], v[156:159]
    buffer_load_dword v103, v100, s[68:71], s34 offen
    s_waitcnt lgkmcnt(6)
    v_mfma_f32_16x16x32_bf16 v[140:143], a[176:179], v[160:163], v[140:143]
    ds_read_b64_tr_b16 a[168:169], v34 offset:24576
    v_mfma_f32_16x16x32_bf16 v[148:151], a[176:179], v[168:171], v[148:151]
    ds_read_b64_tr_b16 a[170:171], v34 offset:30720
    v_mfma_f32_16x16x32_bf16 v[156:159], a[176:179], v[176:179], v[156:159]
    buffer_load_dwordx4 v14, s[12:15], s27 offen nt lds
    v_mfma_f32_16x16x32_bf16 v[140:143], a[180:183], v[184:187], v[140:143]
    ds_read_b64_tr_b16 a[172:173], v37 offset:24576
    v_mfma_f32_16x16x32_bf16 v[148:151], a[180:183], v[192:195], v[148:151]
    ds_read_b64_tr_b16 a[174:175], v37 offset:30720
    v_mfma_f32_16x16x32_bf16 v[156:159], a[180:183], v[200:203], v[156:159]
    s_waitcnt lgkmcnt(8)
    v_mfma_f32_16x16x32_bf16 v[140:143], a[184:187], v[208:211], v[140:143]
    ds_read_b64_tr_b16 a[176:177], v28 offset:24704
    v_mfma_f32_16x16x32_bf16 v[148:151], a[184:187], v[216:219], v[148:151]
    ds_read_b64_tr_b16 a[178:179], v28 offset:30848
    v_mfma_f32_16x16x32_bf16 v[156:159], a[184:187], v[224:227], v[156:159]
    buffer_load_dwordx4 v15, s[12:15], s27 offen offset:1024 nt lds
    v_mfma_f32_16x16x32_bf16 v[140:143], a[188:191], v[232:235], v[140:143]
    ds_read_b64_tr_b16 a[180:181], v31 offset:24704
    v_mfma_f32_16x16x32_bf16 v[148:151], a[188:191], v[240:243], v[148:151]
    ds_read_b64_tr_b16 a[182:183], v31 offset:30848
    v_mfma_f32_16x16x32_bf16 v[156:159], a[188:191], v[248:251], v[156:159]
    s_waitcnt lgkmcnt(8)
    v_mfma_f32_16x16x32_bf16 a[0:3], a[160:163], v[164:167], a[0:3]
    ds_read_b64_tr_b16 a[184:185], v34 offset:24704
    v_mfma_f32_16x16x32_bf16 a[4:7], a[160:163], v[172:175], a[4:7]
    ds_read_b64_tr_b16 a[186:187], v34 offset:30848
    v_mfma_f32_16x16x32_bf16 a[8:11], a[160:163], v[180:183], a[8:11]
    v_exp_f32 v116, v116
    v_mfma_f32_16x16x32_bf16 a[12:15], a[164:167], v[164:167], a[12:15]
    ds_read_b64_tr_b16 a[188:189], v37 offset:24704
    v_mfma_f32_16x16x32_bf16 a[16:19], a[164:167], v[172:175], a[16:19]
    ds_read_b64_tr_b16 a[190:191], v37 offset:30848
    v_mfma_f32_16x16x32_bf16 a[20:23], a[164:167], v[180:183], a[20:23]
    buffer_load_dwordx4 v16, s[12:15], s27 offen offset:2048 nt lds
    s_waitcnt lgkmcnt(8)
    v_mfma_f32_16x16x32_bf16 a[24:27], a[168:171], v[164:167], a[24:27]
    ds_read_b64_tr_b16 a[160:161], v28 offset:24832
    v_mfma_f32_16x16x32_bf16 a[28:31], a[168:171], v[172:175], a[28:31]
    ds_read_b64_tr_b16 a[162:163], v28 offset:30976
    v_mfma_f32_16x16x32_bf16 a[32:35], a[168:171], v[180:183], a[32:35]
    v_exp_f32 v117, v117
    v_mfma_f32_16x16x32_bf16 a[36:39], a[172:175], v[164:167], a[36:39]
    ds_read_b64_tr_b16 a[164:165], v31 offset:24832
    v_cvt_pk_bf16_f32 v188, v116, v117
    v_mfma_f32_16x16x32_bf16 a[40:43], a[172:175], v[172:175], a[40:43]
    s_add_u32 s27, s27, 12288
    ds_read_b64_tr_b16 a[166:167], v31 offset:30976
    v_mfma_f32_16x16x32_bf16 a[44:47], a[172:175], v[180:183], a[44:47]
    s_waitcnt lgkmcnt(8)
    v_mfma_f32_16x16x32_bf16 a[48:51], a[176:179], v[164:167], a[48:51]
    ds_read_b64_tr_b16 a[168:169], v34 offset:24832
    v_mfma_f32_16x16x32_bf16 a[52:55], a[176:179], v[172:175], a[52:55]
    ds_read_b64_tr_b16 a[170:171], v34 offset:30976
    v_mfma_f32_16x16x32_bf16 a[56:59], a[176:179], v[180:183], a[56:59]
    v_exp_f32 v118, v118
    v_mfma_f32_16x16x32_bf16 a[60:63], a[180:183], v[164:167], a[60:63]
    ds_read_b64_tr_b16 a[172:173], v37 offset:24832
    v_mfma_f32_16x16x32_bf16 a[64:67], a[180:183], v[172:175], a[64:67]
    ds_read_b64_tr_b16 a[174:175], v37 offset:30976
    v_mfma_f32_16x16x32_bf16 a[68:71], a[180:183], v[180:183], a[68:71]
    v_exp_f32 v119, v119
    v_mfma_f32_16x16x32_bf16 a[144:147], a[156:159], v[164:167], a[144:147]
    v_exp_f32 v124, v124
    v_mfma_f32_16x16x32_bf16 a[148:151], a[156:159], v[172:175], a[148:151]
    v_exp_f32 v125, v125
    v_mfma_f32_16x16x32_bf16 a[152:155], a[156:159], v[180:183], a[152:155]
    s_waitcnt vmcnt(25)
    s_barrier
    s_waitcnt lgkmcnt(8)
    v_mfma_f32_16x16x32_bf16 a[72:75], a[184:187], v[164:167], a[72:75]
    ds_read_b128 a[176:179], v22 offset:36864
    v_cvt_pk_bf16_f32 v189, v118, v119
    v_mfma_f32_16x16x32_bf16 a[76:79], a[184:187], v[172:175], a[76:79]
    s_add_u32 m0, s29, 98304
    v_exp_f32 v126, v126
    v_mfma_f32_16x16x32_bf16 a[80:83], a[184:187], v[180:183], a[80:83]
    v_exp_f32 v127, v127
    v_mfma_f32_16x16x32_bf16 a[84:87], a[188:191], v[164:167], a[84:87]
    ds_read_b128 a[180:183], v25 offset:36864
    v_cvt_pk_bf16_f32 v196, v124, v125
    v_mfma_f32_16x16x32_bf16 a[88:91], a[188:191], v[172:175], a[88:91]
    v_exp_f32 v132, v132
    v_mfma_f32_16x16x32_bf16 a[92:95], a[188:191], v[180:183], a[92:95]
    v_cvt_pk_bf16_f32 v197, v126, v127
    s_waitcnt lgkmcnt(6)
    v_mfma_f32_16x16x32_bf16 a[96:99], a[160:163], v[164:167], a[96:99]
    ds_read_b128 a[184:187], v22 offset:36992
    v_mfma_f32_16x16x32_bf16 a[100:103], a[160:163], v[172:175], a[100:103]
    v_exp_f32 v133, v133
    v_mfma_f32_16x16x32_bf16 a[104:107], a[160:163], v[180:183], a[104:107]
    v_exp_f32 v134, v134
    v_mfma_f32_16x16x32_bf16 a[108:111], a[164:167], v[164:167], a[108:111]
    ds_read_b128 a[188:191], v25 offset:36992
    v_cvt_pk_bf16_f32 v204, v132, v133
    v_mfma_f32_16x16x32_bf16 a[112:115], a[164:167], v[172:175], a[112:115]
    v_exp_f32 v135, v135
    v_mfma_f32_16x16x32_bf16 a[116:119], a[164:167], v[180:183], a[116:119]
    v_cvt_pk_bf16_f32 v205, v134, v135
    s_waitcnt lgkmcnt(4)
    v_mfma_f32_16x16x32_bf16 a[120:123], a[168:171], v[164:167], a[120:123]
    ds_read_b128 a[160:163], v22 offset:37120
    v_mfma_f32_16x16x32_bf16 a[124:127], a[168:171], v[172:175], a[124:127]
    v_exp_f32 v140, v140
    v_mfma_f32_16x16x32_bf16 a[128:131], a[168:171], v[180:183], a[128:131]
    v_exp_f32 v141, v141
    v_mfma_f32_16x16x32_bf16 a[132:135], a[172:175], v[164:167], a[132:135]
    ds_read_b128 a[164:167], v25 offset:37120
    v_cvt_pk_bf16_f32 v190, v140, v141
    v_mfma_f32_16x16x32_bf16 a[136:139], a[172:175], v[172:175], a[136:139]
    v_exp_f32 v142, v142
    v_mfma_f32_16x16x32_bf16 a[140:143], a[172:175], v[180:183], a[140:143]
    buffer_load_dwordx4 v17, s[16:19], s28 offen nt lds
    s_waitcnt lgkmcnt(4)
    v_mfma_f32_16x16x32_bf16 v[116:119], a[176:179], v[112:115], v[212:215]
    ds_read_b128 a[168:171], v22 offset:43008
    v_mfma_f32_16x16x32_bf16 v[124:127], a[176:179], v[120:123], v[220:223]
    v_exp_f32 v143, v143
    v_mfma_f32_16x16x32_bf16 v[132:135], a[176:179], v[128:131], v[228:231]
    v_exp_f32 v148, v148
    v_mfma_f32_16x16x32_bf16 v[116:119], a[180:183], v[136:139], v[116:119]
    ds_read_b128 a[172:175], v25 offset:43008
    v_cvt_pk_bf16_f32 v191, v142, v143
    v_mfma_f32_16x16x32_bf16 v[124:127], a[180:183], v[144:147], v[124:127]
    v_exp_f32 v149, v149
    v_mfma_f32_16x16x32_bf16 v[132:135], a[180:183], v[152:155], v[132:135]
    v_cvt_pk_bf16_f32 v198, v148, v149
    s_waitcnt lgkmcnt(4)
    v_mfma_f32_16x16x32_bf16 v[116:119], a[184:187], v[160:163], v[116:119]
    ds_read_b128 a[176:179], v22 offset:43136
    v_mfma_f32_16x16x32_bf16 v[124:127], a[184:187], v[168:171], v[124:127]
    v_exp_f32 v150, v150
    v_mfma_f32_16x16x32_bf16 v[132:135], a[184:187], v[176:179], v[132:135]
    v_exp_f32 v151, v151
    v_mfma_f32_16x16x32_bf16 v[116:119], a[188:191], v[184:187], v[116:119]
    ds_read_b128 a[180:183], v25 offset:43136
    v_cvt_pk_bf16_f32 v199, v150, v151
    v_mfma_f32_16x16x32_bf16 v[124:127], a[188:191], v[192:195], v[124:127]
    v_exp_f32 v156, v156
    v_mfma_f32_16x16x32_bf16 v[132:135], a[188:191], v[200:203], v[132:135]
    buffer_load_dwordx4 v18, s[16:19], s28 offen offset:1024 nt lds
    s_waitcnt lgkmcnt(4)
    v_mfma_f32_16x16x32_bf16 v[116:119], a[160:163], v[208:211], v[116:119]
    v_exp_f32 v157, v157
    v_mfma_f32_16x16x32_bf16 v[124:127], a[160:163], v[216:219], v[124:127]
    v_exp_f32 v158, v158
    v_mfma_f32_16x16x32_bf16 v[132:135], a[160:163], v[224:227], v[132:135]
    v_exp_f32 v159, v159
    v_mfma_f32_16x16x32_bf16 v[116:119], a[164:167], v[232:235], v[116:119]
    ds_read_b128 a[184:187], v22 offset:43264
    v_cvt_pk_bf16_f32 v206, v156, v157
    v_mfma_f32_16x16x32_bf16 v[124:127], a[164:167], v[240:243], v[124:127]
    ds_read_b128 a[188:191], v25 offset:43264
    v_cvt_pk_bf16_f32 v207, v158, v159
    v_mfma_f32_16x16x32_bf16 v[132:135], a[164:167], v[248:251], v[132:135]
    buffer_load_dwordx4 v19, s[16:19], s28 offen offset:2048 nt lds
    s_waitcnt lgkmcnt(4)
    v_mfma_f32_16x16x32_bf16 v[140:143], a[168:171], v[112:115], v[212:215]
    s_add_u32 s28, s28, 12288
    ds_read_b64_tr_b16 a[160:161], v26 offset:0
    v_mfma_f32_16x16x32_bf16 v[148:151], a[168:171], v[120:123], v[220:223]
    s_add_u32 m0, s29, 110592
    ds_read_b64_tr_b16 a[162:163], v26 offset:6144
    v_mfma_f32_16x16x32_bf16 v[156:159], a[168:171], v[128:131], v[228:231]
    s_add_u32 s34, s80, 215040
    s_cmp_eq_u32 s31, 0
    s_cselect_b32 s34, s34, 0x7ff00000
    v_mfma_f32_16x16x32_bf16 v[140:143], a[172:175], v[136:139], v[140:143]
    ds_read_b64_tr_b16 a[164:165], v29 offset:0
    v_mfma_f32_16x16x32_bf16 v[148:151], a[172:175], v[144:147], v[148:151]
    ds_read_b64_tr_b16 a[166:167], v29 offset:6144
    v_mfma_f32_16x16x32_bf16 v[156:159], a[172:175], v[152:155], v[156:159]
    buffer_load_dword v103, v100, s[68:71], s34 offen
    s_waitcnt lgkmcnt(6)
    v_mfma_f32_16x16x32_bf16 v[140:143], a[176:179], v[160:163], v[140:143]
    ds_read_b64_tr_b16 a[168:169], v32 offset:0
    v_mfma_f32_16x16x32_bf16 v[148:151], a[176:179], v[168:171], v[148:151]
    ds_read_b64_tr_b16 a[170:171], v32 offset:6144
    v_mfma_f32_16x16x32_bf16 v[156:159], a[176:179], v[176:179], v[156:159]
    buffer_load_dwordx4 v14, s[12:15], s27 offen nt lds
    v_mfma_f32_16x16x32_bf16 v[140:143], a[180:183], v[184:187], v[140:143]
    ds_read_b64_tr_b16 a[172:173], v35 offset:0
    v_mfma_f32_16x16x32_bf16 v[148:151], a[180:183], v[192:195], v[148:151]
    ds_read_b64_tr_b16 a[174:175], v35 offset:6144
    v_mfma_f32_16x16x32_bf16 v[156:159], a[180:183], v[200:203], v[156:159]
    s_waitcnt lgkmcnt(8)
    v_mfma_f32_16x16x32_bf16 v[140:143], a[184:187], v[208:211], v[140:143]
    ds_read_b64_tr_b16 a[176:177], v26 offset:128
    v_mfma_f32_16x16x32_bf16 v[148:151], a[184:187], v[216:219], v[148:151]
    ds_read_b64_tr_b16 a[178:179], v26 offset:6272
    v_mfma_f32_16x16x32_bf16 v[156:159], a[184:187], v[224:227], v[156:159]
    buffer_load_dwordx4 v15, s[12:15], s27 offen offset:1024 nt lds
    v_mfma_f32_16x16x32_bf16 v[140:143], a[188:191], v[232:235], v[140:143]
    ds_read_b64_tr_b16 a[180:181], v29 offset:128
    v_mfma_f32_16x16x32_bf16 v[148:151], a[188:191], v[240:243], v[148:151]
    ds_read_b64_tr_b16 a[182:183], v29 offset:6272
    v_mfma_f32_16x16x32_bf16 v[156:159], a[188:191], v[248:251], v[156:159]
    s_waitcnt lgkmcnt(8)
    v_mfma_f32_16x16x32_bf16 a[0:3], a[160:163], v[188:191], a[0:3]
    ds_read_b64_tr_b16 a[184:185], v32 offset:128
    v_mfma_f32_16x16x32_bf16 a[4:7], a[160:163], v[196:199], a[4:7]
    ds_read_b64_tr_b16 a[186:187], v32 offset:6272
    v_mfma_f32_16x16x32_bf16 a[8:11], a[160:163], v[204:207], a[8:11]
    v_exp_f32 v116, v116
    v_mfma_f32_16x16x32_bf16 a[12:15], a[164:167], v[188:191], a[12:15]
    ds_read_b64_tr_b16 a[188:189], v35 offset:128
    v_mfma_f32_16x16x32_bf16 a[16:19], a[164:167], v[196:199], a[16:19]
    ds_read_b64_tr_b16 a[190:191], v35 offset:6272
    v_mfma_f32_16x16x32_bf16 a[20:23], a[164:167], v[204:207], a[20:23]
    buffer_load_dwordx4 v16, s[12:15], s27 offen offset:2048 nt lds
    s_waitcnt lgkmcnt(8)
    v_mfma_f32_16x16x32_bf16 a[24:27], a[168:171], v[188:191], a[24:27]
    ds_read_b64_tr_b16 a[160:161], v26 offset:256
    v_mfma_f32_16x16x32_bf16 a[28:31], a[168:171], v[196:199], a[28:31]
    ds_read_b64_tr_b16 a[162:163], v26 offset:6400
    v_mfma_f32_16x16x32_bf16 a[32:35], a[168:171], v[204:207], a[32:35]
    v_exp_f32 v117, v117
    v_mfma_f32_16x16x32_bf16 a[36:39], a[172:175], v[188:191], a[36:39]
    ds_read_b64_tr_b16 a[164:165], v29 offset:256
    v_cvt_pk_bf16_f32 v164, v116, v117
    v_mfma_f32_16x16x32_bf16 a[40:43], a[172:175], v[196:199], a[40:43]
    s_add_u32 s27, s27, 12288
    ds_read_b64_tr_b16 a[166:167], v29 offset:6400
    v_mfma_f32_16x16x32_bf16 a[44:47], a[172:175], v[204:207], a[44:47]
    s_waitcnt lgkmcnt(8)
    v_mfma_f32_16x16x32_bf16 a[48:51], a[176:179], v[188:191], a[48:51]
    ds_read_b64_tr_b16 a[168:169], v32 offset:256
    v_mfma_f32_16x16x32_bf16 a[52:55], a[176:179], v[196:199], a[52:55]
    ds_read_b64_tr_b16 a[170:171], v32 offset:6400
    v_mfma_f32_16x16x32_bf16 a[56:59], a[176:179], v[204:207], a[56:59]
    v_exp_f32 v118, v118
    v_mfma_f32_16x16x32_bf16 a[60:63], a[180:183], v[188:191], a[60:63]
    ds_read_b64_tr_b16 a[172:173], v35 offset:256
    v_mfma_f32_16x16x32_bf16 a[64:67], a[180:183], v[196:199], a[64:67]
    ds_read_b64_tr_b16 a[174:175], v35 offset:6400
    v_mfma_f32_16x16x32_bf16 a[68:71], a[180:183], v[204:207], a[68:71]
    v_exp_f32 v119, v119
    v_mfma_f32_16x16x32_bf16 a[144:147], a[156:159], v[188:191], a[144:147]
    v_exp_f32 v124, v124
    v_mfma_f32_16x16x32_bf16 a[148:151], a[156:159], v[196:199], a[148:151]
    v_exp_f32 v125, v125
    v_mfma_f32_16x16x32_bf16 a[152:155], a[156:159], v[204:207], a[152:155]
    s_waitcnt vmcnt(25)
    s_barrier
    s_waitcnt lgkmcnt(8)
    v_mfma_f32_16x16x32_bf16 a[72:75], a[184:187], v[188:191], a[72:75]
    ds_read_b128 a[176:179], v20 offset:12288
    v_cvt_pk_bf16_f32 v165, v118, v119
    v_mfma_f32_16x16x32_bf16 a[76:79], a[184:187], v[196:199], a[76:79]
    s_add_u32 m0, s29, 122880
    v_exp_f32 v126, v126
    v_mfma_f32_16x16x32_bf16 a[80:83], a[184:187], v[204:207], a[80:83]
    v_exp_f32 v127, v127
    v_mfma_f32_16x16x32_bf16 a[84:87], a[188:191], v[188:191], a[84:87]
    ds_read_b128 a[180:183], v23 offset:12288
    v_cvt_pk_bf16_f32 v172, v124, v125
    v_mfma_f32_16x16x32_bf16 a[88:91], a[188:191], v[196:199], a[88:91]
    v_exp_f32 v132, v132
    v_mfma_f32_16x16x32_bf16 a[92:95], a[188:191], v[204:207], a[92:95]
    v_cvt_pk_bf16_f32 v173, v126, v127
    s_waitcnt lgkmcnt(6)
    v_mfma_f32_16x16x32_bf16 a[96:99], a[160:163], v[188:191], a[96:99]
    ds_read_b128 a[184:187], v20 offset:12416
    v_mfma_f32_16x16x32_bf16 a[100:103], a[160:163], v[196:199], a[100:103]
    v_exp_f32 v133, v133
    v_mfma_f32_16x16x32_bf16 a[104:107], a[160:163], v[204:207], a[104:107]
    v_exp_f32 v134, v134
    v_mfma_f32_16x16x32_bf16 a[108:111], a[164:167], v[188:191], a[108:111]
    ds_read_b128 a[188:191], v23 offset:12416
    v_cvt_pk_bf16_f32 v180, v132, v133
    v_mfma_f32_16x16x32_bf16 a[112:115], a[164:167], v[196:199], a[112:115]
    v_exp_f32 v135, v135
    v_mfma_f32_16x16x32_bf16 a[116:119], a[164:167], v[204:207], a[116:119]
    v_cvt_pk_bf16_f32 v181, v134, v135
    s_waitcnt lgkmcnt(4)
    v_mfma_f32_16x16x32_bf16 a[120:123], a[168:171], v[188:191], a[120:123]
    ds_read_b128 a[160:163], v20 offset:12544
    v_mfma_f32_16x16x32_bf16 a[124:127], a[168:171], v[196:199], a[124:127]
    v_exp_f32 v140, v140
    v_mfma_f32_16x16x32_bf16 a[128:131], a[168:171], v[204:207], a[128:131]
    v_exp_f32 v141, v141
    v_mfma_f32_16x16x32_bf16 a[132:135], a[172:175], v[188:191], a[132:135]
    ds_read_b128 a[164:167], v23 offset:12544
    v_cvt_pk_bf16_f32 v166, v140, v141
    v_mfma_f32_16x16x32_bf16 a[136:139], a[172:175], v[196:199], a[136:139]
    v_exp_f32 v142, v142
    v_mfma_f32_16x16x32_bf16 a[140:143], a[172:175], v[204:207], a[140:143]
    buffer_load_dwordx4 v17, s[16:19], s28 offen nt lds
    s_waitcnt lgkmcnt(4)
    v_mfma_f32_16x16x32_bf16 v[116:119], a[176:179], v[112:115], v[212:215]
    ds_read_b128 a[168:171], v20 offset:18432
    v_mfma_f32_16x16x32_bf16 v[124:127], a[176:179], v[120:123], v[220:223]
    v_exp_f32 v143, v143
    v_mfma_f32_16x16x32_bf16 v[132:135], a[176:179], v[128:131], v[228:231]
    v_exp_f32 v148, v148
    v_mfma_f32_16x16x32_bf16 v[116:119], a[180:183], v[136:139], v[116:119]
    ds_read_b128 a[172:175], v23 offset:18432
    v_cvt_pk_bf16_f32 v167, v142, v143
    v_mfma_f32_16x16x32_bf16 v[124:127], a[180:183], v[144:147], v[124:127]
    v_exp_f32 v149, v149
    v_mfma_f32_16x16x32_bf16 v[132:135], a[180:183], v[152:155], v[132:135]
    v_cvt_pk_bf16_f32 v174, v148, v149
    s_waitcnt lgkmcnt(4)
    v_mfma_f32_16x16x32_bf16 v[116:119], a[184:187], v[160:163], v[116:119]
    ds_read_b128 a[176:179], v20 offset:18560
    v_mfma_f32_16x16x32_bf16 v[124:127], a[184:187], v[168:171], v[124:127]
    v_exp_f32 v150, v150
    v_mfma_f32_16x16x32_bf16 v[132:135], a[184:187], v[176:179], v[132:135]
    v_exp_f32 v151, v151
    v_mfma_f32_16x16x32_bf16 v[116:119], a[188:191], v[184:187], v[116:119]
    ds_read_b128 a[180:183], v23 offset:18560
    v_cvt_pk_bf16_f32 v175, v150, v151
    v_mfma_f32_16x16x32_bf16 v[124:127], a[188:191], v[192:195], v[124:127]
    v_exp_f32 v156, v156
    v_mfma_f32_16x16x32_bf16 v[132:135], a[188:191], v[200:203], v[132:135]
    buffer_load_dwordx4 v18, s[16:19], s28 offen offset:1024 nt lds
    s_waitcnt lgkmcnt(4)
    v_mfma_f32_16x16x32_bf16 v[116:119], a[160:163], v[208:211], v[116:119]
    v_exp_f32 v157, v157
    v_mfma_f32_16x16x32_bf16 v[124:127], a[160:163], v[216:219], v[124:127]
    v_exp_f32 v158, v158
    v_mfma_f32_16x16x32_bf16 v[132:135], a[160:163], v[224:227], v[132:135]
    v_exp_f32 v159, v159
    v_mfma_f32_16x16x32_bf16 v[116:119], a[164:167], v[232:235], v[116:119]
    ds_read_b128 a[184:187], v20 offset:18688
    v_cvt_pk_bf16_f32 v182, v156, v157
    v_mfma_f32_16x16x32_bf16 v[124:127], a[164:167], v[240:243], v[124:127]
    ds_read_b128 a[188:191], v23 offset:18688
    v_cvt_pk_bf16_f32 v183, v158, v159
    v_mfma_f32_16x16x32_bf16 v[132:135], a[164:167], v[248:251], v[132:135]
    buffer_load_dwordx4 v19, s[16:19], s28 offen offset:2048 nt lds
    s_waitcnt lgkmcnt(4)
    v_mfma_f32_16x16x32_bf16 v[140:143], a[168:171], v[112:115], v[212:215]
    s_add_u32 s28, s28, 12288
    ds_read_b64_tr_b16 a[160:161], v26 offset:24576
    v_mfma_f32_16x16x32_bf16 v[148:151], a[168:171], v[120:123], v[220:223]
    s_add_u32 m0, s29, 135168
    ds_read_b64_tr_b16 a[162:163], v26 offset:30720
    v_mfma_f32_16x16x32_bf16 v[156:159], a[168:171], v[128:131], v[228:231]
    s_add_u32 s34, s80, 241920
    s_cmp_eq_u32 s31, 1
    s_cselect_b32 s34, s34, 0x7ff00000
    v_mfma_f32_16x16x32_bf16 v[140:143], a[172:175], v[136:139], v[140:143]
    ds_read_b64_tr_b16 a[164:165], v29 offset:24576
    v_mfma_f32_16x16x32_bf16 v[148:151], a[172:175], v[144:147], v[148:151]
    ds_read_b64_tr_b16 a[166:167], v29 offset:30720
    v_mfma_f32_16x16x32_bf16 v[156:159], a[172:175], v[152:155], v[156:159]
    buffer_load_dword v103, v100, s[68:71], s34 offen
    s_waitcnt lgkmcnt(6)
    v_mfma_f32_16x16x32_bf16 v[140:143], a[176:179], v[160:163], v[140:143]
    ds_read_b64_tr_b16 a[168:169], v32 offset:24576
    v_mfma_f32_16x16x32_bf16 v[148:151], a[176:179], v[168:171], v[148:151]
    ds_read_b64_tr_b16 a[170:171], v32 offset:30720
    v_mfma_f32_16x16x32_bf16 v[156:159], a[176:179], v[176:179], v[156:159]
    buffer_load_dwordx4 v17, s[16:19], s28 offen nt lds
    v_mfma_f32_16x16x32_bf16 v[140:143], a[180:183], v[184:187], v[140:143]
    ds_read_b64_tr_b16 a[172:173], v35 offset:24576
    v_mfma_f32_16x16x32_bf16 v[148:151], a[180:183], v[192:195], v[148:151]
    ds_read_b64_tr_b16 a[174:175], v35 offset:30720
    v_mfma_f32_16x16x32_bf16 v[156:159], a[180:183], v[200:203], v[156:159]
    s_waitcnt lgkmcnt(8)
    v_mfma_f32_16x16x32_bf16 v[140:143], a[184:187], v[208:211], v[140:143]
    ds_read_b64_tr_b16 a[176:177], v26 offset:24704
    v_mfma_f32_16x16x32_bf16 v[148:151], a[184:187], v[216:219], v[148:151]
    ds_read_b64_tr_b16 a[178:179], v26 offset:30848
    v_mfma_f32_16x16x32_bf16 v[156:159], a[184:187], v[224:227], v[156:159]
    buffer_load_dwordx4 v18, s[16:19], s28 offen offset:1024 nt lds
    v_mfma_f32_16x16x32_bf16 v[140:143], a[188:191], v[232:235], v[140:143]
    ds_read_b64_tr_b16 a[180:181], v29 offset:24704
    v_mfma_f32_16x16x32_bf16 v[148:151], a[188:191], v[240:243], v[148:151]
    ds_read_b64_tr_b16 a[182:183], v29 offset:30848
    v_mfma_f32_16x16x32_bf16 v[156:159], a[188:191], v[248:251], v[156:159]
    s_waitcnt lgkmcnt(8)
    v_mfma_f32_16x16x32_bf16 a[0:3], a[160:163], v[164:167], a[0:3]
    ds_read_b64_tr_b16 a[184:185], v32 offset:24704
    v_mfma_f32_16x16x32_bf16 a[4:7], a[160:163], v[172:175], a[4:7]
    ds_read_b64_tr_b16 a[186:187], v32 offset:30848
    v_mfma_f32_16x16x32_bf16 a[8:11], a[160:163], v[180:183], a[8:11]
    v_exp_f32 v116, v116
    v_mfma_f32_16x16x32_bf16 a[12:15], a[164:167], v[164:167], a[12:15]
    ds_read_b64_tr_b16 a[188:189], v35 offset:24704
    v_mfma_f32_16x16x32_bf16 a[16:19], a[164:167], v[172:175], a[16:19]
    ds_read_b64_tr_b16 a[190:191], v35 offset:30848
    v_mfma_f32_16x16x32_bf16 a[20:23], a[164:167], v[180:183], a[20:23]
    buffer_load_dwordx4 v19, s[16:19], s28 offen offset:2048 nt lds
    s_waitcnt lgkmcnt(8)
    v_mfma_f32_16x16x32_bf16 a[24:27], a[168:171], v[164:167], a[24:27]
    ds_read_b64_tr_b16 a[160:161], v26 offset:24832
    v_mfma_f32_16x16x32_bf16 a[28:31], a[168:171], v[172:175], a[28:31]
    ds_read_b64_tr_b16 a[162:163], v26 offset:30976
    v_mfma_f32_16x16x32_bf16 a[32:35], a[168:171], v[180:183], a[32:35]
    v_exp_f32 v117, v117
    v_mfma_f32_16x16x32_bf16 a[36:39], a[172:175], v[164:167], a[36:39]
    ds_read_b64_tr_b16 a[164:165], v29 offset:24832
    v_cvt_pk_bf16_f32 v188, v116, v117
    v_mfma_f32_16x16x32_bf16 a[40:43], a[172:175], v[172:175], a[40:43]
    s_add_u32 s28, s28, 12288
    ds_read_b64_tr_b16 a[166:167], v29 offset:30976
    v_mfma_f32_16x16x32_bf16 a[44:47], a[172:175], v[180:183], a[44:47]
    s_waitcnt lgkmcnt(8)
    v_mfma_f32_16x16x32_bf16 a[48:51], a[176:179], v[164:167], a[48:51]
    ds_read_b64_tr_b16 a[168:169], v32 offset:24832
    v_mfma_f32_16x16x32_bf16 a[52:55], a[176:179], v[172:175], a[52:55]
    ds_read_b64_tr_b16 a[170:171], v32 offset:30976
    v_mfma_f32_16x16x32_bf16 a[56:59], a[176:179], v[180:183], a[56:59]
    v_exp_f32 v118, v118
    v_mfma_f32_16x16x32_bf16 a[60:63], a[180:183], v[164:167], a[60:63]
    ds_read_b64_tr_b16 a[172:173], v35 offset:24832
    v_mfma_f32_16x16x32_bf16 a[64:67], a[180:183], v[172:175], a[64:67]
    ds_read_b64_tr_b16 a[174:175], v35 offset:30976
    v_mfma_f32_16x16x32_bf16 a[68:71], a[180:183], v[180:183], a[68:71]
    v_exp_f32 v119, v119
    v_mfma_f32_16x16x32_bf16 a[144:147], a[156:159], v[164:167], a[144:147]
    v_exp_f32 v124, v124
    v_mfma_f32_16x16x32_bf16 a[148:151], a[156:159], v[172:175], a[148:151]
    v_exp_f32 v125, v125
    v_mfma_f32_16x16x32_bf16 a[152:155], a[156:159], v[180:183], a[152:155]
    s_waitcnt vmcnt(25)
    s_barrier
    s_waitcnt lgkmcnt(8)
    v_mfma_f32_16x16x32_bf16 a[72:75], a[184:187], v[164:167], a[72:75]
    ds_read_b128 a[176:179], v20 offset:36864
    v_cvt_pk_bf16_f32 v189, v118, v119
    v_mfma_f32_16x16x32_bf16 a[76:79], a[184:187], v[172:175], a[76:79]
    v_exp_f32 v126, v126
    v_mfma_f32_16x16x32_bf16 a[80:83], a[184:187], v[180:183], a[80:83]
    v_exp_f32 v127, v127
    v_mfma_f32_16x16x32_bf16 a[84:87], a[188:191], v[164:167], a[84:87]
    ds_read_b128 a[180:183], v23 offset:36864
    v_cvt_pk_bf16_f32 v196, v124, v125
    v_mfma_f32_16x16x32_bf16 a[88:91], a[188:191], v[172:175], a[88:91]
    v_exp_f32 v132, v132
    v_mfma_f32_16x16x32_bf16 a[92:95], a[188:191], v[180:183], a[92:95]
    v_cvt_pk_bf16_f32 v197, v126, v127
    s_waitcnt lgkmcnt(6)
    v_mfma_f32_16x16x32_bf16 a[96:99], a[160:163], v[164:167], a[96:99]
    ds_read_b128 a[184:187], v20 offset:36992
    v_mfma_f32_16x16x32_bf16 a[100:103], a[160:163], v[172:175], a[100:103]
    v_exp_f32 v133, v133
    v_mfma_f32_16x16x32_bf16 a[104:107], a[160:163], v[180:183], a[104:107]
    v_exp_f32 v134, v134
    v_mfma_f32_16x16x32_bf16 a[108:111], a[164:167], v[164:167], a[108:111]
    ds_read_b128 a[188:191], v23 offset:36992
    v_cvt_pk_bf16_f32 v204, v132, v133
    v_mfma_f32_16x16x32_bf16 a[112:115], a[164:167], v[172:175], a[112:115]
    v_exp_f32 v135, v135
    v_mfma_f32_16x16x32_bf16 a[116:119], a[164:167], v[180:183], a[116:119]
    v_cvt_pk_bf16_f32 v205, v134, v135
    s_waitcnt lgkmcnt(4)
    v_mfma_f32_16x16x32_bf16 a[120:123], a[168:171], v[164:167], a[120:123]
    ds_read_b128 a[160:163], v20 offset:37120
    v_mfma_f32_16x16x32_bf16 a[124:127], a[168:171], v[172:175], a[124:127]
    v_exp_f32 v140, v140
    v_mfma_f32_16x16x32_bf16 a[128:131], a[168:171], v[180:183], a[128:131]
    v_exp_f32 v141, v141
    v_mfma_f32_16x16x32_bf16 a[132:135], a[172:175], v[164:167], a[132:135]
    ds_read_b128 a[164:167], v23 offset:37120
    v_cvt_pk_bf16_f32 v190, v140, v141
    v_mfma_f32_16x16x32_bf16 a[136:139], a[172:175], v[172:175], a[136:139]
    v_exp_f32 v142, v142
    v_mfma_f32_16x16x32_bf16 a[140:143], a[172:175], v[180:183], a[140:143]
    s_add_u32 s26, s26, 384
    s_add_u32 s25, s25, 384
    s_waitcnt lgkmcnt(4)
    v_mfma_f32_16x16x32_bf16 v[116:119], a[176:179], v[112:115], v[212:215]
    ds_read_b128 a[168:171], v20 offset:43008
    v_mfma_f32_16x16x32_bf16 v[124:127], a[176:179], v[120:123], v[220:223]
    v_exp_f32 v143, v143
    v_mfma_f32_16x16x32_bf16 v[132:135], a[176:179], v[128:131], v[228:231]
    v_exp_f32 v148, v148
    v_mfma_f32_16x16x32_bf16 v[116:119], a[180:183], v[136:139], v[116:119]
    ds_read_b128 a[172:175], v23 offset:43008
    v_cvt_pk_bf16_f32 v191, v142, v143
    v_mfma_f32_16x16x32_bf16 v[124:127], a[180:183], v[144:147], v[124:127]
    v_exp_f32 v149, v149
    v_mfma_f32_16x16x32_bf16 v[132:135], a[180:183], v[152:155], v[132:135]
    v_cvt_pk_bf16_f32 v198, v148, v149
    s_waitcnt lgkmcnt(4)
    v_mfma_f32_16x16x32_bf16 v[116:119], a[184:187], v[160:163], v[116:119]
    ds_read_b128 a[176:179], v20 offset:43136
    v_mfma_f32_16x16x32_bf16 v[124:127], a[184:187], v[168:171], v[124:127]
    v_exp_f32 v150, v150
    v_mfma_f32_16x16x32_bf16 v[132:135], a[184:187], v[176:179], v[132:135]
    v_exp_f32 v151, v151
    v_mfma_f32_16x16x32_bf16 v[116:119], a[188:191], v[184:187], v[116:119]
    ds_read_b128 a[180:183], v23 offset:43136
    v_cvt_pk_bf16_f32 v199, v150, v151
    v_mfma_f32_16x16x32_bf16 v[124:127], a[188:191], v[192:195], v[124:127]
    v_exp_f32 v156, v156
    v_mfma_f32_16x16x32_bf16 v[132:135], a[188:191], v[200:203], v[132:135]
    s_waitcnt lgkmcnt(4)
    v_mfma_f32_16x16x32_bf16 v[116:119], a[160:163], v[208:211], v[116:119]
    v_exp_f32 v157, v157
    v_mfma_f32_16x16x32_bf16 v[124:127], a[160:163], v[216:219], v[124:127]
    v_exp_f32 v158, v158
    v_mfma_f32_16x16x32_bf16 v[132:135], a[160:163], v[224:227], v[132:135]
    v_exp_f32 v159, v159
    v_mfma_f32_16x16x32_bf16 v[116:119], a[164:167], v[232:235], v[116:119]
    ds_read_b128 a[184:187], v20 offset:43264
    v_cvt_pk_bf16_f32 v206, v156, v157
    v_mfma_f32_16x16x32_bf16 v[124:127], a[164:167], v[240:243], v[124:127]
    ds_read_b128 a[188:191], v23 offset:43264
    v_cvt_pk_bf16_f32 v207, v158, v159
    v_mfma_f32_16x16x32_bf16 v[132:135], a[164:167], v[248:251], v[132:135]
    s_waitcnt lgkmcnt(4)
    v_mfma_f32_16x16x32_bf16 v[140:143], a[168:171], v[112:115], v[212:215]
    ds_read_b64_tr_b16 a[160:161], v27 offset:0
    v_mfma_f32_16x16x32_bf16 v[148:151], a[168:171], v[120:123], v[220:223]
    ds_read_b64_tr_b16 a[162:163], v27 offset:6144
    v_mfma_f32_16x16x32_bf16 v[156:159], a[168:171], v[128:131], v[228:231]
    s_cmp_eq_u32 s30, 0
    s_cselect_b32 s6, s6, 0
    s_cselect_b32 s10, s10, 0
    v_mfma_f32_16x16x32_bf16 v[140:143], a[172:175], v[136:139], v[140:143]
    s_add_u32 m0, s29, 0
    ds_read_b64_tr_b16 a[164:165], v30 offset:0
    v_mfma_f32_16x16x32_bf16 v[148:151], a[172:175], v[144:147], v[148:151]
    ds_read_b64_tr_b16 a[166:167], v30 offset:6144
    v_mfma_f32_16x16x32_bf16 v[156:159], a[172:175], v[152:155], v[156:159]
    buffer_load_dwordx4 v2, s[4:7], s24 offen lds
    s_waitcnt lgkmcnt(6)
    v_mfma_f32_16x16x32_bf16 v[140:143], a[176:179], v[160:163], v[140:143]
    ds_read_b64_tr_b16 a[168:169], v33 offset:0
    v_mfma_f32_16x16x32_bf16 v[148:151], a[176:179], v[168:171], v[148:151]
    ds_read_b64_tr_b16 a[170:171], v33 offset:6144
    v_mfma_f32_16x16x32_bf16 v[156:159], a[176:179], v[176:179], v[156:159]
    buffer_load_dwordx4 v3, s[4:7], s24 offen offset:1024 lds
    v_mfma_f32_16x16x32_bf16 v[140:143], a[180:183], v[184:187], v[140:143]
    ds_read_b64_tr_b16 a[172:173], v36 offset:0
    v_mfma_f32_16x16x32_bf16 v[148:151], a[180:183], v[192:195], v[148:151]
    ds_read_b64_tr_b16 a[174:175], v36 offset:6144
    v_mfma_f32_16x16x32_bf16 v[156:159], a[180:183], v[200:203], v[156:159]
    buffer_load_dwordx4 v4, s[4:7], s24 offen offset:2048 lds
    s_waitcnt lgkmcnt(8)
    v_mfma_f32_16x16x32_bf16 v[140:143], a[184:187], v[208:211], v[140:143]
    s_add_u32 m0, s29, 12288
    ds_read_b64_tr_b16 a[176:177], v27 offset:128
    v_mfma_f32_16x16x32_bf16 v[148:151], a[184:187], v[216:219], v[148:151]
    ds_read_b64_tr_b16 a[178:179], v27 offset:6272
    v_mfma_f32_16x16x32_bf16 v[156:159], a[184:187], v[224:227], v[156:159]
    buffer_load_dwordx4 v5, s[4:7], s24 offen lds
    v_mfma_f32_16x16x32_bf16 v[140:143], a[188:191], v[232:235], v[140:143]
    ds_read_b64_tr_b16 a[180:181], v30 offset:128
    v_mfma_f32_16x16x32_bf16 v[148:151], a[188:191], v[240:243], v[148:151]
    ds_read_b64_tr_b16 a[182:183], v30 offset:6272
    v_mfma_f32_16x16x32_bf16 v[156:159], a[188:191], v[248:251], v[156:159]
    s_waitcnt lgkmcnt(8)
    v_mfma_f32_16x16x32_bf16 a[0:3], a[160:163], v[188:191], a[0:3]
    ds_read_b64_tr_b16 a[184:185], v33 offset:128
    v_mfma_f32_16x16x32_bf16 a[4:7], a[160:163], v[196:199], a[4:7]
    ds_read_b64_tr_b16 a[186:187], v33 offset:6272
    v_mfma_f32_16x16x32_bf16 a[8:11], a[160:163], v[204:207], a[8:11]
    v_exp_f32 v116, v116
    v_mfma_f32_16x16x32_bf16 a[12:15], a[164:167], v[188:191], a[12:15]
    ds_read_b64_tr_b16 a[188:189], v36 offset:128
    v_mfma_f32_16x16x32_bf16 a[16:19], a[164:167], v[196:199], a[16:19]
    ds_read_b64_tr_b16 a[190:191], v36 offset:6272
    v_mfma_f32_16x16x32_bf16 a[20:23], a[164:167], v[204:207], a[20:23]
    buffer_load_dwordx4 v6, s[4:7], s24 offen offset:1024 lds
    s_waitcnt lgkmcnt(8)
    v_mfma_f32_16x16x32_bf16 a[24:27], a[168:171], v[188:191], a[24:27]
    ds_read_b64_tr_b16 a[160:161], v27 offset:256
    v_mfma_f32_16x16x32_bf16 a[28:31], a[168:171], v[196:199], a[28:31]
    ds_read_b64_tr_b16 a[162:163], v27 offset:6400
    v_mfma_f32_16x16x32_bf16 a[32:35], a[168:171], v[204:207], a[32:35]
    v_exp_f32 v117, v117
    v_mfma_f32_16x16x32_bf16 a[36:39], a[172:175], v[188:191], a[36:39]
    ds_read_b64_tr_b16 a[164:165], v30 offset:256
    v_cvt_pk_bf16_f32 v164, v116, v117
    v_mfma_f32_16x16x32_bf16 a[40:43], a[172:175], v[196:199], a[40:43]
    ds_read_b64_tr_b16 a[166:167], v30 offset:6400
    v_mfma_f32_16x16x32_bf16 a[44:47], a[172:175], v[204:207], a[44:47]
    buffer_load_dwordx4 v7, s[4:7], s24 offen offset:2048 lds
    s_waitcnt lgkmcnt(8)
    v_mfma_f32_16x16x32_bf16 a[48:51], a[176:179], v[188:191], a[48:51]
    ds_read_b64_tr_b16 a[168:169], v33 offset:256
    v_mfma_f32_16x16x32_bf16 a[52:55], a[176:179], v[196:199], a[52:55]
    ds_read_b64_tr_b16 a[170:171], v33 offset:6400
    v_mfma_f32_16x16x32_bf16 a[56:59], a[176:179], v[204:207], a[56:59]
    v_exp_f32 v118, v118
    v_mfma_f32_16x16x32_bf16 a[60:63], a[180:183], v[188:191], a[60:63]
    ds_read_b64_tr_b16 a[172:173], v36 offset:256
    v_mfma_f32_16x16x32_bf16 a[64:67], a[180:183], v[196:199], a[64:67]
    ds_read_b64_tr_b16 a[174:175], v36 offset:6400
    v_mfma_f32_16x16x32_bf16 a[68:71], a[180:183], v[204:207], a[68:71]
    v_exp_f32 v119, v119
    v_mfma_f32_16x16x32_bf16 a[144:147], a[156:159], v[188:191], a[144:147]
    v_exp_f32 v124, v124
    v_mfma_f32_16x16x32_bf16 a[148:151], a[156:159], v[196:199], a[148:151]
    v_exp_f32 v125, v125
    v_mfma_f32_16x16x32_bf16 a[152:155], a[156:159], v[204:207], a[152:155]
    s_waitcnt vmcnt(24)
    s_barrier
    s_waitcnt lgkmcnt(8)
    v_mfma_f32_16x16x32_bf16 a[72:75], a[184:187], v[188:191], a[72:75]
    ds_read_b128 a[176:179], v21 offset:12288
    v_cvt_pk_bf16_f32 v165, v118, v119
    v_mfma_f32_16x16x32_bf16 a[76:79], a[184:187], v[196:199], a[76:79]
    s_add_u32 m0, s29, 24576
    v_exp_f32 v126, v126
    v_mfma_f32_16x16x32_bf16 a[80:83], a[184:187], v[204:207], a[80:83]
    v_exp_f32 v127, v127
    v_mfma_f32_16x16x32_bf16 a[84:87], a[188:191], v[188:191], a[84:87]
    ds_read_b128 a[180:183], v24 offset:12288
    v_cvt_pk_bf16_f32 v172, v124, v125
    v_mfma_f32_16x16x32_bf16 a[88:91], a[188:191], v[196:199], a[88:91]
    v_exp_f32 v132, v132
    v_mfma_f32_16x16x32_bf16 a[92:95], a[188:191], v[204:207], a[92:95]
    v_cvt_pk_bf16_f32 v173, v126, v127
    s_waitcnt lgkmcnt(6)
    v_mfma_f32_16x16x32_bf16 a[96:99], a[160:163], v[188:191], a[96:99]
    ds_read_b128 a[184:187], v21 offset:12416
    v_mfma_f32_16x16x32_bf16 a[100:103], a[160:163], v[196:199], a[100:103]
    v_exp_f32 v133, v133
    v_mfma_f32_16x16x32_bf16 a[104:107], a[160:163], v[204:207], a[104:107]
    v_exp_f32 v134, v134
    v_mfma_f32_16x16x32_bf16 a[108:111], a[164:167], v[188:191], a[108:111]
    ds_read_b128 a[188:191], v24 offset:12416
    v_cvt_pk_bf16_f32 v180, v132, v133
    v_mfma_f32_16x16x32_bf16 a[112:115], a[164:167], v[196:199], a[112:115]
    v_exp_f32 v135, v135
    v_mfma_f32_16x16x32_bf16 a[116:119], a[164:167], v[204:207], a[116:119]
    v_cvt_pk_bf16_f32 v181, v134, v135
    s_waitcnt lgkmcnt(4)
    v_mfma_f32_16x16x32_bf16 a[120:123], a[168:171], v[188:191], a[120:123]
    ds_read_b128 a[160:163], v21 offset:12544
    v_mfma_f32_16x16x32_bf16 a[124:127], a[168:171], v[196:199], a[124:127]
    v_exp_f32 v140, v140
    v_mfma_f32_16x16x32_bf16 a[128:131], a[168:171], v[204:207], a[128:131]
    v_exp_f32 v141, v141
    v_mfma_f32_16x16x32_bf16 a[132:135], a[172:175], v[188:191], a[132:135]
    ds_read_b128 a[164:167], v24 offset:12544
    v_cvt_pk_bf16_f32 v166, v140, v141
    v_mfma_f32_16x16x32_bf16 a[136:139], a[172:175], v[196:199], a[136:139]
    v_exp_f32 v142, v142
    v_mfma_f32_16x16x32_bf16 a[140:143], a[172:175], v[204:207], a[140:143]
    buffer_load_dwordx4 v8, s[8:11], s25 offen lds
    s_waitcnt lgkmcnt(4)
    v_mfma_f32_16x16x32_bf16 v[116:119], a[176:179], v[112:115], v[212:215]
    ds_read_b128 a[168:171], v21 offset:18432
    v_mfma_f32_16x16x32_bf16 v[124:127], a[176:179], v[120:123], v[220:223]
    v_exp_f32 v143, v143
    v_mfma_f32_16x16x32_bf16 v[132:135], a[176:179], v[128:131], v[228:231]
    v_exp_f32 v148, v148
    v_mfma_f32_16x16x32_bf16 v[116:119], a[180:183], v[136:139], v[116:119]
    ds_read_b128 a[172:175], v24 offset:18432
    v_cvt_pk_bf16_f32 v167, v142, v143
    v_mfma_f32_16x16x32_bf16 v[124:127], a[180:183], v[144:147], v[124:127]
    v_exp_f32 v149, v149
    v_mfma_f32_16x16x32_bf16 v[132:135], a[180:183], v[152:155], v[132:135]
    v_cvt_pk_bf16_f32 v174, v148, v149
    s_waitcnt lgkmcnt(4)
    v_mfma_f32_16x16x32_bf16 v[116:119], a[184:187], v[160:163], v[116:119]
    ds_read_b128 a[176:179], v21 offset:18560
    v_mfma_f32_16x16x32_bf16 v[124:127], a[184:187], v[168:171], v[124:127]
    v_exp_f32 v150, v150
    v_mfma_f32_16x16x32_bf16 v[132:135], a[184:187], v[176:179], v[132:135]
    v_exp_f32 v151, v151
    v_mfma_f32_16x16x32_bf16 v[116:119], a[188:191], v[184:187], v[116:119]
    ds_read_b128 a[180:183], v24 offset:18560
    v_cvt_pk_bf16_f32 v175, v150, v151
    v_mfma_f32_16x16x32_bf16 v[124:127], a[188:191], v[192:195], v[124:127]
    v_exp_f32 v156, v156
    v_mfma_f32_16x16x32_bf16 v[132:135], a[188:191], v[200:203], v[132:135]
    buffer_load_dwordx4 v9, s[8:11], s25 offen offset:1024 lds
    s_waitcnt lgkmcnt(4)
    v_mfma_f32_16x16x32_bf16 v[116:119], a[160:163], v[208:211], v[116:119]
    v_exp_f32 v157, v157
    v_mfma_f32_16x16x32_bf16 v[124:127], a[160:163], v[216:219], v[124:127]
    v_exp_f32 v158, v158
    v_mfma_f32_16x16x32_bf16 v[132:135], a[160:163], v[224:227], v[132:135]
    v_exp_f32 v159, v159
    v_mfma_f32_16x16x32_bf16 v[116:119], a[164:167], v[232:235], v[116:119]
    ds_read_b128 a[184:187], v21 offset:18688
    v_cvt_pk_bf16_f32 v182, v156, v157
    v_mfma_f32_16x16x32_bf16 v[124:127], a[164:167], v[240:243], v[124:127]
    ds_read_b128 a[188:191], v24 offset:18688
    v_cvt_pk_bf16_f32 v183, v158, v159
    v_mfma_f32_16x16x32_bf16 v[132:135], a[164:167], v[248:251], v[132:135]
    buffer_load_dwordx4 v10, s[8:11], s25 offen offset:2048 lds
    s_waitcnt lgkmcnt(4)
    v_mfma_f32_16x16x32_bf16 v[140:143], a[168:171], v[112:115], v[212:215]
    s_add_u32 m0, s29, 36864
    ds_read_b64_tr_b16 a[160:161], v27 offset:24576
    v_mfma_f32_16x16x32_bf16 v[148:151], a[168:171], v[120:123], v[220:223]
    ds_read_b64_tr_b16 a[162:163], v27 offset:30720
    v_mfma_f32_16x16x32_bf16 v[156:159], a[168:171], v[128:131], v[228:231]
    buffer_load_dwordx4 v11, s[8:11], s25 offen lds
    v_mfma_f32_16x16x32_bf16 v[140:143], a[172:175], v[136:139], v[140:143]
    ds_read_b64_tr_b16 a[164:165], v30 offset:24576
    v_mfma_f32_16x16x32_bf16 v[148:151], a[172:175], v[144:147], v[148:151]
    ds_read_b64_tr_b16 a[166:167], v30 offset:30720
    v_mfma_f32_16x16x32_bf16 v[156:159], a[172:175], v[152:155], v[156:159]
    s_waitcnt lgkmcnt(6)
    v_mfma_f32_16x16x32_bf16 v[140:143], a[176:179], v[160:163], v[140:143]
    ds_read_b64_tr_b16 a[168:169], v33 offset:24576
    v_mfma_f32_16x16x32_bf16 v[148:151], a[176:179], v[168:171], v[148:151]
    ds_read_b64_tr_b16 a[170:171], v33 offset:30720
    v_mfma_f32_16x16x32_bf16 v[156:159], a[176:179], v[176:179], v[156:159]
    buffer_load_dwordx4 v12, s[8:11], s25 offen offset:1024 lds
    v_mfma_f32_16x16x32_bf16 v[140:143], a[180:183], v[184:187], v[140:143]
    ds_read_b64_tr_b16 a[172:173], v36 offset:24576
    v_mfma_f32_16x16x32_bf16 v[148:151], a[180:183], v[192:195], v[148:151]
    ds_read_b64_tr_b16 a[174:175], v36 offset:30720
    v_mfma_f32_16x16x32_bf16 v[156:159], a[180:183], v[200:203], v[156:159]
    s_waitcnt lgkmcnt(8)
    v_mfma_f32_16x16x32_bf16 v[140:143], a[184:187], v[208:211], v[140:143]
    ds_read_b64_tr_b16 a[176:177], v27 offset:24704
    v_mfma_f32_16x16x32_bf16 v[148:151], a[184:187], v[216:219], v[148:151]
    ds_read_b64_tr_b16 a[178:179], v27 offset:30848
    v_mfma_f32_16x16x32_bf16 v[156:159], a[184:187], v[224:227], v[156:159]
    buffer_load_dwordx4 v13, s[8:11], s25 offen offset:2048 lds
    v_mfma_f32_16x16x32_bf16 v[140:143], a[188:191], v[232:235], v[140:143]
    ds_read_b64_tr_b16 a[180:181], v30 offset:24704
    v_mfma_f32_16x16x32_bf16 v[148:151], a[188:191], v[240:243], v[148:151]
    ds_read_b64_tr_b16 a[182:183], v30 offset:30848
    v_mfma_f32_16x16x32_bf16 v[156:159], a[188:191], v[248:251], v[156:159]
    s_waitcnt lgkmcnt(8)
    v_mfma_f32_16x16x32_bf16 a[0:3], a[160:163], v[164:167], a[0:3]
    ds_read_b64_tr_b16 a[184:185], v33 offset:24704
    v_mfma_f32_16x16x32_bf16 a[4:7], a[160:163], v[172:175], a[4:7]
    ds_read_b64_tr_b16 a[186:187], v33 offset:30848
    v_mfma_f32_16x16x32_bf16 a[8:11], a[160:163], v[180:183], a[8:11]
    v_exp_f32 v116, v116
    v_mfma_f32_16x16x32_bf16 a[12:15], a[164:167], v[164:167], a[12:15]
    ds_read_b64_tr_b16 a[188:189], v36 offset:24704
    v_mfma_f32_16x16x32_bf16 a[16:19], a[164:167], v[172:175], a[16:19]
    ds_read_b64_tr_b16 a[190:191], v36 offset:30848
    v_mfma_f32_16x16x32_bf16 a[20:23], a[164:167], v[180:183], a[20:23]
    s_add_u32 s25, s25, 786432
    s_add_u32 s24, s24, 128
    s_waitcnt lgkmcnt(8)
    v_mfma_f32_16x16x32_bf16 a[24:27], a[168:171], v[164:167], a[24:27]
    ds_read_b64_tr_b16 a[160:161], v27 offset:24832
    v_mfma_f32_16x16x32_bf16 a[28:31], a[168:171], v[172:175], a[28:31]
    ds_read_b64_tr_b16 a[162:163], v27 offset:30976
    v_mfma_f32_16x16x32_bf16 a[32:35], a[168:171], v[180:183], a[32:35]
    v_exp_f32 v117, v117
    v_mfma_f32_16x16x32_bf16 a[36:39], a[172:175], v[164:167], a[36:39]
    ds_read_b64_tr_b16 a[164:165], v30 offset:24832
    v_cvt_pk_bf16_f32 v188, v116, v117
    v_mfma_f32_16x16x32_bf16 a[40:43], a[172:175], v[172:175], a[40:43]
    ds_read_b64_tr_b16 a[166:167], v30 offset:30976
    v_mfma_f32_16x16x32_bf16 a[44:47], a[172:175], v[180:183], a[44:47]
    s_waitcnt lgkmcnt(8)
    v_mfma_f32_16x16x32_bf16 a[48:51], a[176:179], v[164:167], a[48:51]
    ds_read_b64_tr_b16 a[168:169], v33 offset:24832
    v_mfma_f32_16x16x32_bf16 a[52:55], a[176:179], v[172:175], a[52:55]
    ds_read_b64_tr_b16 a[170:171], v33 offset:30976
    v_mfma_f32_16x16x32_bf16 a[56:59], a[176:179], v[180:183], a[56:59]
    s_cmp_eq_u32 s24, 1280
    s_cmov_b32 s24, 0
    s_cmov_b32 s25, s26
    v_mfma_f32_16x16x32_bf16 a[60:63], a[180:183], v[164:167], a[60:63]
    ds_read_b64_tr_b16 a[172:173], v36 offset:24832
    v_mfma_f32_16x16x32_bf16 a[64:67], a[180:183], v[172:175], a[64:67]
    ds_read_b64_tr_b16 a[174:175], v36 offset:30976
    v_mfma_f32_16x16x32_bf16 a[68:71], a[180:183], v[180:183], a[68:71]
    v_exp_f32 v118, v118
    v_mfma_f32_16x16x32_bf16 a[144:147], a[156:159], v[164:167], a[144:147]
    v_exp_f32 v119, v119
    v_mfma_f32_16x16x32_bf16 a[148:151], a[156:159], v[172:175], a[148:151]
    v_exp_f32 v124, v124
    v_mfma_f32_16x16x32_bf16 a[152:155], a[156:159], v[180:183], a[152:155]
    s_waitcnt vmcnt(23)
    s_barrier
    s_waitcnt lgkmcnt(8)
    v_mfma_f32_16x16x32_bf16 a[72:75], a[184:187], v[164:167], a[72:75]
    ds_read_b128 a[176:179], v21 offset:36864
    v_cvt_pk_bf16_f32 v189, v118, v119
    v_mfma_f32_16x16x32_bf16 a[76:79], a[184:187], v[172:175], a[76:79]
    s_add_u32 m0, s29, 49152
    v_exp_f32 v125, v125
    v_mfma_f32_16x16x32_bf16 a[80:83], a[184:187], v[180:183], a[80:83]
    v_exp_f32 v126, v126
    v_mfma_f32_16x16x32_bf16 a[84:87], a[188:191], v[164:167], a[84:87]
    ds_read_b128 a[180:183], v24 offset:36864
    v_cvt_pk_bf16_f32 v196, v124, v125
    v_mfma_f32_16x16x32_bf16 a[88:91], a[188:191], v[172:175], a[88:91]
    v_exp_f32 v127, v127
    v_mfma_f32_16x16x32_bf16 a[92:95], a[188:191], v[180:183], a[92:95]
    v_cvt_pk_bf16_f32 v197, v126, v127
    s_waitcnt lgkmcnt(6)
    v_mfma_f32_16x16x32_bf16 a[96:99], a[160:163], v[164:167], a[96:99]
    ds_read_b128 a[184:187], v21 offset:36992
    v_mfma_f32_16x16x32_bf16 a[100:103], a[160:163], v[172:175], a[100:103]
    v_exp_f32 v132, v132
    v_mfma_f32_16x16x32_bf16 a[104:107], a[160:163], v[180:183], a[104:107]
    v_exp_f32 v133, v133
    v_mfma_f32_16x16x32_bf16 a[108:111], a[164:167], v[164:167], a[108:111]
    ds_read_b128 a[188:191], v24 offset:36992
    v_cvt_pk_bf16_f32 v204, v132, v133
    v_mfma_f32_16x16x32_bf16 a[112:115], a[164:167], v[172:175], a[112:115]
    v_exp_f32 v134, v134
    v_mfma_f32_16x16x32_bf16 a[116:119], a[164:167], v[180:183], a[116:119]
    buffer_load_dwordx4 v2, s[4:7], s24 offen lds
    s_waitcnt lgkmcnt(4)
    v_mfma_f32_16x16x32_bf16 a[120:123], a[168:171], v[164:167], a[120:123]
    ds_read_b128 a[160:163], v21 offset:37120
    v_mfma_f32_16x16x32_bf16 a[124:127], a[168:171], v[172:175], a[124:127]
    v_exp_f32 v135, v135
    v_mfma_f32_16x16x32_bf16 a[128:131], a[168:171], v[180:183], a[128:131]
    v_cvt_pk_bf16_f32 v205, v134, v135
    v_mfma_f32_16x16x32_bf16 a[132:135], a[172:175], v[164:167], a[132:135]
    ds_read_b128 a[164:167], v24 offset:37120
    v_mfma_f32_16x16x32_bf16 a[136:139], a[172:175], v[172:175], a[136:139]
    v_exp_f32 v140, v140
    v_mfma_f32_16x16x32_bf16 a[140:143], a[172:175], v[180:183], a[140:143]
    buffer_load_dwordx4 v3, s[4:7], s24 offen offset:1024 lds
    s_waitcnt lgkmcnt(4)
    v_mfma_f32_16x16x32_bf16 v[116:119], a[176:179], v[112:115], v[212:215]
    ds_read_b128 a[168:171], v21 offset:43008
    v_mfma_f32_16x16x32_bf16 v[124:127], a[176:179], v[120:123], v[220:223]
    v_exp_f32 v141, v141
    v_mfma_f32_16x16x32_bf16 v[132:135], a[176:179], v[128:131], v[228:231]
    v_exp_f32 v142, v142
    v_mfma_f32_16x16x32_bf16 v[116:119], a[180:183], v[136:139], v[116:119]
    ds_read_b128 a[172:175], v24 offset:43008
    v_cvt_pk_bf16_f32 v190, v140, v141
    v_mfma_f32_16x16x32_bf16 v[124:127], a[180:183], v[144:147], v[124:127]
    v_exp_f32 v143, v143
    v_mfma_f32_16x16x32_bf16 v[132:135], a[180:183], v[152:155], v[132:135]
    v_cvt_pk_bf16_f32 v191, v142, v143
    s_waitcnt lgkmcnt(4)
    v_mfma_f32_16x16x32_bf16 v[116:119], a[184:187], v[160:163], v[116:119]
    ds_read_b128 a[176:179], v21 offset:43136
    v_mfma_f32_16x16x32_bf16 v[124:127], a[184:187], v[168:171], v[124:127]
    v_exp_f32 v148, v148
    v_mfma_f32_16x16x32_bf16 v[132:135], a[184:187], v[176:179], v[132:135]
    v_exp_f32 v149, v149
    v_mfma_f32_16x16x32_bf16 v[116:119], a[188:191], v[184:187], v[116:119]
    ds_read_b128 a[180:183], v24 offset:43136
    v_cvt_pk_bf16_f32 v198, v148, v149
    v_mfma_f32_16x16x32_bf16 v[124:127], a[188:191], v[192:195], v[124:127]
    v_exp_f32 v150, v150
    v_mfma_f32_16x16x32_bf16 v[132:135], a[188:191], v[200:203], v[132:135]
    buffer_load_dwordx4 v4, s[4:7], s24 offen offset:2048 lds
    s_waitcnt lgkmcnt(4)
    v_mfma_f32_16x16x32_bf16 v[116:119], a[160:163], v[208:211], v[116:119]
    v_exp_f32 v151, v151
    v_mfma_f32_16x16x32_bf16 v[124:127], a[160:163], v[216:219], v[124:127]
    v_exp_f32 v156, v156
    v_mfma_f32_16x16x32_bf16 v[132:135], a[160:163], v[224:227], v[132:135]
    v_exp_f32 v157, v157
    v_exp_f32 v158, v158
    v_exp_f32 v159, v159
    v_mfma_f32_16x16x32_bf16 v[116:119], a[164:167], v[232:235], v[116:119]
    ds_read_b128 a[184:187], v21 offset:43264
    v_cvt_pk_bf16_f32 v199, v150, v151
    v_mfma_f32_16x16x32_bf16 v[124:127], a[164:167], v[240:243], v[124:127]
    v_cvt_pk_bf16_f32 v206, v156, v157
    v_cvt_pk_bf16_f32 v207, v158, v159
    v_mfma_f32_16x16x32_bf16 v[132:135], a[164:167], v[248:251], v[132:135]
    ds_read_b128 a[188:191], v24 offset:43264
    s_waitcnt lgkmcnt(4)
    v_mfma_f32_16x16x32_bf16 v[140:143], a[168:171], v[112:115], v[212:215]
    s_add_u32 m0, s29, 61440
    ds_read_b64_tr_b16 a[160:161], v28 offset:0
    v_mfma_f32_16x16x32_bf16 v[148:151], a[168:171], v[120:123], v[220:223]
    ds_read_b64_tr_b16 a[162:163], v28 offset:6144
    v_mfma_f32_16x16x32_bf16 v[156:159], a[168:171], v[128:131], v[228:231]
    v_exp_f32 v116, v116
    v_mfma_f32_16x16x32_bf16 v[140:143], a[172:175], v[136:139], v[140:143]
    ds_read_b64_tr_b16 a[164:165], v31 offset:0
    v_mfma_f32_16x16x32_bf16 v[148:151], a[172:175], v[144:147], v[148:151]
    ds_read_b64_tr_b16 a[166:167], v31 offset:6144
    v_mfma_f32_16x16x32_bf16 v[156:159], a[172:175], v[152:155], v[156:159]
    s_waitcnt lgkmcnt(6)
    v_mfma_f32_16x16x32_bf16 v[140:143], a[176:179], v[160:163], v[140:143]
    ds_read_b64_tr_b16 a[168:169], v34 offset:0
    v_mfma_f32_16x16x32_bf16 v[148:151], a[176:179], v[168:171], v[148:151]
    ds_read_b64_tr_b16 a[170:171], v34 offset:6144
    v_mfma_f32_16x16x32_bf16 v[156:159], a[176:179], v[176:179], v[156:159]
    buffer_load_dwordx4 v5, s[4:7], s24 offen lds
    v_mfma_f32_16x16x32_bf16 v[140:143], a[180:183], v[184:187], v[140:143]
    ds_read_b64_tr_b16 a[172:173], v37 offset:0
    v_mfma_f32_16x16x32_bf16 v[148:151], a[180:183], v[192:195], v[148:151]
    ds_read_b64_tr_b16 a[174:175], v37 offset:6144
    v_mfma_f32_16x16x32_bf16 v[156:159], a[180:183], v[200:203], v[156:159]
    s_waitcnt lgkmcnt(8)
    v_mfma_f32_16x16x32_bf16 v[140:143], a[184:187], v[208:211], v[140:143]
    ds_read_b64_tr_b16 a[176:177], v28 offset:128
    v_mfma_f32_16x16x32_bf16 v[148:151], a[184:187], v[216:219], v[148:151]
    ds_read_b64_tr_b16 a[178:179], v28 offset:6272
    v_mfma_f32_16x16x32_bf16 v[156:159], a[184:187], v[224:227], v[156:159]
    v_exp_f32 v117, v117
    v_mfma_f32_16x16x32_bf16 v[140:143], a[188:191], v[232:235], v[140:143]
    ds_read_b64_tr_b16 a[180:181], v31 offset:128
    v_cvt_pk_bf16_f32 v164, v116, v117
    v_mfma_f32_16x16x32_bf16 v[148:151], a[188:191], v[240:243], v[148:151]
    ds_read_b64_tr_b16 a[182:183], v31 offset:6272
    v_mfma_f32_16x16x32_bf16 v[156:159], a[188:191], v[248:251], v[156:159]
    buffer_load_dwordx4 v6, s[4:7], s24 offen offset:1024 lds
    s_waitcnt lgkmcnt(8)
    v_mfma_f32_16x16x32_bf16 a[0:3], a[160:163], v[188:191], a[0:3]
    ds_read_b64_tr_b16 a[184:185], v34 offset:128
    v_mfma_f32_16x16x32_bf16 a[4:7], a[160:163], v[196:199], a[4:7]
    ds_read_b64_tr_b16 a[186:187], v34 offset:6272
    v_mfma_f32_16x16x32_bf16 a[8:11], a[160:163], v[204:207], a[8:11]
    v_exp_f32 v118, v118
    v_mfma_f32_16x16x32_bf16 a[12:15], a[164:167], v[188:191], a[12:15]
    ds_read_b64_tr_b16 a[188:189], v37 offset:128
    v_mfma_f32_16x16x32_bf16 a[16:19], a[164:167], v[196:199], a[16:19]
    ds_read_b64_tr_b16 a[190:191], v37 offset:6272
    v_mfma_f32_16x16x32_bf16 a[20:23], a[164:167], v[204:207], a[20:23]
    s_waitcnt lgkmcnt(8)
    v_mfma_f32_16x16x32_bf16 a[24:27], a[168:171], v[188:191], a[24:27]
    ds_read_b64_tr_b16 a[160:161], v28 offset:256
    v_mfma_f32_16x16x32_bf16 a[28:31], a[168:171], v[196:199], a[28:31]
    ds_read_b64_tr_b16 a[162:163], v28 offset:6400
    v_mfma_f32_16x16x32_bf16 a[32:35], a[168:171], v[204:207], a[32:35]
    buffer_load_dwordx4 v7, s[4:7], s24 offen offset:2048 lds
    v_mfma_f32_16x16x32_bf16 a[36:39], a[172:175], v[188:191], a[36:39]
    ds_read_b64_tr_b16 a[164:165], v31 offset:256
    v_mfma_f32_16x16x32_bf16 a[40:43], a[172:175], v[196:199], a[40:43]
    ds_read_b64_tr_b16 a[166:167], v31 offset:6400
    v_mfma_f32_16x16x32_bf16 a[44:47], a[172:175], v[204:207], a[44:47]
    s_waitcnt lgkmcnt(8)
    v_mfma_f32_16x16x32_bf16 a[48:51], a[176:179], v[188:191], a[48:51]
    ds_read_b64_tr_b16 a[168:169], v34 offset:256
    v_mfma_f32_16x16x32_bf16 a[52:55], a[176:179], v[196:199], a[52:55]
    ds_read_b64_tr_b16 a[170:171], v34 offset:6400
    v_mfma_f32_16x16x32_bf16 a[56:59], a[176:179], v[204:207], a[56:59]
    v_exp_f32 v119, v119
    v_mfma_f32_16x16x32_bf16 a[60:63], a[180:183], v[188:191], a[60:63]
    ds_read_b64_tr_b16 a[172:173], v37 offset:256
    v_cvt_pk_bf16_f32 v165, v118, v119
    v_mfma_f32_16x16x32_bf16 a[64:67], a[180:183], v[196:199], a[64:67]
    ds_read_b64_tr_b16 a[174:175], v37 offset:6400
    v_mfma_f32_16x16x32_bf16 a[68:71], a[180:183], v[204:207], a[68:71]
    v_exp_f32 v124, v124
    v_mfma_f32_16x16x32_bf16 a[144:147], a[156:159], v[188:191], a[144:147]
    v_exp_f32 v125, v125
    v_mfma_f32_16x16x32_bf16 a[148:151], a[156:159], v[196:199], a[148:151]
    v_exp_f32 v126, v126
    v_mfma_f32_16x16x32_bf16 a[152:155], a[156:159], v[204:207], a[152:155]
    s_waitcnt vmcnt(22)
    s_barrier
    s_waitcnt lgkmcnt(8)
    v_mfma_f32_16x16x32_bf16 a[72:75], a[184:187], v[188:191], a[72:75]
    ds_read_b128 a[176:179], v22 offset:12288
    v_cvt_pk_bf16_f32 v172, v124, v125
    v_mfma_f32_16x16x32_bf16 a[76:79], a[184:187], v[196:199], a[76:79]
    s_add_u32 m0, s29, 73728
    v_exp_f32 v127, v127
    v_mfma_f32_16x16x32_bf16 a[80:83], a[184:187], v[204:207], a[80:83]
    v_exp_f32 v132, v132
    v_mfma_f32_16x16x32_bf16 a[84:87], a[188:191], v[188:191], a[84:87]
    ds_read_b128 a[180:183], v25 offset:12288
    v_cvt_pk_bf16_f32 v173, v126, v127
    v_mfma_f32_16x16x32_bf16 a[88:91], a[188:191], v[196:199], a[88:91]
    v_exp_f32 v133, v133
    v_mfma_f32_16x16x32_bf16 a[92:95], a[188:191], v[204:207], a[92:95]
    v_cvt_pk_bf16_f32 v180, v132, v133
    s_waitcnt lgkmcnt(6)
    v_mfma_f32_16x16x32_bf16 a[96:99], a[160:163], v[188:191], a[96:99]
    ds_read_b128 a[184:187], v22 offset:12416
    v_mfma_f32_16x16x32_bf16 a[100:103], a[160:163], v[196:199], a[100:103]
    v_exp_f32 v134, v134
    v_mfma_f32_16x16x32_bf16 a[104:107], a[160:163], v[204:207], a[104:107]
    v_exp_f32 v135, v135
    v_mfma_f32_16x16x32_bf16 a[108:111], a[164:167], v[188:191], a[108:111]
    ds_read_b128 a[188:191], v25 offset:12416
    v_cvt_pk_bf16_f32 v181, v134, v135
    v_mfma_f32_16x16x32_bf16 a[112:115], a[164:167], v[196:199], a[112:115]
    v_exp_f32 v140, v140
    v_mfma_f32_16x16x32_bf16 a[116:119], a[164:167], v[204:207], a[116:119]
    buffer_load_dwordx4 v8, s[8:11], s25 offen lds
    s_waitcnt lgkmcnt(4)
    v_mfma_f32_16x16x32_bf16 a[120:123], a[168:171], v[188:191], a[120:123]
    ds_read_b128 a[160:163], v22 offset:12544
    v_mfma_f32_16x16x32_bf16 a[124:127], a[168:171], v[196:199], a[124:127]
    v_exp_f32 v141, v141
    v_mfma_f32_16x16x32_bf16 a[128:131], a[168:171], v[204:207], a[128:131]
    v_exp_f32 v142, v142
    v_mfma_f32_16x16x32_bf16 a[132:135], a[172:175], v[188:191], a[132:135]
    ds_read_b128 a[164:167], v25 offset:12544
    v_cvt_pk_bf16_f32 v166, v140, v141
    v_mfma_f32_16x16x32_bf16 a[136:139], a[172:175], v[196:199], a[136:139]
    v_exp_f32 v143, v143
    v_mfma_f32_16x16x32_bf16 a[140:143], a[172:175], v[204:207], a[140:143]
    v_cvt_pk_bf16_f32 v167, v142, v143
    s_waitcnt lgkmcnt(4)
    v_mfma_f32_16x16x32_bf16 v[116:119], a[176:179], v[112:115], v[212:215]
    ds_read_b128 a[168:171], v22 offset:18432
    v_mfma_f32_16x16x32_bf16 v[124:127], a[176:179], v[120:123], v[220:223]
    v_exp_f32 v148, v148
    v_mfma_f32_16x16x32_bf16 v[132:135], a[176:179], v[128:131], v[228:231]
    v_exp_f32 v149, v149
    v_mfma_f32_16x16x32_bf16 v[116:119], a[180:183], v[136:139], v[116:119]
    ds_read_b128 a[172:175], v25 offset:18432
    v_cvt_pk_bf16_f32 v174, v148, v149
    v_mfma_f32_16x16x32_bf16 v[124:127], a[180:183], v[144:147], v[124:127]
    v_exp_f32 v150, v150
    v_mfma_f32_16x16x32_bf16 v[132:135], a[180:183], v[152:155], v[132:135]
    buffer_load_dwordx4 v9, s[8:11], s25 offen offset:1024 lds
    s_waitcnt lgkmcnt(4)
    v_mfma_f32_16x16x32_bf16 v[116:119], a[184:187], v[160:163], v[116:119]
    ds_read_b128 a[176:179], v22 offset:18560
    v_mfma_f32_16x16x32_bf16 v[124:127], a[184:187], v[168:171], v[124:127]
    v_exp_f32 v151, v151
    v_mfma_f32_16x16x32_bf16 v[132:135], a[184:187], v[176:179], v[132:135]
    v_exp_f32 v156, v156
    v_mfma_f32_16x16x32_bf16 v[116:119], a[188:191], v[184:187], v[116:119]
    ds_read_b128 a[180:183], v25 offset:18560
    v_cvt_pk_bf16_f32 v175, v150, v151
    v_mfma_f32_16x16x32_bf16 v[124:127], a[188:191], v[192:195], v[124:127]
    v_exp_f32 v157, v157
    v_mfma_f32_16x16x32_bf16 v[132:135], a[188:191], v[200:203], v[132:135]
    v_cvt_pk_bf16_f32 v182, v156, v157
    s_waitcnt lgkmcnt(4)
    v_mfma_f32_16x16x32_bf16 v[116:119], a[160:163], v[208:211], v[116:119]
    v_exp_f32 v158, v158
    v_mfma_f32_16x16x32_bf16 v[124:127], a[160:163], v[216:219], v[124:127]
    v_exp_f32 v159, v159
    v_mfma_f32_16x16x32_bf16 v[132:135], a[160:163], v[224:227], v[132:135]
    ds_read_b128 a[184:187], v22 offset:18688
    v_cvt_pk_bf16_f32 v183, v158, v159
    v_mfma_f32_16x16x32_bf16 v[116:119], a[164:167], v[232:235], v[116:119]
    ds_read_b128 a[188:191], v25 offset:18688
    v_mfma_f32_16x16x32_bf16 v[124:127], a[164:167], v[240:243], v[124:127]
    buffer_load_dwordx4 v10, s[8:11], s25 offen offset:2048 lds
    s_add_u32 m0, s29, 86016
    v_mfma_f32_16x16x32_bf16 v[132:135], a[164:167], v[248:251], v[132:135]
    buffer_load_dwordx4 v11, s[8:11], s25 offen lds
    s_waitcnt lgkmcnt(4)
    v_mfma_f32_16x16x32_bf16 v[140:143], a[168:171], v[112:115], v[212:215]
    ds_read_b64_tr_b16 a[160:161], v28 offset:24576
    v_mfma_f32_16x16x32_bf16 v[148:151], a[168:171], v[120:123], v[220:223]
    ds_read_b64_tr_b16 a[162:163], v28 offset:30720
    v_mfma_f32_16x16x32_bf16 v[156:159], a[168:171], v[128:131], v[228:231]
    v_exp_f32 v116, v116
    v_mfma_f32_16x16x32_bf16 v[140:143], a[172:175], v[136:139], v[140:143]
    ds_read_b64_tr_b16 a[164:165], v31 offset:24576
    v_mfma_f32_16x16x32_bf16 v[148:151], a[172:175], v[144:147], v[148:151]
    ds_read_b64_tr_b16 a[166:167], v31 offset:30720
    v_mfma_f32_16x16x32_bf16 v[156:159], a[172:175], v[152:155], v[156:159]
    s_waitcnt lgkmcnt(6)
    v_mfma_f32_16x16x32_bf16 v[140:143], a[176:179], v[160:163], v[140:143]
    ds_read_b64_tr_b16 a[168:169], v34 offset:24576
    v_mfma_f32_16x16x32_bf16 v[148:151], a[176:179], v[168:171], v[148:151]
    ds_read_b64_tr_b16 a[170:171], v34 offset:30720
    v_mfma_f32_16x16x32_bf16 v[156:159], a[176:179], v[176:179], v[156:159]
    buffer_load_dwordx4 v12, s[8:11], s25 offen offset:1024 lds
    v_mfma_f32_16x16x32_bf16 v[140:143], a[180:183], v[184:187], v[140:143]
    ds_read_b64_tr_b16 a[172:173], v37 offset:24576
    v_mfma_f32_16x16x32_bf16 v[148:151], a[180:183], v[192:195], v[148:151]
    ds_read_b64_tr_b16 a[174:175], v37 offset:30720
    v_mfma_f32_16x16x32_bf16 v[156:159], a[180:183], v[200:203], v[156:159]
    s_waitcnt lgkmcnt(8)
    v_mfma_f32_16x16x32_bf16 v[140:143], a[184:187], v[208:211], v[140:143]
    ds_read_b64_tr_b16 a[176:177], v28 offset:24704
    v_mfma_f32_16x16x32_bf16 v[148:151], a[184:187], v[216:219], v[148:151]
    ds_read_b64_tr_b16 a[178:179], v28 offset:30848
    v_mfma_f32_16x16x32_bf16 v[156:159], a[184:187], v[224:227], v[156:159]
    buffer_load_dwordx4 v13, s[8:11], s25 offen offset:2048 lds
    v_mfma_f32_16x16x32_bf16 v[140:143], a[188:191], v[232:235], v[140:143]
    ds_read_b64_tr_b16 a[180:181], v31 offset:24704
    v_mfma_f32_16x16x32_bf16 v[148:151], a[188:191], v[240:243], v[148:151]
    ds_read_b64_tr_b16 a[182:183], v31 offset:30848
    v_mfma_f32_16x16x32_bf16 v[156:159], a[188:191], v[248:251], v[156:159]
    s_waitcnt lgkmcnt(8)
    v_mfma_f32_16x16x32_bf16 a[0:3], a[160:163], v[164:167], a[0:3]
    ds_read_b64_tr_b16 a[184:185], v34 offset:24704
    v_mfma_f32_16x16x32_bf16 a[4:7], a[160:163], v[172:175], a[4:7]
    ds_read_b64_tr_b16 a[186:187], v34 offset:30848
    v_mfma_f32_16x16x32_bf16 a[8:11], a[160:163], v[180:183], a[8:11]
    v_exp_f32 v117, v117
    v_mfma_f32_16x16x32_bf16 a[12:15], a[164:167], v[164:167], a[12:15]
    ds_read_b64_tr_b16 a[188:189], v37 offset:24704
    v_cvt_pk_bf16_f32 v188, v116, v117
    v_mfma_f32_16x16x32_bf16 a[16:19], a[164:167], v[172:175], a[16:19]
    ds_read_b64_tr_b16 a[190:191], v37 offset:30848
    v_mfma_f32_16x16x32_bf16 a[20:23], a[164:167], v[180:183], a[20:23]
    s_add_u32 s25, s25, 786432
    s_add_u32 s24, s24, 128
    s_waitcnt lgkmcnt(8)
    v_mfma_f32_16x16x32_bf16 a[24:27], a[168:171], v[164:167], a[24:27]
    ds_read_b64_tr_b16 a[160:161], v28 offset:24832
    v_mfma_f32_16x16x32_bf16 a[28:31], a[168:171], v[172:175], a[28:31]
    ds_read_b64_tr_b16 a[162:163], v28 offset:30976
    v_mfma_f32_16x16x32_bf16 a[32:35], a[168:171], v[180:183], a[32:35]
    v_exp_f32 v118, v118
    v_mfma_f32_16x16x32_bf16 a[36:39], a[172:175], v[164:167], a[36:39]
    ds_read_b64_tr_b16 a[164:165], v31 offset:24832
    v_mfma_f32_16x16x32_bf16 a[40:43], a[172:175], v[172:175], a[40:43]
    ds_read_b64_tr_b16 a[166:167], v31 offset:30976
    v_mfma_f32_16x16x32_bf16 a[44:47], a[172:175], v[180:183], a[44:47]
    s_waitcnt lgkmcnt(8)
    v_mfma_f32_16x16x32_bf16 a[48:51], a[176:179], v[164:167], a[48:51]
    ds_read_b64_tr_b16 a[168:169], v34 offset:24832
    v_mfma_f32_16x16x32_bf16 a[52:55], a[176:179], v[172:175], a[52:55]
    ds_read_b64_tr_b16 a[170:171], v34 offset:30976
    v_mfma_f32_16x16x32_bf16 a[56:59], a[176:179], v[180:183], a[56:59]
    s_cmp_eq_u32 s24, 1280
    s_cmov_b32 s24, 0
    s_cmov_b32 s25, s26
    v_mfma_f32_16x16x32_bf16 a[60:63], a[180:183], v[164:167], a[60:63]
    ds_read_b64_tr_b16 a[172:173], v37 offset:24832
    v_mfma_f32_16x16x32_bf16 a[64:67], a[180:183], v[172:175], a[64:67]
    ds_read_b64_tr_b16 a[174:175], v37 offset:30976
    v_mfma_f32_16x16x32_bf16 a[68:71], a[180:183], v[180:183], a[68:71]
    v_exp_f32 v119, v119
    v_mfma_f32_16x16x32_bf16 a[144:147], a[156:159], v[164:167], a[144:147]
    v_exp_f32 v124, v124
    v_mfma_f32_16x16x32_bf16 a[148:151], a[156:159], v[172:175], a[148:151]
    v_exp_f32 v125, v125
    v_mfma_f32_16x16x32_bf16 a[152:155], a[156:159], v[180:183], a[152:155]
    s_waitcnt vmcnt(24)
    s_barrier
    s_waitcnt lgkmcnt(8)
    v_mfma_f32_16x16x32_bf16 a[72:75], a[184:187], v[164:167], a[72:75]
    ds_read_b64_tr_b16 a[176:177], v28 offset:36864
    v_cvt_pk_bf16_f32 v189, v118, v119
    v_mfma_f32_16x16x32_bf16 a[76:79], a[184:187], v[172:175], a[76:79]
    ds_read_b64_tr_b16 a[178:179], v28 offset:43008
    v_cvt_pk_bf16_f32 v196, v124, v125
    v_mfma_f32_16x16x32_bf16 a[80:83], a[184:187], v[180:183], a[80:83]
    s_add_u32 m0, s29, 98304
    v_exp_f32 v126, v126
    v_mfma_f32_16x16x32_bf16 a[84:87], a[188:191], v[164:167], a[84:87]
    ds_read_b64_tr_b16 a[180:181], v31 offset:36864
    v_mfma_f32_16x16x32_bf16 a[88:91], a[188:191], v[172:175], a[88:91]
    ds_read_b64_tr_b16 a[182:183], v31 offset:43008
    v_mfma_f32_16x16x32_bf16 a[92:95], a[188:191], v[180:183], a[92:95]
    buffer_load_dwordx4 v2, s[4:7], s24 offen lds
    s_waitcnt lgkmcnt(8)
    v_mfma_f32_16x16x32_bf16 a[96:99], a[160:163], v[164:167], a[96:99]
    ds_read_b64_tr_b16 a[184:185], v34 offset:36864
    v_mfma_f32_16x16x32_bf16 a[100:103], a[160:163], v[172:175], a[100:103]
    ds_read_b64_tr_b16 a[186:187], v34 offset:43008
    v_mfma_f32_16x16x32_bf16 a[104:107], a[160:163], v[180:183], a[104:107]
    v_exp_f32 v127, v127
    v_mfma_f32_16x16x32_bf16 a[108:111], a[164:167], v[164:167], a[108:111]
    ds_read_b64_tr_b16 a[188:189], v37 offset:36864
    v_cvt_pk_bf16_f32 v197, v126, v127
    v_mfma_f32_16x16x32_bf16 a[112:115], a[164:167], v[172:175], a[112:115]
    ds_read_b64_tr_b16 a[190:191], v37 offset:43008
    v_mfma_f32_16x16x32_bf16 a[116:119], a[164:167], v[180:183], a[116:119]
    buffer_load_dwordx4 v3, s[4:7], s24 offen offset:1024 lds
    s_waitcnt lgkmcnt(8)
    v_mfma_f32_16x16x32_bf16 a[120:123], a[168:171], v[164:167], a[120:123]
    ds_read_b64_tr_b16 a[160:161], v28 offset:36992
    v_mfma_f32_16x16x32_bf16 a[124:127], a[168:171], v[172:175], a[124:127]
    v_exp_f32 v132, v132
    v_mfma_f32_16x16x32_bf16 a[128:131], a[168:171], v[180:183], a[128:131]
    v_exp_f32 v133, v133
    v_mfma_f32_16x16x32_bf16 a[132:135], a[172:175], v[164:167], a[132:135]
    v_exp_f32 v134, v134
    v_exp_f32 v135, v135
    v_exp_f32 v140, v140
    v_exp_f32 v141, v141
    v_exp_f32 v142, v142
    v_exp_f32 v143, v143
    v_exp_f32 v148, v148
    v_exp_f32 v149, v149
    v_exp_f32 v150, v150
    v_exp_f32 v151, v151
    v_exp_f32 v156, v156
    v_exp_f32 v157, v157
    v_exp_f32 v158, v158
    v_exp_f32 v159, v159
    v_mfma_f32_16x16x32_bf16 a[136:139], a[172:175], v[172:175], a[136:139]
    ds_read_b64_tr_b16 a[162:163], v28 offset:43136
    v_cvt_pk_bf16_f32 v204, v132, v133
    v_mfma_f32_16x16x32_bf16 a[140:143], a[172:175], v[180:183], a[140:143]
    v_cvt_pk_bf16_f32 v205, v134, v135
    v_cvt_pk_bf16_f32 v190, v140, v141
    v_cvt_pk_bf16_f32 v191, v142, v143
    v_cvt_pk_bf16_f32 v198, v148, v149
    v_cvt_pk_bf16_f32 v199, v150, v151
    v_cvt_pk_bf16_f32 v206, v156, v157
    v_cvt_pk_bf16_f32 v207, v158, v159
    s_waitcnt lgkmcnt(6)
    v_mfma_f32_16x16x32_bf16 a[0:3], a[176:179], v[188:191], a[0:3]
    ds_read_b64_tr_b16 a[164:165], v31 offset:36992
    v_mfma_f32_16x16x32_bf16 a[4:7], a[176:179], v[196:199], a[4:7]
    ds_read_b64_tr_b16 a[166:167], v31 offset:43136
    v_mfma_f32_16x16x32_bf16 a[8:11], a[176:179], v[204:207], a[8:11]
    ds_read_b64_tr_b16 a[168:169], v34 offset:36992
    v_mfma_f32_16x16x32_bf16 a[144:147], a[156:159], v[188:191], a[144:147]
    ds_read_b64_tr_b16 a[170:171], v34 offset:43136
    v_mfma_f32_16x16x32_bf16 a[148:151], a[156:159], v[196:199], a[148:151]
    buffer_load_dwordx4 v4, s[4:7], s24 offen offset:2048 lds
    s_add_u32 m0, s29, 110592
    v_mfma_f32_16x16x32_bf16 a[152:155], a[156:159], v[204:207], a[152:155]
    buffer_load_dwordx4 v5, s[4:7], s24 offen lds
    v_mfma_f32_16x16x32_bf16 a[12:15], a[180:183], v[188:191], a[12:15]
    ds_read_b64_tr_b16 a[172:173], v37 offset:36992
    v_mfma_f32_16x16x32_bf16 a[16:19], a[180:183], v[196:199], a[16:19]
    ds_read_b64_tr_b16 a[174:175], v37 offset:43136
    v_mfma_f32_16x16x32_bf16 a[20:23], a[180:183], v[204:207], a[20:23]
    buffer_load_dwordx4 v6, s[4:7], s24 offen offset:1024 lds
    s_waitcnt lgkmcnt(8)
    v_mfma_f32_16x16x32_bf16 a[24:27], a[184:187], v[188:191], a[24:27]
    ds_read_b64_tr_b16 a[176:177], v28 offset:37120
    v_mfma_f32_16x16x32_bf16 a[28:31], a[184:187], v[196:199], a[28:31]
    ds_read_b64_tr_b16 a[178:179], v28 offset:43264
    v_mfma_f32_16x16x32_bf16 a[32:35], a[184:187], v[204:207], a[32:35]
    v_mfma_f32_16x16x32_bf16 a[36:39], a[188:191], v[188:191], a[36:39]
    ds_read_b64_tr_b16 a[180:181], v31 offset:37120
    v_mfma_f32_16x16x32_bf16 a[40:43], a[188:191], v[196:199], a[40:43]
    ds_read_b64_tr_b16 a[182:183], v31 offset:43264
    v_mfma_f32_16x16x32_bf16 a[44:47], a[188:191], v[204:207], a[44:47]
    buffer_load_dwordx4 v7, s[4:7], s24 offen offset:2048 lds
    s_waitcnt lgkmcnt(8)
    v_mfma_f32_16x16x32_bf16 a[48:51], a[160:163], v[188:191], a[48:51]
    ds_read_b64_tr_b16 a[184:185], v34 offset:37120
    v_mfma_f32_16x16x32_bf16 a[52:55], a[160:163], v[196:199], a[52:55]
    ds_read_b64_tr_b16 a[186:187], v34 offset:43264
    v_mfma_f32_16x16x32_bf16 a[56:59], a[160:163], v[204:207], a[56:59]
    v_mfma_f32_16x16x32_bf16 a[60:63], a[164:167], v[188:191], a[60:63]
    ds_read_b64_tr_b16 a[188:189], v37 offset:37120
    v_mfma_f32_16x16x32_bf16 a[64:67], a[164:167], v[196:199], a[64:67]
    ds_read_b64_tr_b16 a[190:191], v37 offset:43264
    v_mfma_f32_16x16x32_bf16 a[68:71], a[164:167], v[204:207], a[68:71]
    s_waitcnt vmcnt(18)
    s_barrier
    s_waitcnt lgkmcnt(8)
    v_mfma_f32_16x16x32_bf16 a[72:75], a[168:171], v[188:191], a[72:75]
    ds_read_b64_tr_b16 a[160:161], v38 offset:24576
    v_mfma_f32_16x16x32_bf16 a[76:79], a[168:171], v[196:199], a[76:79]
    ds_read_b64_tr_b16 a[162:163], v38 offset:26112
    v_mfma_f32_16x16x32_bf16 a[80:83], a[168:171], v[204:207], a[80:83]
    ds_read_b128 a[192:195], v50 offset:0
    v_mfma_f32_16x16x32_bf16 a[84:87], a[172:175], v[188:191], a[84:87]
    ds_read_b64_tr_b16 a[164:165], v41 offset:24576
    v_mfma_f32_16x16x32_bf16 a[88:91], a[172:175], v[196:199], a[88:91]
    ds_read_b64_tr_b16 a[166:167], v41 offset:26112
    v_mfma_f32_16x16x32_bf16 a[92:95], a[172:175], v[204:207], a[92:95]
    ds_read_b128 a[196:199], v50 offset:2048
    s_waitcnt lgkmcnt(10)
    v_mfma_f32_16x16x32_bf16 a[96:99], a[176:179], v[188:191], a[96:99]
    ds_read_b64_tr_b16 a[168:169], v44 offset:24576
    v_mfma_f32_16x16x32_bf16 a[100:103], a[176:179], v[196:199], a[100:103]
    ds_read_b64_tr_b16 a[170:171], v44 offset:26112
    v_mfma_f32_16x16x32_bf16 a[104:107], a[176:179], v[204:207], a[104:107]
    ds_read_b128 a[200:203], v50 offset:4096
    v_mfma_f32_16x16x32_bf16 a[108:111], a[180:183], v[188:191], a[108:111]
    ds_read_b64_tr_b16 a[172:173], v47 offset:24576
    v_mfma_f32_16x16x32_bf16 a[112:115], a[180:183], v[196:199], a[112:115]
    ds_read_b64_tr_b16 a[174:175], v47 offset:26112
    v_mfma_f32_16x16x32_bf16 a[116:119], a[180:183], v[204:207], a[116:119]
    s_waitcnt lgkmcnt(11)
    v_mfma_f32_16x16x32_bf16 a[120:123], a[184:187], v[188:191], a[120:123]
    ds_read_b64_tr_b16 a[176:177], v38 offset:24704
    v_mfma_f32_16x16x32_bf16 a[124:127], a[184:187], v[196:199], a[124:127]
    ds_read_b64_tr_b16 a[178:179], v38 offset:26240
    v_mfma_f32_16x16x32_bf16 a[128:131], a[184:187], v[204:207], a[128:131]
    v_mfma_f32_16x16x32_bf16 a[132:135], a[188:191], v[188:191], a[132:135]
    ds_read_b64_tr_b16 a[180:181], v41 offset:24704
    v_mfma_f32_16x16x32_bf16 a[136:139], a[188:191], v[196:199], a[136:139]
    ds_read_b64_tr_b16 a[182:183], v41 offset:26240
    v_mfma_f32_16x16x32_bf16 a[140:143], a[188:191], v[204:207], a[140:143]
    s_nop 7
    v_accvgpr_read_b32 v64, a144
    v_accvgpr_read_b32 v65, a148
    v_accvgpr_read_b32 v66, a152
    v_add_f32 v65, v65, v66
    v_add_f32 v65, v65, v64
    v_mov_b32 v67, 0x4f400000
    s_nop 0
    v_cmp_le_f32 vcc, v65, v67
    s_nop 4
    s_cmp_eq_u64 vcc, -1
    s_cbranch_scc0 L_slow
L_slow_ret:
    s_cmp_eq_u32 s30, 0
    s_cbranch_scc1 L_nopre
    s_cmp_lg_u32 s31, 0
    s_cbranch_scc1 L_poll9_d
    v_accvgpr_read_b32 v104, a240
    v_accvgpr_read_b32 v106, a241
    s_mov_b32 s34, 0
L_poll9:
    buffer_load_dword v105, v104, s[52:55], 0 offen sc1
    buffer_load_dword v107, v106, s[52:55], 0 offen sc1
    s_waitcnt vmcnt(0)
    v_readfirstlane_b32 s35, v105
    v_readfirstlane_b32 s101, v107
    s_add_u32 s34, s34, 1
    s_nop 2
    s_lshr_b32 s35, s35, 0
    s_and_b32 s35, s35, 0xff
    s_lshr_b32 s101, s101, 16
    s_and_b32 s101, s101, 0xff
    s_cselect_b32 s35, s35, 0
    s_cmp_ge_u32 s35, 4
    s_cbranch_scc1 L_poll9_d
    s_sleep 2
    s_cmp_lt_u32 s34, 0x80000
    s_cbranch_scc1 L_poll9
L_poll9_d:
    s_barrier
    v_accvgpr_read_b32 v2, a228
    v_accvgpr_read_b32 v5, a231
    v_accvgpr_read_b32 v3, a229
    v_accvgpr_read_b32 v6, a232
    v_accvgpr_read_b32 v4, a230
    v_accvgpr_read_b32 v7, a233
    s_mov_b32 s99, 0
    s_add_u32 s34, s98, s99
    s_and_b32 s34, s34, 3
    s_lshl_b32 s34, s34, 1
    s_lshr_b32 s35, s99, 2
    s_add_u32 s34, s34, s35
    s_mul_i32 s34, s34, 6
    s_lshl_b32 s86, s34, 10
    s_mul_i32 s87, s34, 40960
    s_add_u32 m0, s29, 0
    s_nop 0
    buffer_load_dwordx4 v2, s[36:39], s86 offen lds
    buffer_load_dwordx4 v3, s[36:39], s86 offen offset:1024 lds
    buffer_load_dwordx4 v4, s[36:39], s86 offen offset:2048 lds
    s_add_u32 m0, s29, 12288
    s_nop 0
    buffer_load_dwordx4 v5, s[40:43], s87 offen lds
    buffer_load_dwordx4 v6, s[40:43], s87 offen offset:1024 lds
    buffer_load_dwordx4 v7, s[40:43], s87 offen offset:2048 lds
    s_add_u32 s86, s86, 1024
    s_add_u32 s87, s87, 40960
    s_add_u32 m0, s29, 24576
    s_nop 0
    buffer_load_dwordx4 v2, s[36:39], s86 offen lds
    buffer_load_dwordx4 v3, s[36:39], s86 offen offset:1024 lds
    buffer_load_dwordx4 v4, s[36:39], s86 offen offset:2048 lds
    s_add_u32 m0, s29, 36864
    s_nop 0
    buffer_load_dwordx4 v5, s[40:43], s87 offen lds
    buffer_load_dwordx4 v6, s[40:43], s87 offen offset:1024 lds
    buffer_load_dwordx4 v7, s[40:43], s87 offen offset:2048 lds
    s_add_u32 s86, s86, 1024
    s_add_u32 s87, s87, 40960
    s_add_u32 m0, s29, 49152
    s_nop 0
    buffer_load_dwordx4 v2, s[36:39], s86 offen lds
    buffer_load_dwordx4 v3, s[36:39], s86 offen offset:1024 lds
    buffer_load_dwordx4 v4, s[36:39], s86 offen offset:2048 lds
    s_add_u32 m0, s29, 61440
    s_nop 0
    buffer_load_dwordx4 v5, s[40:43], s87 offen lds
    buffer_load_dwordx4 v6, s[40:43], s87 offen offset:1024 lds
    buffer_load_dwordx4 v7, s[40:43], s87 offen offset:2048 lds
    s_add_u32 s86, s86, 1024
    s_add_u32 s87, s87, 40960
    s_add_u32 m0, s29, 73728
    s_nop 0
    buffer_load_dwordx4 v2, s[36:39], s86 offen lds
    buffer_load_dwordx4 v3, s[36:39], s86 offen offset:1024 lds
    buffer_load_dwordx4 v4, s[36:39], s86 offen offset:2048 lds
L_nopre:
    s_mov_b32 s70, 1965120
    s_nop 7
    v_accvgpr_read_b32 v56, a144
    v_accvgpr_read_b32 v58, a148
    v_accvgpr_read_b32 v60, a152
    v_rcp_f32 v56, v56
    v_rcp_f32 v58, v58
    v_rcp_f32 v60, v60
    v_mov_b32 v57, v56
    v_mov_b32 v59, v58
    v_mov_b32 v61, v60
    v_accvgpr_read_b32 v64, a72
    v_accvgpr_read_b32 v65, a73
    v_accvgpr_read_b32 v66, a74
    v_accvgpr_read_b32 v67, a75
    v_accvgpr_read_b32 v68, a84
    v_accvgpr_read_b32 v69, a85
    v_accvgpr_read_b32 v70, a86
    v_accvgpr_read_b32 v71, a87
    v_pk_mul_f32 v[64:65], v[64:65], v[56:57]
    v_pk_mul_f32 v[66:67], v[66:67], v[56:57]
    v_pk_mul_f32 v[68:69], v[68:69], v[56:57]
    v_pk_mul_f32 v[70:71], v[70:71], v[56:57]
    v_accvgpr_read_b32 v76, a76
    v_accvgpr_read_b32 v77, a77
    v_accvgpr_read_b32 v78, a78
    v_accvgpr_read_b32 v79, a79
    v_cvt_pk_bf16_f32 v72, v64, v65
    v_cvt_pk_bf16_f32 v73, v66, v67
    v_cvt_pk_bf16_f32 v74, v68, v69
    v_cvt_pk_bf16_f32 v75, v70, v71
    v_accvgpr_read_b32 v80, a88
    v_accvgpr_read_b32 v81, a89
    v_accvgpr_read_b32 v82, a90
    v_accvgpr_read_b32 v83, a91
    v_accvgpr_write_b32 a72, v72
    v_accvgpr_write_b32 a73, v73
    v_accvgpr_write_b32 a74, v74
    v_accvgpr_write_b32 a75, v75
    v_pk_mul_f32 v[76:77], v[76:77], v[58:59]
    v_pk_mul_f32 v[78:79], v[78:79], v[58:59]
    v_pk_mul_f32 v[80:81], v[80:81], v[58:59]
    v_pk_mul_f32 v[82:83], v[82:83], v[58:59]
    v_accvgpr_read_b32 v88, a80
    v_accvgpr_read_b32 v89, a81
    v_accvgpr_read_b32 v90, a82
    v_accvgpr_read_b32 v91, a83
    v_cvt_pk_bf16_f32 v84, v76, v77
    v_cvt_pk_bf16_f32 v85, v78, v79
    v_cvt_pk_bf16_f32 v86, v80, v81
    v_cvt_pk_bf16_f32 v87, v82, v83
    v_accvgpr_read_b32 v92, a92
    v_accvgpr_read_b32 v93, a93
    v_accvgpr_read_b32 v94, a94
    v_accvgpr_read_b32 v95, a95
    v_accvgpr_write_b32 a76, v84
    v_accvgpr_write_b32 a77, v85
    v_accvgpr_write_b32 a78, v86
    v_accvgpr_write_b32 a79, v87
    v_pk_mul_f32 v[88:89], v[88:89], v[60:61]
    v_pk_mul_f32 v[90:91], v[90:91], v[60:61]
    v_pk_mul_f32 v[92:93], v[92:93], v[60:61]
    v_pk_mul_f32 v[94:95], v[94:95], v[60:61]
    v_accvgpr_read_b32 v100, a96
    v_accvgpr_read_b32 v101, a97
    v_accvgpr_read_b32 v102, a98
    v_accvgpr_read_b32 v103, a99
    v_cvt_pk_bf16_f32 v96, v88, v89
    v_cvt_pk_bf16_f32 v97, v90, v91
    v_cvt_pk_bf16_f32 v98, v92, v93
    v_cvt_pk_bf16_f32 v99, v94, v95
    v_accvgpr_read_b32 v104, a108
    v_accvgpr_read_b32 v105, a109
    v_accvgpr_read_b32 v106, a110
    v_accvgpr_read_b32 v107, a111
    v_accvgpr_write_b32 a80, v96
    v_accvgpr_write_b32 a81, v97
    v_accvgpr_write_b32 a82, v98
    v_accvgpr_write_b32 a83, v99
    v_pk_mul_f32 v[100:101], v[100:101], v[56:57]
    v_pk_mul_f32 v[102:103], v[102:103], v[56:57]
    v_pk_mul_f32 v[104:105], v[104:105], v[56:57]
    v_pk_mul_f32 v[106:107], v[106:107], v[56:57]
    v_accvgpr_read_b32 v64, a100
    v_accvgpr_read_b32 v65, a101
    v_accvgpr_read_b32 v66, a102
    v_accvgpr_read_b32 v67, a103
    v_cvt_pk_bf16_f32 v108, v100, v101
    v_cvt_pk_bf16_f32 v109, v102, v103
    v_cvt_pk_bf16_f32 v110, v104, v105
    v_cvt_pk_bf16_f32 v111, v106, v107
    v_accvgpr_read_b32 v68, a112
    v_accvgpr_read_b32 v69, a113
    v_accvgpr_read_b32 v70, a114
    v_accvgpr_read_b32 v71, a115
    v_accvgpr_write_b32 a96, v108
    v_accvgpr_write_b32 a97, v109
    v_accvgpr_write_b32 a98, v110
    v_accvgpr_write_b32 a99, v111
    v_pk_mul_f32 v[64:65], v[64:65], v[58:59]
    v_pk_mul_f32 v[66:67], v[66:67], v[58:59]
    v_pk_mul_f32 v[68:69], v[68:69], v[58:59]
    v_pk_mul_f32 v[70:71], v[70:71], v[58:59]
    v_accvgpr_read_b32 v76, a104
    v_accvgpr_read_b32 v77, a105
    v_accvgpr_read_b32 v78, a106
    v_accvgpr_read_b32 v79, a107
    v_cvt_pk_bf16_f32 v72, v64, v65
    v_cvt_pk_bf16_f32 v73, v66, v67
    v_cvt_pk_bf16_f32 v74, v68, v69
    v_cvt_pk_bf16_f32 v75, v70, v71
    v_accvgpr_read_b32 v80, a116
    v_accvgpr_read_b32 v81, a117
    v_accvgpr_read_b32 v82, a118
    v_accvgpr_read_b32 v83, a119
    v_accvgpr_write_b32 a100, v72
    v_accvgpr_write_b32 a101, v73
    v_accvgpr_write_b32 a102, v74
    v_accvgpr_write_b32 a103, v75
    v_pk_mul_f32 v[76:77], v[76:77], v[60:61]
    v_pk_mul_f32 v[78:79], v[78:79], v[60:61]
    v_pk_mul_f32 v[80:81], v[80:81], v[60:61]
    v_pk_mul_f32 v[82:83], v[82:83], v[60:61]
    v_accvgpr_read_b32 v88, a120
    v_accvgpr_read_b32 v89, a121
    v_accvgpr_read_b32 v90, a122
    v_accvgpr_read_b32 v91, a123
    v_cvt_pk_bf16_f32 v84, v76, v77
    v_cvt_pk_bf16_f32 v85, v78, v79
    v_cvt_pk_bf16_f32 v86, v80, v81
    v_cvt_pk_bf16_f32 v87, v82, v83
    v_accvgpr_read_b32 v92, a132
    v_accvgpr_read_b32 v93, a133
    v_accvgpr_read_b32 v94, a134
    v_accvgpr_read_b32 v95, a135
    v_accvgpr_write_b32 a104, v84
    v_accvgpr_write_b32 a105, v85
    v_accvgpr_write_b32 a106, v86
    v_accvgpr_write_b32 a107, v87
    v_pk_mul_f32 v[88:89], v[88:89], v[56:57]
    v_pk_mul_f32 v[90:91], v[90:91], v[56:57]
    v_pk_mul_f32 v[92:93], v[92:93], v[56:57]
    v_pk_mul_f32 v[94:95], v[94:95], v[56:57]
    v_accvgpr_read_b32 v100, a124
    v_accvgpr_read_b32 v101, a125
    v_accvgpr_read_b32 v102, a126
    v_accvgpr_read_b32 v103, a127
    v_cvt_pk_bf16_f32 v96, v88, v89
    v_cvt_pk_bf16_f32 v97, v90, v91
    v_cvt_pk_bf16_f32 v98, v92, v93
    v_cvt_pk_bf16_f32 v99, v94, v95
    v_accvgpr_read_b32 v104, a136
    v_accvgpr_read_b32 v105, a137
    v_accvgpr_read_b32 v106, a138
    v_accvgpr_read_b32 v107, a139
    v_accvgpr_write_b32 a120, v96
    v_accvgpr_write_b32 a121, v97
    v_accvgpr_write_b32 a122, v98
    v_accvgpr_write_b32 a123, v99
    v_pk_mul_f32 v[100:101], v[100:101], v[58:59]
    v_pk_mul_f32 v[102:103], v[102:103], v[58:59]
    v_pk_mul_f32 v[104:105], v[104:105], v[58:59]
    v_pk_mul_f32 v[106:107], v[106:107], v[58:59]
    v_accvgpr_read_b32 v64, a128
    v_accvgpr_read_b32 v65, a129
    v_accvgpr_read_b32 v66, a130
    v_accvgpr_read_b32 v67, a131
    v_cvt_pk_bf16_f32 v108, v100, v101
    v_cvt_pk_bf16_f32 v109, v102, v103
    v_cvt_pk_bf16_f32 v110, v104, v105
    v_cvt_pk_bf16_f32 v111, v106, v107
    v_accvgpr_read_b32 v68, a140
    v_accvgpr_read_b32 v69, a141
    v_accvgpr_read_b32 v70, a142
    v_accvgpr_read_b32 v71, a143
    v_accvgpr_write_b32 a124, v108
    v_accvgpr_write_b32 a125, v109
    v_accvgpr_write_b32 a126, v110
    v_accvgpr_write_b32 a127, v111
    v_pk_mul_f32 v[64:65], v[64:65], v[60:61]
    v_pk_mul_f32 v[66:67], v[66:67], v[60:61]
    v_pk_mul_f32 v[68:69], v[68:69], v[60:61]
    v_pk_mul_f32 v[70:71], v[70:71], v[60:61]
    v_accvgpr_read_b32 v76, a0
    v_accvgpr_read_b32 v77, a1
    v_accvgpr_read_b32 v78, a2
    v_accvgpr_read_b32 v79, a3
    v_cvt_pk_bf16_f32 v72, v64, v65
    v_cvt_pk_bf16_f32 v73, v66, v67
    v_cvt_pk_bf16_f32 v74, v68, v69
    v_cvt_pk_bf16_f32 v75, v70, v71
    v_accvgpr_read_b32 v80, a12
    v_accvgpr_read_b32 v81, a13
    v_accvgpr_read_b32 v82, a14
    v_accvgpr_read_b32 v83, a15
    v_accvgpr_write_b32 a128, v72
    v_accvgpr_write_b32 a129, v73
    v_accvgpr_write_b32 a130, v74
    v_accvgpr_write_b32 a131, v75
    v_pk_mul_f32 v[76:77], v[76:77], v[56:57]
    v_pk_mul_f32 v[78:79], v[78:79], v[56:57]
    v_pk_mul_f32 v[80:81], v[80:81], v[56:57]
    v_pk_mul_f32 v[82:83], v[82:83], v[56:57]
    v_accvgpr_read_b32 v88, a4
    v_accvgpr_read_b32 v89, a5
    v_accvgpr_read_b32 v90, a6
    v_accvgpr_read_b32 v91, a7
    v_cvt_pk_bf16_f32 v84, v76, v77
    v_cvt_pk_bf16_f32 v85, v78, v79
    v_cvt_pk_bf16_f32 v86, v80, v81
    v_cvt_pk_bf16_f32 v87, v82, v83
    v_accvgpr_read_b32 v92, a16
    v_accvgpr_read_b32 v93, a17
    v_accvgpr_read_b32 v94, a18
    v_accvgpr_read_b32 v95, a19
    v_accvgpr_write_b32 a84, v84
    v_accvgpr_write_b32 a85, v85
    v_accvgpr_write_b32 a86, v86
    v_accvgpr_write_b32 a87, v87
    v_pk_mul_f32 v[88:89], v[88:89], v[58:59]
    v_pk_mul_f32 v[90:91], v[90:91], v[58:59]
    v_pk_mul_f32 v[92:93], v[92:93], v[58:59]
    v_pk_mul_f32 v[94:95], v[94:95], v[58:59]
    v_accvgpr_read_b32 v100, a8
    v_accvgpr_read_b32 v101, a9
    v_accvgpr_read_b32 v102, a10
    v_accvgpr_read_b32 v103, a11
    v_cvt_pk_bf16_f32 v96, v88, v89
    v_cvt_pk_bf16_f32 v97, v90, v91
    v_cvt_pk_bf16_f32 v98, v92, v93
    v_cvt_pk_bf16_f32 v99, v94, v95
    v_accvgpr_read_b32 v104, a20
    v_accvgpr_read_b32 v105, a21
    v_accvgpr_read_b32 v106, a22
    v_accvgpr_read_b32 v107, a23
    v_accvgpr_write_b32 a88, v96
    v_accvgpr_write_b32 a89, v97
    v_accvgpr_write_b32 a90, v98
    v_accvgpr_write_b32 a91, v99
    v_pk_mul_f32 v[100:101], v[100:101], v[60:61]
    v_pk_mul_f32 v[102:103], v[102:103], v[60:61]
    v_pk_mul_f32 v[104:105], v[104:105], v[60:61]
    v_pk_mul_f32 v[106:107], v[106:107], v[60:61]
    v_accvgpr_read_b32 v64, a24
    v_accvgpr_read_b32 v65, a25
    v_accvgpr_read_b32 v66, a26
    v_accvgpr_read_b32 v67, a27
    v_cvt_pk_bf16_f32 v108, v100, v101
    v_cvt_pk_bf16_f32 v109, v102, v103
    v_cvt_pk_bf16_f32 v110, v104, v105
    v_cvt_pk_bf16_f32 v111, v106, v107
    v_accvgpr_read_b32 v68, a36
    v_accvgpr_read_b32 v69, a37
    v_accvgpr_read_b32 v70, a38
    v_accvgpr_read_b32 v71, a39
    v_accvgpr_write_b32 a92, v108
    v_accvgpr_write_b32 a93, v109
    v_accvgpr_write_b32 a94, v110
    v_accvgpr_write_b32 a95, v111
    v_pk_mul_f32 v[64:65], v[64:65], v[56:57]
    v_pk_mul_f32 v[66:67], v[66:67], v[56:57]
    v_pk_mul_f32 v[68:69], v[68:69], v[56:57]
    v_pk_mul_f32 v[70:71], v[70:71], v[56:57]
    v_accvgpr_read_b32 v76, a28
    v_accvgpr_read_b32 v77, a29
    v_accvgpr_read_b32 v78, a30
    v_accvgpr_read_b32 v79, a31
    v_cvt_pk_bf16_f32 v72, v64, v65
    v_cvt_pk_bf16_f32 v73, v66, v67
    v_cvt_pk_bf16_f32 v74, v68, v69
    v_cvt_pk_bf16_f32 v75, v70, v71
    v_accvgpr_read_b32 v80, a40
    v_accvgpr_read_b32 v81, a41
    v_accvgpr_read_b32 v82, a42
    v_accvgpr_read_b32 v83, a43
    v_accvgpr_write_b32 a108, v72
    v_accvgpr_write_b32 a109, v73
    v_accvgpr_write_b32 a110, v74
    v_accvgpr_write_b32 a111, v75
    v_pk_mul_f32 v[76:77], v[76:77], v[58:59]
    v_pk_mul_f32 v[78:79], v[78:79], v[58:59]
    v_pk_mul_f32 v[80:81], v[80:81], v[58:59]
    v_pk_mul_f32 v[82:83], v[82:83], v[58:59]
    v_accvgpr_read_b32 v88, a32
    v_accvgpr_read_b32 v89, a33
    v_accvgpr_read_b32 v90, a34
    v_accvgpr_read_b32 v91, a35
    v_cvt_pk_bf16_f32 v84, v76, v77
    v_cvt_pk_bf16_f32 v85, v78, v79
    v_cvt_pk_bf16_f32 v86, v80, v81
    v_cvt_pk_bf16_f32 v87, v82, v83
    v_accvgpr_read_b32 v92, a44
    v_accvgpr_read_b32 v93, a45
    v_accvgpr_read_b32 v94, a46
    v_accvgpr_read_b32 v95, a47
    v_accvgpr_write_b32 a112, v84
    v_accvgpr_write_b32 a113, v85
    v_accvgpr_write_b32 a114, v86
    v_accvgpr_write_b32 a115, v87
    v_pk_mul_f32 v[88:89], v[88:89], v[60:61]
    v_pk_mul_f32 v[90:91], v[90:91], v[60:61]
    v_pk_mul_f32 v[92:93], v[92:93], v[60:61]
    v_pk_mul_f32 v[94:95], v[94:95], v[60:61]
    v_accvgpr_read_b32 v100, a48
    v_accvgpr_read_b32 v101, a49
    v_accvgpr_read_b32 v102, a50
    v_accvgpr_read_b32 v103, a51
    v_cvt_pk_bf16_f32 v96, v88, v89
    v_cvt_pk_bf16_f32 v97, v90, v91
    v_cvt_pk_bf16_f32 v98, v92, v93
    v_cvt_pk_bf16_f32 v99, v94, v95
    v_accvgpr_read_b32 v104, a60
    v_accvgpr_read_b32 v105, a61
    v_accvgpr_read_b32 v106, a62
    v_accvgpr_read_b32 v107, a63
    v_accvgpr_write_b32 a116, v96
    v_accvgpr_write_b32 a117, v97
    v_accvgpr_write_b32 a118, v98
    v_accvgpr_write_b32 a119, v99
    v_pk_mul_f32 v[100:101], v[100:101], v[56:57]
    v_pk_mul_f32 v[102:103], v[102:103], v[56:57]
    v_pk_mul_f32 v[104:105], v[104:105], v[56:57]
    v_pk_mul_f32 v[106:107], v[106:107], v[56:57]
    v_accvgpr_read_b32 v64, a52
    v_accvgpr_read_b32 v65, a53
    v_accvgpr_read_b32 v66, a54
    v_accvgpr_read_b32 v67, a55
    v_cvt_pk_bf16_f32 v108, v100, v101
    v_cvt_pk_bf16_f32 v109, v102, v103
    v_cvt_pk_bf16_f32 v110, v104, v105
    v_cvt_pk_bf16_f32 v111, v106, v107
    v_accvgpr_read_b32 v68, a64
    v_accvgpr_read_b32 v69, a65
    v_accvgpr_read_b32 v70, a66
    v_accvgpr_read_b32 v71, a67
    v_accvgpr_write_b32 a132, v108
    v_accvgpr_write_b32 a133, v109
    v_accvgpr_write_b32 a134, v110
    v_accvgpr_write_b32 a135, v111
    v_pk_mul_f32 v[64:65], v[64:65], v[58:59]
    v_pk_mul_f32 v[66:67], v[66:67], v[58:59]
    v_pk_mul_f32 v[68:69], v[68:69], v[58:59]
    v_pk_mul_f32 v[70:71], v[70:71], v[58:59]
    v_accvgpr_read_b32 v76, a56
    v_accvgpr_read_b32 v77, a57
    v_accvgpr_read_b32 v78, a58
    v_accvgpr_read_b32 v79, a59
    v_cvt_pk_bf16_f32 v72, v64, v65
    v_cvt_pk_bf16_f32 v73, v66, v67
    v_cvt_pk_bf16_f32 v74, v68, v69
    v_cvt_pk_bf16_f32 v75, v70, v71
    v_accvgpr_read_b32 v80, a68
    v_accvgpr_read_b32 v81, a69
    v_accvgpr_read_b32 v82, a70
    v_accvgpr_read_b32 v83, a71
    v_accvgpr_write_b32 a136, v72
    v_accvgpr_write_b32 a137, v73
    v_accvgpr_write_b32 a138, v74
    v_accvgpr_write_b32 a139, v75
    v_pk_mul_f32 v[76:77], v[76:77], v[60:61]
    v_pk_mul_f32 v[78:79], v[78:79], v[60:61]
    v_pk_mul_f32 v[80:81], v[80:81], v[60:61]
    v_pk_mul_f32 v[82:83], v[82:83], v[60:61]
    v_cvt_pk_bf16_f32 v84, v76, v77
    v_cvt_pk_bf16_f32 v85, v78, v79
    v_cvt_pk_bf16_f32 v86, v80, v81
    v_cvt_pk_bf16_f32 v87, v82, v83
    v_accvgpr_write_b32 a140, v84
    v_accvgpr_write_b32 a141, v85
    v_accvgpr_write_b32 a142, v86
    v_accvgpr_write_b32 a143, v87
    s_add_u32 s30, s30, 1
    s_cmp_lt_u32 s30, 2
    s_cbranch_scc1 L_item
    v_accvgpr_read_b32 v8, a234
    v_accvgpr_read_b32 v11, a235
    v_accvgpr_read_b32 v14, a236
    v_accvgpr_read_b32 v17, a237
    v_accvgpr_read_b32 v20, a238
    v_accvgpr_read_b32 v23, a239
    v_add_u32 v9, 49152, v8
    v_add_u32 v10, 98304, v8
    v_add_u32 v12, 49152, v11
    v_add_u32 v13, 98304, v11
    v_add_u32 v15, 49152, v14
    v_add_u32 v16, 98304, v14
    v_add_u32 v18, 49152, v17
    v_add_u32 v19, 98304, v17
    v_add_u32 v21, 49152, v20
    v_add_u32 v22, 98304, v20
    v_add_u32 v24, 49152, v23
    v_add_u32 v25, 98304, v23
    v_mov_b32 v128, 0
    v_mov_b32 v129, 0
    v_mov_b32 v130, 0
    v_mov_b32 v131, 0
    v_mov_b32 v132, 0
    v_mov_b32 v133, 0
    v_mov_b32 v134, 0
    v_mov_b32 v135, 0
    v_mov_b32 v136, 0
    v_mov_b32 v137, 0
    v_mov_b32 v138, 0
    v_mov_b32 v139, 0
    v_mov_b32 v140, 0
    v_mov_b32 v141, 0
    v_mov_b32 v142, 0
    v_mov_b32 v143, 0
    v_mov_b32 v144, 0
    v_mov_b32 v145, 0
    v_mov_b32 v146, 0
    v_mov_b32 v147, 0
    v_mov_b32 v148, 0
    v_mov_b32 v149, 0
    v_mov_b32 v150, 0
    v_mov_b32 v151, 0
    v_mov_b32 v152, 0
    v_mov_b32 v153, 0
    v_mov_b32 v154, 0
    v_mov_b32 v155, 0
    v_mov_b32 v156, 0
    v_mov_b32 v157, 0
    v_mov_b32 v158, 0
    v_mov_b32 v159, 0
    v_mov_b32 v160, 0
    v_mov_b32 v161, 0
    v_mov_b32 v162, 0
    v_mov_b32 v163, 0
    v_mov_b32 v164, 0
    v_mov_b32 v165, 0
    v_mov_b32 v166, 0
    v_mov_b32 v167, 0
    v_mov_b32 v168, 0
    v_mov_b32 v169, 0
    v_mov_b32 v170, 0
    v_mov_b32 v171, 0
    v_mov_b32 v172, 0
    v_mov_b32 v173, 0
    v_mov_b32 v174, 0
    v_mov_b32 v175, 0
    v_mov_b32 v176, 0
    v_mov_b32 v177, 0
    v_mov_b32 v178, 0
    v_mov_b32 v179, 0
    v_mov_b32 v180, 0
    v_mov_b32 v181, 0
    v_mov_b32 v182, 0
    v_mov_b32 v183, 0
    v_mov_b32 v184, 0
    v_mov_b32 v185, 0
    v_mov_b32 v186, 0
    v_mov_b32 v187, 0
    v_mov_b32 v188, 0
    v_mov_b32 v189, 0
    v_mov_b32 v190, 0
    v_mov_b32 v191, 0
    v_mov_b32 v192, 0
    v_mov_b32 v193, 0
    v_mov_b32 v194, 0
    v_mov_b32 v195, 0
    v_mov_b32 v196, 0
    v_mov_b32 v197, 0
    v_mov_b32 v198, 0
    v_mov_b32 v199, 0
    v_mov_b32 v200, 0
    v_mov_b32 v201, 0
    v_mov_b32 v202, 0
    v_mov_b32 v203, 0
    v_mov_b32 v204, 0
    v_mov_b32 v205, 0
    v_mov_b32 v206, 0
    v_mov_b32 v207, 0
    v_mov_b32 v208, 0
    v_mov_b32 v209, 0
    v_mov_b32 v210, 0
    v_mov_b32 v211, 0
    v_mov_b32 v212, 0
    v_mov_b32 v213, 0
    v_mov_b32 v214, 0
    v_mov_b32 v215, 0
    v_mov_b32 v216, 0
    v_mov_b32 v217, 0
    v_mov_b32 v218, 0
    v_mov_b32 v219, 0
    v_mov_b32 v220, 0
    v_mov_b32 v221, 0
    v_mov_b32 v222, 0
    v_mov_b32 v223, 0
    v_mov_b32 v224, 0
    v_mov_b32 v225, 0
    v_mov_b32 v226, 0
    v_mov_b32 v227, 0
    v_mov_b32 v228, 0
    v_mov_b32 v229, 0
    v_mov_b32 v230, 0
    v_mov_b32 v231, 0
    v_mov_b32 v232, 0
    v_mov_b32 v233, 0
    v_mov_b32 v234, 0
    v_mov_b32 v235, 0
    v_mov_b32 v236, 0
    v_mov_b32 v237, 0
    v_mov_b32 v238, 0
    v_mov_b32 v239, 0
    v_mov_b32 v240, 0
    v_mov_b32 v241, 0
    v_mov_b32 v242, 0
    v_mov_b32 v243, 0
    v_mov_b32 v244, 0
    v_mov_b32 v245, 0
    v_mov_b32 v246, 0
    v_mov_b32 v247, 0
    s_mov_b32 s88, 8
    s_waitcnt vmcnt(9)
    s_barrier
    s_waitcnt lgkmcnt(14)
    ds_read_b128 a[0:3], v8 offset:0
    s_waitcnt lgkmcnt(14)
    ds_read_b128 a[4:7], v8 offset:1024
    s_waitcnt lgkmcnt(14)
    ds_read_b128 a[8:11], v8 offset:2048
    s_waitcnt lgkmcnt(14)
    ds_read_b128 a[12:15], v8 offset:3072
    s_waitcnt lgkmcnt(14)
    ds_read_b128 a[16:19], v8 offset:4096
    s_waitcnt lgkmcnt(14)
    ds_read_b128 a[20:23], v8 offset:5120
    s_waitcnt lgkmcnt(14)
    ds_read_b64_tr_b16 a[48:49], v11 offset:12288
    s_waitcnt lgkmcnt(14)
    ds_read_b64_tr_b16 a[50:51], v11 offset:18432
    s_waitcnt lgkmcnt(14)
    ds_read_b64_tr_b16 a[52:53], v14 offset:12288
    s_waitcnt lgkmcnt(14)
    ds_read_b64_tr_b16 a[54:55], v14 offset:18432
    s_waitcnt lgkmcnt(14)
    ds_read_b64_tr_b16 a[56:57], v17 offset:12288
    s_waitcnt lgkmcnt(14)
    ds_read_b64_tr_b16 a[58:59], v17 offset:18432
    s_add_u32 m0, s29, 86016
    s_waitcnt lgkmcnt(4)
    v_mfma_f32_16x16x32_bf16 v[128:131], a[48:51], a[0:3], v[128:131]
    ds_read_b64_tr_b16 a[60:61], v20 offset:12288
    v_mfma_f32_16x16x32_bf16 v[132:135], a[48:51], a[4:7], v[132:135]
    ds_read_b64_tr_b16 a[62:63], v20 offset:18432
    v_mfma_f32_16x16x32_bf16 v[136:139], a[48:51], a[8:11], v[136:139]
    ds_read_b128 a[24:27], v8 offset:24576
    v_mfma_f32_16x16x32_bf16 v[140:143], a[48:51], a[12:15], v[140:143]
    ds_read_b128 a[28:31], v8 offset:25600
    v_mfma_f32_16x16x32_bf16 v[144:147], a[48:51], a[16:19], v[144:147]
    ds_read_b128 a[32:35], v8 offset:26624
    v_mfma_f32_16x16x32_bf16 v[148:151], a[48:51], a[20:23], v[148:151]
    ds_read_b128 a[36:39], v8 offset:27648
    s_waitcnt lgkmcnt(8)
    v_mfma_f32_16x16x32_bf16 v[152:155], a[52:55], a[0:3], v[152:155]
    ds_read_b64_tr_b16 a[64:65], v23 offset:12288
    v_mfma_f32_16x16x32_bf16 v[156:159], a[52:55], a[4:7], v[156:159]
    ds_read_b64_tr_b16 a[66:67], v23 offset:18432
    v_mfma_f32_16x16x32_bf16 v[160:163], a[52:55], a[8:11], v[160:163]
    ds_read_b128 a[40:43], v8 offset:28672
    v_mfma_f32_16x16x32_bf16 v[164:167], a[52:55], a[12:15], v[164:167]
    ds_read_b128 a[44:47], v8 offset:29696
    v_mfma_f32_16x16x32_bf16 v[168:171], a[52:55], a[16:19], v[168:171]
    buffer_load_dwordx4 v5, s[40:43], s87 offen lds
    v_mfma_f32_16x16x32_bf16 v[172:175], a[52:55], a[20:23], v[172:175]
    buffer_load_dwordx4 v6, s[40:43], s87 offen offset:1024 lds
    s_waitcnt lgkmcnt(10)
    v_mfma_f32_16x16x32_bf16 v[176:179], a[56:59], a[0:3], v[176:179]
    ds_read_b64_tr_b16 a[48:49], v11 offset:36864
    v_mfma_f32_16x16x32_bf16 v[180:183], a[56:59], a[4:7], v[180:183]
    ds_read_b64_tr_b16 a[50:51], v11 offset:43008
    v_mfma_f32_16x16x32_bf16 v[184:187], a[56:59], a[8:11], v[184:187]
    buffer_load_dwordx4 v7, s[40:43], s87 offen offset:2048 lds
    s_add_u32 s33, s32, 0
    v_mfma_f32_16x16x32_bf16 v[188:191], a[56:59], a[12:15], v[188:191]
    s_add_u32 s86, s86, 1024
    s_add_u32 s87, s87, 40960
    s_add_u32 m0, s29, 98304
    v_mfma_f32_16x16x32_bf16 v[192:195], a[56:59], a[16:19], v[192:195]
    buffer_store_dwordx4 a[84:87], v1, s[20:23], s33 offen sc1
    s_add_u32 s33, s32, 196608
    v_mfma_f32_16x16x32_bf16 v[196:199], a[56:59], a[20:23], v[196:199]
    buffer_store_dwordx4 a[88:91], v1, s[20:23], s33 offen sc1
    s_waitcnt lgkmcnt(10)
    v_mfma_f32_16x16x32_bf16 v[200:203], a[60:63], a[0:3], v[200:203]
    s_add_u32 s33, s32, 393216
    ds_read_b64_tr_b16 a[52:53], v14 offset:36864
    v_mfma_f32_16x16x32_bf16 v[204:207], a[60:63], a[4:7], v[204:207]
    ds_read_b64_tr_b16 a[54:55], v14 offset:43008
    v_mfma_f32_16x16x32_bf16 v[208:211], a[60:63], a[8:11], v[208:211]
    buffer_store_dwordx4 a[92:95], v1, s[20:23], s33 offen sc1
    s_add_u32 s33, s32, 1024
    v_mfma_f32_16x16x32_bf16 v[212:215], a[60:63], a[12:15], v[212:215]
    buffer_store_dwordx4 a[108:111], v1, s[20:23], s33 offen sc1
    s_add_u32 s33, s32, 197632
    v_mfma_f32_16x16x32_bf16 v[216:219], a[60:63], a[16:19], v[216:219]
    buffer_store_dwordx4 a[112:115], v1, s[20:23], s33 offen sc1
    s_add_u32 s33, s32, 394240
    v_mfma_f32_16x16x32_bf16 v[220:223], a[60:63], a[20:23], v[220:223]
    buffer_store_dwordx4 a[116:119], v1, s[20:23], s33 offen sc1
    s_waitcnt lgkmcnt(6)
    v_mfma_f32_16x16x32_bf16 v[224:227], a[64:67], a[0:3], v[224:227]
    ds_read_b64_tr_b16 a[56:57], v17 offset:36864
    v_mfma_f32_16x16x32_bf16 v[228:231], a[64:67], a[4:7], v[228:231]
    ds_read_b64_tr_b16 a[58:59], v17 offset:43008
    v_mfma_f32_16x16x32_bf16 v[232:235], a[64:67], a[8:11], v[232:235]
    buffer_load_dwordx4 v2, s[36:39], s86 offen lds
    v_mfma_f32_16x16x32_bf16 v[236:239], a[64:67], a[12:15], v[236:239]
    buffer_load_dwordx4 v3, s[36:39], s86 offen offset:1024 lds
    v_mfma_f32_16x16x32_bf16 v[240:243], a[64:67], a[16:19], v[240:243]
    buffer_load_dwordx4 v4, s[36:39], s86 offen offset:2048 lds
    s_add_u32 m0, s29, 110592
    v_mfma_f32_16x16x32_bf16 v[244:247], a[64:67], a[20:23], v[244:247]
    buffer_load_dwordx4 v5, s[40:43], s87 offen lds
    s_waitcnt lgkmcnt(4)
    v_mfma_f32_16x16x32_bf16 v[128:131], a[48:51], a[24:27], v[128:131]
    ds_read_b64_tr_b16 a[60:61], v20 offset:36864
    v_mfma_f32_16x16x32_bf16 v[132:135], a[48:51], a[28:31], v[132:135]
    ds_read_b64_tr_b16 a[62:63], v20 offset:43008
    v_mfma_f32_16x16x32_bf16 v[136:139], a[48:51], a[32:35], v[136:139]
    buffer_load_dwordx4 v6, s[40:43], s87 offen offset:1024 lds
    v_mfma_f32_16x16x32_bf16 v[140:143], a[48:51], a[36:39], v[140:143]
    buffer_load_dwordx4 v7, s[40:43], s87 offen offset:2048 lds
    v_mfma_f32_16x16x32_bf16 v[144:147], a[48:51], a[40:43], v[144:147]
    s_add_u32 s86, s86, 1024
    s_add_u32 s87, s87, 40960
    s_add_u32 m0, s29, 122880
    v_mfma_f32_16x16x32_bf16 v[148:151], a[48:51], a[44:47], v[148:151]
    buffer_load_dwordx4 v2, s[36:39], s86 offen lds
    s_waitcnt lgkmcnt(4)
    v_mfma_f32_16x16x32_bf16 v[152:155], a[52:55], a[24:27], v[152:155]
    ds_read_b64_tr_b16 a[64:65], v23 offset:36864
    v_mfma_f32_16x16x32_bf16 v[156:159], a[52:55], a[28:31], v[156:159]
    ds_read_b64_tr_b16 a[66:67], v23 offset:43008
    v_mfma_f32_16x16x32_bf16 v[160:163], a[52:55], a[32:35], v[160:163]
    buffer_load_dwordx4 v3, s[36:39], s86 offen offset:1024 lds
    v_mfma_f32_16x16x32_bf16 v[164:167], a[52:55], a[36:39], v[164:167]
    buffer_load_dwordx4 v4, s[36:39], s86 offen offset:2048 lds
    v_mfma_f32_16x16x32_bf16 v[168:171], a[52:55], a[40:43], v[168:171]
    v_mfma_f32_16x16x32_bf16 v[172:175], a[52:55], a[44:47], v[172:175]
    s_waitcnt vmcnt(15)
    s_barrier
    s_waitcnt lgkmcnt(4)
    v_mfma_f32_16x16x32_bf16 v[176:179], a[56:59], a[24:27], v[176:179]
    s_add_u32 m0, s29, 135168
    ds_read_b64_tr_b16 a[48:49], v12 offset:12288
    v_mfma_f32_16x16x32_bf16 v[180:183], a[56:59], a[28:31], v[180:183]
    ds_read_b64_tr_b16 a[50:51], v12 offset:18432
    v_mfma_f32_16x16x32_bf16 v[184:187], a[56:59], a[32:35], v[184:187]
    ds_read_b128 a[0:3], v9 offset:0
    v_mfma_f32_16x16x32_bf16 v[188:191], a[56:59], a[36:39], v[188:191]
    ds_read_b128 a[4:7], v9 offset:1024
    v_mfma_f32_16x16x32_bf16 v[192:195], a[56:59], a[40:43], v[192:195]
    ds_read_b128 a[8:11], v9 offset:2048
    v_mfma_f32_16x16x32_bf16 v[196:199], a[56:59], a[44:47], v[196:199]
    ds_read_b128 a[12:15], v9 offset:3072
    s_waitcnt lgkmcnt(8)
    v_mfma_f32_16x16x32_bf16 v[200:203], a[60:63], a[24:27], v[200:203]
    ds_read_b64_tr_b16 a[52:53], v15 offset:12288
    v_mfma_f32_16x16x32_bf16 v[204:207], a[60:63], a[28:31], v[204:207]
    ds_read_b64_tr_b16 a[54:55], v15 offset:18432
    v_mfma_f32_16x16x32_bf16 v[208:211], a[60:63], a[32:35], v[208:211]
    ds_read_b128 a[16:19], v9 offset:4096
    v_mfma_f32_16x16x32_bf16 v[212:215], a[60:63], a[36:39], v[212:215]
    ds_read_b128 a[20:23], v9 offset:5120
    v_mfma_f32_16x16x32_bf16 v[216:219], a[60:63], a[40:43], v[216:219]
    buffer_load_dwordx4 v5, s[40:43], s87 offen lds
    v_mfma_f32_16x16x32_bf16 v[220:223], a[60:63], a[44:47], v[220:223]
    buffer_load_dwordx4 v6, s[40:43], s87 offen offset:1024 lds
    s_waitcnt lgkmcnt(10)
    v_mfma_f32_16x16x32_bf16 v[224:227], a[64:67], a[24:27], v[224:227]
    ds_read_b64_tr_b16 a[56:57], v18 offset:12288
    v_mfma_f32_16x16x32_bf16 v[228:231], a[64:67], a[28:31], v[228:231]
    ds_read_b64_tr_b16 a[58:59], v18 offset:18432
    v_mfma_f32_16x16x32_bf16 v[232:235], a[64:67], a[32:35], v[232:235]
    buffer_load_dwordx4 v7, s[40:43], s87 offen offset:2048 lds
    s_add_u32 s33, s32, 2048
    v_mfma_f32_16x16x32_bf16 v[236:239], a[64:67], a[36:39], v[236:239]
    s_add_u32 s86, s86, 1024
    s_add_u32 s87, s87, 40960
    v_mfma_f32_16x16x32_bf16 v[240:243], a[64:67], a[40:43], v[240:243]
    s_add_u32 s99, s99, 1
    s_add_u32 s34, s98, s99
    s_and_b32 s34, s34, 3
    v_mfma_f32_16x16x32_bf16 v[244:247], a[64:67], a[44:47], v[244:247]
    buffer_store_dwordx4 a[132:135], v1, s[20:23], s33 offen sc1
    s_waitcnt lgkmcnt(2)
    v_mfma_f32_16x16x32_bf16 v[128:131], a[48:51], a[0:3], v[128:131]
    s_add_u32 s33, s32, 198656
    ds_read_b64_tr_b16 a[60:61], v21 offset:12288
    v_mfma_f32_16x16x32_bf16 v[132:135], a[48:51], a[4:7], v[132:135]
    ds_read_b64_tr_b16 a[62:63], v21 offset:18432
    v_mfma_f32_16x16x32_bf16 v[136:139], a[48:51], a[8:11], v[136:139]
    ds_read_b128 a[24:27], v9 offset:24576
    v_mfma_f32_16x16x32_bf16 v[140:143], a[48:51], a[12:15], v[140:143]
    ds_read_b128 a[28:31], v9 offset:25600
    v_mfma_f32_16x16x32_bf16 v[144:147], a[48:51], a[16:19], v[144:147]
    ds_read_b128 a[32:35], v9 offset:26624
    v_mfma_f32_16x16x32_bf16 v[148:151], a[48:51], a[20:23], v[148:151]
    ds_read_b128 a[36:39], v9 offset:27648
    v_mfma_f32_16x16x32_bf16 v[152:155], a[52:55], a[0:3], v[152:155]
    ds_read_b64_tr_b16 a[64:65], v24 offset:12288
    v_mfma_f32_16x16x32_bf16 v[156:159], a[52:55], a[4:7], v[156:159]
    ds_read_b64_tr_b16 a[66:67], v24 offset:18432
    v_mfma_f32_16x16x32_bf16 v[160:163], a[52:55], a[8:11], v[160:163]
    ds_read_b128 a[40:43], v9 offset:28672
    v_mfma_f32_16x16x32_bf16 v[164:167], a[52:55], a[12:15], v[164:167]
    ds_read_b128 a[44:47], v9 offset:29696
    v_mfma_f32_16x16x32_bf16 v[168:171], a[52:55], a[16:19], v[168:171]
    s_lshl_b32 s34, s34, 1
    s_lshr_b32 s35, s99, 2
    s_add_u32 s34, s34, s35
    v_mfma_f32_16x16x32_bf16 v[172:175], a[52:55], a[20:23], v[172:175]
    buffer_store_dwordx4 a[136:139], v1, s[20:23], s33 offen sc1
    s_waitcnt lgkmcnt(10)
    v_mfma_f32_16x16x32_bf16 v[176:179], a[56:59], a[0:3], v[176:179]
    s_add_u32 s33, s32, 395264
    ds_read_b64_tr_b16 a[48:49], v12 offset:36864
    v_mfma_f32_16x16x32_bf16 v[180:183], a[56:59], a[4:7], v[180:183]
    ds_read_b64_tr_b16 a[50:51], v12 offset:43008
    v_mfma_f32_16x16x32_bf16 v[184:187], a[56:59], a[8:11], v[184:187]
    s_mul_i32 s34, s34, 6
    s_lshl_b32 s86, s34, 10
    s_mul_i32 s87, s34, 40960
    v_mfma_f32_16x16x32_bf16 v[188:191], a[56:59], a[12:15], v[188:191]
    s_cmp_eq_u32 s99, 8
    s_cselect_b32 s38, 0, s38
    s_cselect_b32 s42, 0, s42
    v_mfma_f32_16x16x32_bf16 v[192:195], a[56:59], a[16:19], v[192:195]
    s_add_u32 m0, s29, 0
    buffer_store_dwordx4 a[140:143], v1, s[20:23], s33 offen sc1
    v_mfma_f32_16x16x32_bf16 v[196:199], a[56:59], a[20:23], v[196:199]
    s_add_u32 s33, s32, 3072
    s_waitcnt lgkmcnt(10)
    v_mfma_f32_16x16x32_bf16 v[200:203], a[60:63], a[0:3], v[200:203]
    ds_read_b64_tr_b16 a[52:53], v15 offset:36864
    v_mfma_f32_16x16x32_bf16 v[204:207], a[60:63], a[4:7], v[204:207]
    ds_read_b64_tr_b16 a[54:55], v15 offset:43008
    v_mfma_f32_16x16x32_bf16 v[208:211], a[60:63], a[8:11], v[208:211]
    buffer_store_dwordx4 a[72:75], v1, s[20:23], s33 offen sc1
    s_add_u32 s33, s32, 199680
    v_mfma_f32_16x16x32_bf16 v[212:215], a[60:63], a[12:15], v[212:215]
    buffer_store_dwordx4 a[76:79], v1, s[20:23], s33 offen sc1
    s_add_u32 s33, s32, 396288
    v_mfma_f32_16x16x32_bf16 v[216:219], a[60:63], a[16:19], v[216:219]
    buffer_store_dwordx4 a[80:83], v1, s[20:23], s33 offen sc1
    v_mfma_f32_16x16x32_bf16 v[220:223], a[60:63], a[20:23], v[220:223]
    buffer_load_dwordx4 v2, s[36:39], s86 offen lds
    s_waitcnt lgkmcnt(6)
    v_mfma_f32_16x16x32_bf16 v[224:227], a[64:67], a[0:3], v[224:227]
    ds_read_b64_tr_b16 a[56:57], v18 offset:36864
    v_mfma_f32_16x16x32_bf16 v[228:231], a[64:67], a[4:7], v[228:231]
    ds_read_b64_tr_b16 a[58:59], v18 offset:43008
    v_mfma_f32_16x16x32_bf16 v[232:235], a[64:67], a[8:11], v[232:235]
    buffer_load_dwordx4 v3, s[36:39], s86 offen offset:1024 lds
    v_mfma_f32_16x16x32_bf16 v[236:239], a[64:67], a[12:15], v[236:239]
    buffer_load_dwordx4 v4, s[36:39], s86 offen offset:2048 lds
    s_add_u32 m0, s29, 12288
    v_mfma_f32_16x16x32_bf16 v[240:243], a[64:67], a[16:19], v[240:243]
    buffer_load_dwordx4 v5, s[40:43], s87 offen lds
    v_mfma_f32_16x16x32_bf16 v[244:247], a[64:67], a[20:23], v[244:247]
    buffer_load_dwordx4 v6, s[40:43], s87 offen offset:1024 lds
    s_waitcnt lgkmcnt(4)
    v_mfma_f32_16x16x32_bf16 v[128:131], a[48:51], a[24:27], v[128:131]
    ds_read_b64_tr_b16 a[60:61], v21 offset:36864
    v_mfma_f32_16x16x32_bf16 v[132:135], a[48:51], a[28:31], v[132:135]
    ds_read_b64_tr_b16 a[62:63], v21 offset:43008
    v_mfma_f32_16x16x32_bf16 v[136:139], a[48:51], a[32:35], v[136:139]
    buffer_load_dwordx4 v7, s[40:43], s87 offen offset:2048 lds
    v_mfma_f32_16x16x32_bf16 v[140:143], a[48:51], a[36:39], v[140:143]
    s_add_u32 s86, s86, 1024
    s_add_u32 s87, s87, 40960
    s_add_u32 m0, s29, 24576
    v_mfma_f32_16x16x32_bf16 v[144:147], a[48:51], a[40:43], v[144:147]
    buffer_load_dwordx4 v2, s[36:39], s86 offen lds
    v_mfma_f32_16x16x32_bf16 v[148:151], a[48:51], a[44:47], v[148:151]
    buffer_load_dwordx4 v3, s[36:39], s86 offen offset:1024 lds
    s_waitcnt lgkmcnt(4)
    v_mfma_f32_16x16x32_bf16 v[152:155], a[52:55], a[24:27], v[152:155]
    ds_read_b64_tr_b16 a[64:65], v24 offset:36864
    v_mfma_f32_16x16x32_bf16 v[156:159], a[52:55], a[28:31], v[156:159]
    ds_read_b64_tr_b16 a[66:67], v24 offset:43008
    v_mfma_f32_16x16x32_bf16 v[160:163], a[52:55], a[32:35], v[160:163]
    buffer_load_dwordx4 v4, s[36:39], s86 offen offset:2048 lds
    v_mfma_f32_16x16x32_bf16 v[164:167], a[52:55], a[36:39], v[164:167]
    v_mfma_f32_16x16x32_bf16 v[168:171], a[52:55], a[40:43], v[168:171]
    v_mfma_f32_16x16x32_bf16 v[172:175], a[52:55], a[44:47], v[172:175]
    s_waitcnt vmcnt(15)
    s_barrier
    s_waitcnt lgkmcnt(4)
    v_mfma_f32_16x16x32_bf16 v[176:179], a[56:59], a[24:27], v[176:179]
    s_add_u32 m0, s29, 36864
    ds_read_b64_tr_b16 a[48:49], v13 offset:12288
    v_mfma_f32_16x16x32_bf16 v[180:183], a[56:59], a[28:31], v[180:183]
    ds_read_b64_tr_b16 a[50:51], v13 offset:18432
    v_mfma_f32_16x16x32_bf16 v[184:187], a[56:59], a[32:35], v[184:187]
    ds_read_b128 a[0:3], v10 offset:0
    v_mfma_f32_16x16x32_bf16 v[188:191], a[56:59], a[36:39], v[188:191]
    ds_read_b128 a[4:7], v10 offset:1024
    v_mfma_f32_16x16x32_bf16 v[192:195], a[56:59], a[40:43], v[192:195]
    ds_read_b128 a[8:11], v10 offset:2048
    v_mfma_f32_16x16x32_bf16 v[196:199], a[56:59], a[44:47], v[196:199]
    ds_read_b128 a[12:15], v10 offset:3072
    s_waitcnt lgkmcnt(8)
    v_mfma_f32_16x16x32_bf16 v[200:203], a[60:63], a[24:27], v[200:203]
    ds_read_b64_tr_b16 a[52:53], v16 offset:12288
    v_mfma_f32_16x16x32_bf16 v[204:207], a[60:63], a[28:31], v[204:207]
    ds_read_b64_tr_b16 a[54:55], v16 offset:18432
    v_mfma_f32_16x16x32_bf16 v[208:211], a[60:63], a[32:35], v[208:211]
    ds_read_b128 a[16:19], v10 offset:4096
    v_mfma_f32_16x16x32_bf16 v[212:215], a[60:63], a[36:39], v[212:215]
    ds_read_b128 a[20:23], v10 offset:5120
    v_mfma_f32_16x16x32_bf16 v[216:219], a[60:63], a[40:43], v[216:219]
    buffer_load_dwordx4 v5, s[40:43], s87 offen lds
    v_mfma_f32_16x16x32_bf16 v[220:223], a[60:63], a[44:47], v[220:223]
    buffer_load_dwordx4 v6, s[40:43], s87 offen offset:1024 lds
    s_waitcnt lgkmcnt(10)
    v_mfma_f32_16x16x32_bf16 v[224:227], a[64:67], a[24:27], v[224:227]
    ds_read_b64_tr_b16 a[56:57], v19 offset:12288
    v_mfma_f32_16x16x32_bf16 v[228:231], a[64:67], a[28:31], v[228:231]
    ds_read_b64_tr_b16 a[58:59], v19 offset:18432
    v_mfma_f32_16x16x32_bf16 v[232:235], a[64:67], a[32:35], v[232:235]
    buffer_load_dwordx4 v7, s[40:43], s87 offen offset:2048 lds
    s_add_u32 s33, s32, 4096
    v_mfma_f32_16x16x32_bf16 v[236:239], a[64:67], a[36:39], v[236:239]
    s_add_u32 s86, s86, 1024
    s_add_u32 s87, s87, 40960
    s_add_u32 m0, s29, 49152
    v_mfma_f32_16x16x32_bf16 v[240:243], a[64:67], a[40:43], v[240:243]
    buffer_store_dwordx4 a[96:99], v1, s[20:23], s33 offen sc1
    s_add_u32 s33, s32, 200704
    v_mfma_f32_16x16x32_bf16 v[244:247], a[64:67], a[44:47], v[244:247]
    buffer_store_dwordx4 a[100:103], v1, s[20:23], s33 offen sc1
    s_waitcnt lgkmcnt(2)
    v_mfma_f32_16x16x32_bf16 v[128:131], a[48:51], a[0:3], v[128:131]
    s_add_u32 s33, s32, 397312
    ds_read_b64_tr_b16 a[60:61], v22 offset:12288
    v_mfma_f32_16x16x32_bf16 v[132:135], a[48:51], a[4:7], v[132:135]
    ds_read_b64_tr_b16 a[62:63], v22 offset:18432
    v_mfma_f32_16x16x32_bf16 v[136:139], a[48:51], a[8:11], v[136:139]
    ds_read_b128 a[24:27], v10 offset:24576
    v_mfma_f32_16x16x32_bf16 v[140:143], a[48:51], a[12:15], v[140:143]
    ds_read_b128 a[28:31], v10 offset:25600
    v_mfma_f32_16x16x32_bf16 v[144:147], a[48:51], a[16:19], v[144:147]
    ds_read_b128 a[32:35], v10 offset:26624
    v_mfma_f32_16x16x32_bf16 v[148:151], a[48:51], a[20:23], v[148:151]
    ds_read_b128 a[36:39], v10 offset:27648
    v_mfma_f32_16x16x32_bf16 v[152:155], a[52:55], a[0:3], v[152:155]
    ds_read_b64_tr_b16 a[64:65], v25 offset:12288
    v_mfma_f32_16x16x32_bf16 v[156:159], a[52:55], a[4:7], v[156:159]
    ds_read_b64_tr_b16 a[66:67], v25 offset:18432
    v_mfma_f32_16x16x32_bf16 v[160:163], a[52:55], a[8:11], v[160:163]
    ds_read_b128 a[40:43], v10 offset:28672
    v_mfma_f32_16x16x32_bf16 v[164:167], a[52:55], a[12:15], v[164:167]
    ds_read_b128 a[44:47], v10 offset:29696
    v_mfma_f32_16x16x32_bf16 v[168:171], a[52:55], a[16:19], v[168:171]
    buffer_store_dwordx4 a[104:107], v1, s[20:23], s33 offen sc1
    s_add_u32 s33, s32, 5120
    v_mfma_f32_16x16x32_bf16 v[172:175], a[52:55], a[20:23], v[172:175]
    buffer_store_dwordx4 a[120:123], v1, s[20:23], s33 offen sc1
    s_waitcnt lgkmcnt(10)
    v_mfma_f32_16x16x32_bf16 v[176:179], a[56:59], a[0:3], v[176:179]
    s_add_u32 s33, s32, 201728
    ds_read_b64_tr_b16 a[48:49], v13 offset:36864
    v_mfma_f32_16x16x32_bf16 v[180:183], a[56:59], a[4:7], v[180:183]
    ds_read_b64_tr_b16 a[50:51], v13 offset:43008
    v_mfma_f32_16x16x32_bf16 v[184:187], a[56:59], a[8:11], v[184:187]
    buffer_store_dwordx4 a[124:127], v1, s[20:23], s33 offen sc1
    s_add_u32 s33, s32, 398336
    v_mfma_f32_16x16x32_bf16 v[188:191], a[56:59], a[12:15], v[188:191]
    buffer_store_dwordx4 a[128:131], v1, s[20:23], s33 offen sc1
    v_mfma_f32_16x16x32_bf16 v[192:195], a[56:59], a[16:19], v[192:195]
    buffer_load_dwordx4 v2, s[36:39], s86 offen lds
    v_mfma_f32_16x16x32_bf16 v[196:199], a[56:59], a[20:23], v[196:199]
    buffer_load_dwordx4 v3, s[36:39], s86 offen offset:1024 lds
    s_waitcnt lgkmcnt(10)
    v_mfma_f32_16x16x32_bf16 v[200:203], a[60:63], a[0:3], v[200:203]
    ds_read_b64_tr_b16 a[52:53], v16 offset:36864
    v_mfma_f32_16x16x32_bf16 v[204:207], a[60:63], a[4:7], v[204:207]
    ds_read_b64_tr_b16 a[54:55], v16 offset:43008
    v_mfma_f32_16x16x32_bf16 v[208:211], a[60:63], a[8:11], v[208:211]
    buffer_load_dwordx4 v4, s[36:39], s86 offen offset:2048 lds
    s_add_u32 m0, s29, 61440
    v_mfma_f32_16x16x32_bf16 v[212:215], a[60:63], a[12:15], v[212:215]
    buffer_load_dwordx4 v5, s[40:43], s87 offen lds
    v_mfma_f32_16x16x32_bf16 v[216:219], a[60:63], a[16:19], v[216:219]
    buffer_load_dwordx4 v6, s[40:43], s87 offen offset:1024 lds
    v_mfma_f32_16x16x32_bf16 v[220:223], a[60:63], a[20:23], v[220:223]
    buffer_load_dwordx4 v7, s[40:43], s87 offen offset:2048 lds
    s_waitcnt lgkmcnt(6)
    v_mfma_f32_16x16x32_bf16 v[224:227], a[64:67], a[0:3], v[224:227]
    ds_read_b64_tr_b16 a[56:57], v19 offset:36864
    v_mfma_f32_16x16x32_bf16 v[228:231], a[64:67], a[4:7], v[228:231]
    ds_read_b64_tr_b16 a[58:59], v19 offset:43008
    v_mfma_f32_16x16x32_bf16 v[232:235], a[64:67], a[8:11], v[232:235]
    s_add_u32 s86, s86, 1024
    s_add_u32 s87, s87, 40960
    s_add_u32 m0, s29, 73728
    v_mfma_f32_16x16x32_bf16 v[236:239], a[64:67], a[12:15], v[236:239]
    v_mfma_f32_16x16x32_bf16 v[240:243], a[64:67], a[16:19], v[240:243]
    v_mfma_f32_16x16x32_bf16 v[244:247], a[64:67], a[20:23], v[244:247]
    buffer_load_dwordx4 v2, s[36:39], s86 offen lds
    s_waitcnt lgkmcnt(4)
    v_mfma_f32_16x16x32_bf16 v[128:131], a[48:51], a[24:27], v[128:131]
    ds_read_b64_tr_b16 a[60:61], v22 offset:36864
    v_mfma_f32_16x16x32_bf16 v[132:135], a[48:51], a[28:31], v[132:135]
    ds_read_b64_tr_b16 a[62:63], v22 offset:43008
    v_mfma_f32_16x16x32_bf16 v[136:139], a[48:51], a[32:35], v[136:139]
    buffer_load_dwordx4 v3, s[36:39], s86 offen offset:1024 lds
    v_mfma_f32_16x16x32_bf16 v[140:143], a[48:51], a[36:39], v[140:143]
    v_mfma_f32_16x16x32_bf16 v[144:147], a[48:51], a[40:43], v[144:147]
    v_mfma_f32_16x16x32_bf16 v[148:151], a[48:51], a[44:47], v[148:151]
    buffer_load_dwordx4 v4, s[36:39], s86 offen offset:2048 lds
    s_waitcnt lgkmcnt(4)
    v_mfma_f32_16x16x32_bf16 v[152:155], a[52:55], a[24:27], v[152:155]
    ds_read_b64_tr_b16 a[64:65], v25 offset:36864
    v_mfma_f32_16x16x32_bf16 v[156:159], a[52:55], a[28:31], v[156:159]
    ds_read_b64_tr_b16 a[66:67], v25 offset:43008
    v_mfma_f32_16x16x32_bf16 v[160:163], a[52:55], a[32:35], v[160:163]
    v_mfma_f32_16x16x32_bf16 v[164:167], a[52:55], a[36:39], v[164:167]
    v_mfma_f32_16x16x32_bf16 v[168:171], a[52:55], a[40:43], v[168:171]
    v_mfma_f32_16x16x32_bf16 v[172:175], a[52:55], a[44:47], v[172:175]
    s_waitcnt vmcnt(15)
    s_barrier
    s_waitcnt lgkmcnt(4)
    v_mfma_f32_16x16x32_bf16 v[176:179], a[56:59], a[24:27], v[176:179]
    ds_read_b64_tr_b16 a[48:49], v11 offset:12288
    v_mfma_f32_16x16x32_bf16 v[180:183], a[56:59], a[28:31], v[180:183]
    ds_read_b64_tr_b16 a[50:51], v11 offset:18432
    v_mfma_f32_16x16x32_bf16 v[184:187], a[56:59], a[32:35], v[184:187]
    ds_read_b128 a[0:3], v8 offset:0
    v_mfma_f32_16x16x32_bf16 v[188:191], a[56:59], a[36:39], v[188:191]
    ds_read_b128 a[4:7], v8 offset:1024
    v_mfma_f32_16x16x32_bf16 v[192:195], a[56:59], a[40:43], v[192:195]
    ds_read_b128 a[8:11], v8 offset:2048
    v_mfma_f32_16x16x32_bf16 v[196:199], a[56:59], a[44:47], v[196:199]
    ds_read_b128 a[12:15], v8 offset:3072
    s_waitcnt lgkmcnt(8)
    v_mfma_f32_16x16x32_bf16 v[200:203], a[60:63], a[24:27], v[200:203]
    ds_read_b64_tr_b16 a[52:53], v14 offset:12288
    v_mfma_f32_16x16x32_bf16 v[204:207], a[60:63], a[28:31], v[204:207]
    ds_read_b64_tr_b16 a[54:55], v14 offset:18432
    v_mfma_f32_16x16x32_bf16 v[208:211], a[60:63], a[32:35], v[208:211]
    ds_read_b128 a[16:19], v8 offset:4096
    v_mfma_f32_16x16x32_bf16 v[212:215], a[60:63], a[36:39], v[212:215]
    ds_read_b128 a[20:23], v8 offset:5120
    v_mfma_f32_16x16x32_bf16 v[216:219], a[60:63], a[40:43], v[216:219]
    v_mfma_f32_16x16x32_bf16 v[220:223], a[60:63], a[44:47], v[220:223]
    s_waitcnt lgkmcnt(10)
    v_mfma_f32_16x16x32_bf16 v[224:227], a[64:67], a[24:27], v[224:227]
    ds_read_b64_tr_b16 a[56:57], v17 offset:12288
    v_mfma_f32_16x16x32_bf16 v[228:231], a[64:67], a[28:31], v[228:231]
    ds_read_b64_tr_b16 a[58:59], v17 offset:18432
    v_mfma_f32_16x16x32_bf16 v[232:235], a[64:67], a[32:35], v[232:235]
    v_mfma_f32_16x16x32_bf16 v[236:239], a[64:67], a[36:39], v[236:239]
    v_mfma_f32_16x16x32_bf16 v[240:243], a[64:67], a[40:43], v[240:243]
    v_mfma_f32_16x16x32_bf16 v[244:247], a[64:67], a[44:47], v[244:247]
    s_sub_u32 s88, s88, 1
L_lb:
    s_add_u32 m0, s29, 86016
    s_waitcnt lgkmcnt(2)
    v_mfma_f32_16x16x32_bf16 v[128:131], a[48:51], a[0:3], v[128:131]
    ds_read_b64_tr_b16 a[60:61], v20 offset:12288
    v_mfma_f32_16x16x32_bf16 v[132:135], a[48:51], a[4:7], v[132:135]
    ds_read_b64_tr_b16 a[62:63], v20 offset:18432
    v_mfma_f32_16x16x32_bf16 v[136:139], a[48:51], a[8:11], v[136:139]
    ds_read_b128 a[24:27], v8 offset:24576
    v_mfma_f32_16x16x32_bf16 v[140:143], a[48:51], a[12:15], v[140:143]
    ds_read_b128 a[28:31], v8 offset:25600
    v_mfma_f32_16x16x32_bf16 v[144:147], a[48:51], a[16:19], v[144:147]
    ds_read_b128 a[32:35], v8 offset:26624
    v_mfma_f32_16x16x32_bf16 v[148:151], a[48:51], a[20:23], v[148:151]
    ds_read_b128 a[36:39], v8 offset:27648
    v_mfma_f32_16x16x32_bf16 v[152:155], a[52:55], a[0:3], v[152:155]
    ds_read_b64_tr_b16 a[64:65], v23 offset:12288
    v_mfma_f32_16x16x32_bf16 v[156:159], a[52:55], a[4:7], v[156:159]
    ds_read_b64_tr_b16 a[66:67], v23 offset:18432
    v_mfma_f32_16x16x32_bf16 v[160:163], a[52:55], a[8:11], v[160:163]
    ds_read_b128 a[40:43], v8 offset:28672
    v_mfma_f32_16x16x32_bf16 v[164:167], a[52:55], a[12:15], v[164:167]
    ds_read_b128 a[44:47], v8 offset:29696
    v_mfma_f32_16x16x32_bf16 v[168:171], a[52:55], a[16:19], v[168:171]
    buffer_load_dwordx4 v5, s[40:43], s87 offen lds
    v_mfma_f32_16x16x32_bf16 v[172:175], a[52:55], a[20:23], v[172:175]
    buffer_load_dwordx4 v6, s[40:43], s87 offen offset:1024 lds
    s_waitcnt lgkmcnt(10)
    v_mfma_f32_16x16x32_bf16 v[176:179], a[56:59], a[0:3], v[176:179]
    ds_read_b64_tr_b16 a[48:49], v11 offset:36864
    v_mfma_f32_16x16x32_bf16 v[180:183], a[56:59], a[4:7], v[180:183]
    ds_read_b64_tr_b16 a[50:51], v11 offset:43008
    v_mfma_f32_16x16x32_bf16 v[184:187], a[56:59], a[8:11], v[184:187]
    buffer_load_dwordx4 v7, s[40:43], s87 offen offset:2048 lds
    v_mfma_f32_16x16x32_bf16 v[188:191], a[56:59], a[12:15], v[188:191]
    s_add_u32 s86, s86, 1024
    s_add_u32 s87, s87, 40960
    s_add_u32 m0, s29, 98304
    v_mfma_f32_16x16x32_bf16 v[192:195], a[56:59], a[16:19], v[192:195]
    buffer_load_dwordx4 v2, s[36:39], s86 offen lds
    v_mfma_f32_16x16x32_bf16 v[196:199], a[56:59], a[20:23], v[196:199]
    buffer_load_dwordx4 v3, s[36:39], s86 offen offset:1024 lds
    s_waitcnt lgkmcnt(10)
    v_mfma_f32_16x16x32_bf16 v[200:203], a[60:63], a[0:3], v[200:203]
    ds_read_b64_tr_b16 a[52:53], v14 offset:36864
    v_mfma_f32_16x16x32_bf16 v[204:207], a[60:63], a[4:7], v[204:207]
    ds_read_b64_tr_b16 a[54:55], v14 offset:43008
    v_mfma_f32_16x16x32_bf16 v[208:211], a[60:63], a[8:11], v[208:211]
    buffer_load_dwordx4 v4, s[36:39], s86 offen offset:2048 lds
    s_add_u32 m0, s29, 110592
    v_mfma_f32_16x16x32_bf16 v[212:215], a[60:63], a[12:15], v[212:215]
    buffer_load_dwordx4 v5, s[40:43], s87 offen lds
    v_mfma_f32_16x16x32_bf16 v[216:219], a[60:63], a[16:19], v[216:219]
    v_mfma_f32_16x16x32_bf16 v[220:223], a[60:63], a[20:23], v[220:223]
    buffer_load_dwordx4 v6, s[40:43], s87 offen offset:1024 lds
    s_waitcnt lgkmcnt(6)
    v_mfma_f32_16x16x32_bf16 v[224:227], a[64:67], a[0:3], v[224:227]
    ds_read_b64_tr_b16 a[56:57], v17 offset:36864
    v_mfma_f32_16x16x32_bf16 v[228:231], a[64:67], a[4:7], v[228:231]
    ds_read_b64_tr_b16 a[58:59], v17 offset:43008
    v_mfma_f32_16x16x32_bf16 v[232:235], a[64:67], a[8:11], v[232:235]
    buffer_load_dwordx4 v7, s[40:43], s87 offen offset:2048 lds
    v_mfma_f32_16x16x32_bf16 v[236:239], a[64:67], a[12:15], v[236:239]
    s_add_u32 s86, s86, 1024
    s_add_u32 s87, s87, 40960
    v_mfma_f32_16x16x32_bf16 v[240:243], a[64:67], a[16:19], v[240:243]
    v_mfma_f32_16x16x32_bf16 v[244:247], a[64:67], a[20:23], v[244:247]
    s_waitcnt lgkmcnt(4)
    v_mfma_f32_16x16x32_bf16 v[128:131], a[48:51], a[24:27], v[128:131]
    s_add_u32 m0, s29, 122880
    ds_read_b64_tr_b16 a[60:61], v20 offset:36864
    v_mfma_f32_16x16x32_bf16 v[132:135], a[48:51], a[28:31], v[132:135]
    ds_read_b64_tr_b16 a[62:63], v20 offset:43008
    v_mfma_f32_16x16x32_bf16 v[136:139], a[48:51], a[32:35], v[136:139]
    buffer_load_dwordx4 v2, s[36:39], s86 offen lds
    v_mfma_f32_16x16x32_bf16 v[140:143], a[48:51], a[36:39], v[140:143]
    v_mfma_f32_16x16x32_bf16 v[144:147], a[48:51], a[40:43], v[144:147]
    buffer_load_dwordx4 v3, s[36:39], s86 offen offset:1024 lds
    v_mfma_f32_16x16x32_bf16 v[148:151], a[48:51], a[44:47], v[148:151]
    s_waitcnt lgkmcnt(4)
    v_mfma_f32_16x16x32_bf16 v[152:155], a[52:55], a[24:27], v[152:155]
    ds_read_b64_tr_b16 a[64:65], v23 offset:36864
    v_mfma_f32_16x16x32_bf16 v[156:159], a[52:55], a[28:31], v[156:159]
    ds_read_b64_tr_b16 a[66:67], v23 offset:43008
    v_mfma_f32_16x16x32_bf16 v[160:163], a[52:55], a[32:35], v[160:163]
    buffer_load_dwordx4 v4, s[36:39], s86 offen offset:2048 lds
    v_mfma_f32_16x16x32_bf16 v[164:167], a[52:55], a[36:39], v[164:167]
    v_mfma_f32_16x16x32_bf16 v[168:171], a[52:55], a[40:43], v[168:171]
    v_mfma_f32_16x16x32_bf16 v[172:175], a[52:55], a[44:47], v[172:175]
    s_cmp_eq_u32 s88, 5
    s_cbranch_scc1 L_ool2
L_ool2_r:
    s_waitcnt vmcnt(9)
    s_barrier
    s_waitcnt lgkmcnt(4)
    v_mfma_f32_16x16x32_bf16 v[176:179], a[56:59], a[24:27], v[176:179]
    s_add_u32 m0, s29, 135168
    ds_read_b64_tr_b16 a[48:49], v12 offset:12288
    v_mfma_f32_16x16x32_bf16 v[180:183], a[56:59], a[28:31], v[180:183]
    ds_read_b64_tr_b16 a[50:51], v12 offset:18432
    v_mfma_f32_16x16x32_bf16 v[184:187], a[56:59], a[32:35], v[184:187]
    ds_read_b128 a[0:3], v9 offset:0
    v_mfma_f32_16x16x32_bf16 v[188:191], a[56:59], a[36:39], v[188:191]
    ds_read_b128 a[4:7], v9 offset:1024
    v_mfma_f32_16x16x32_bf16 v[192:195], a[56:59], a[40:43], v[192:195]
    ds_read_b128 a[8:11], v9 offset:2048
    v_mfma_f32_16x16x32_bf16 v[196:199], a[56:59], a[44:47], v[196:199]
    ds_read_b128 a[12:15], v9 offset:3072
    s_waitcnt lgkmcnt(8)
    v_mfma_f32_16x16x32_bf16 v[200:203], a[60:63], a[24:27], v[200:203]
    ds_read_b64_tr_b16 a[52:53], v15 offset:12288
    v_mfma_f32_16x16x32_bf16 v[204:207], a[60:63], a[28:31], v[204:207]
    ds_read_b64_tr_b16 a[54:55], v15 offset:18432
    v_mfma_f32_16x16x32_bf16 v[208:211], a[60:63], a[32:35], v[208:211]
    ds_read_b128 a[16:19], v9 offset:4096
    v_mfma_f32_16x16x32_bf16 v[212:215], a[60:63], a[36:39], v[212:215]
    ds_read_b128 a[20:23], v9 offset:5120
    v_mfma_f32_16x16x32_bf16 v[216:219], a[60:63], a[40:43], v[216:219]
    buffer_load_dwordx4 v5, s[40:43], s87 offen lds
    v_mfma_f32_16x16x32_bf16 v[220:223], a[60:63], a[44:47], v[220:223]
    buffer_load_dwordx4 v6, s[40:43], s87 offen offset:1024 lds
    s_waitcnt lgkmcnt(10)
    v_mfma_f32_16x16x32_bf16 v[224:227], a[64:67], a[24:27], v[224:227]
    ds_read_b64_tr_b16 a[56:57], v18 offset:12288
    v_mfma_f32_16x16x32_bf16 v[228:231], a[64:67], a[28:31], v[228:231]
    ds_read_b64_tr_b16 a[58:59], v18 offset:18432
    v_mfma_f32_16x16x32_bf16 v[232:235], a[64:67], a[32:35], v[232:235]
    buffer_load_dwordx4 v7, s[40:43], s87 offen offset:2048 lds
    v_mfma_f32_16x16x32_bf16 v[236:239], a[64:67], a[36:39], v[236:239]
    s_add_u32 s86, s86, 1024
    s_add_u32 s87, s87, 40960
    v_mfma_f32_16x16x32_bf16 v[240:243], a[64:67], a[40:43], v[240:243]
    s_add_u32 s99, s99, 1
    s_add_u32 s34, s98, s99
    s_and_b32 s34, s34, 3
    v_mfma_f32_16x16x32_bf16 v[244:247], a[64:67], a[44:47], v[244:247]
    s_waitcnt lgkmcnt(2)
    v_mfma_f32_16x16x32_bf16 v[128:131], a[48:51], a[0:3], v[128:131]
    ds_read_b64_tr_b16 a[60:61], v21 offset:12288
    v_mfma_f32_16x16x32_bf16 v[132:135], a[48:51], a[4:7], v[132:135]
    ds_read_b64_tr_b16 a[62:63], v21 offset:18432
    v_mfma_f32_16x16x32_bf16 v[136:139], a[48:51], a[8:11], v[136:139]
    ds_read_b128 a[24:27], v9 offset:24576
    v_mfma_f32_16x16x32_bf16 v[140:143], a[48:51], a[12:15], v[140:143]
    ds_read_b128 a[28:31], v9 offset:25600
    v_mfma_f32_16x16x32_bf16 v[144:147], a[48:51], a[16:19], v[144:147]
    ds_read_b128 a[32:35], v9 offset:26624
    v_mfma_f32_16x16x32_bf16 v[148:151], a[48:51], a[20:23], v[148:151]
    ds_read_b128 a[36:39], v9 offset:27648
    v_mfma_f32_16x16x32_bf16 v[152:155], a[52:55], a[0:3], v[152:155]
    ds_read_b64_tr_b16 a[64:65], v24 offset:12288
    v_mfma_f32_16x16x32_bf16 v[156:159], a[52:55], a[4:7], v[156:159]
    ds_read_b64_tr_b16 a[66:67], v24 offset:18432
    v_mfma_f32_16x16x32_bf16 v[160:163], a[52:55], a[8:11], v[160:163]
    ds_read_b128 a[40:43], v9 offset:28672
    v_mfma_f32_16x16x32_bf16 v[164:167], a[52:55], a[12:15], v[164:167]
    ds_read_b128 a[44:47], v9 offset:29696
    v_mfma_f32_16x16x32_bf16 v[168:171], a[52:55], a[16:19], v[168:171]
    s_lshl_b32 s34, s34, 1
    s_lshr_b32 s35, s99, 2
    s_add_u32 s34, s34, s35
    v_mfma_f32_16x16x32_bf16 v[172:175], a[52:55], a[20:23], v[172:175]
    s_waitcnt lgkmcnt(10)
    v_mfma_f32_16x16x32_bf16 v[176:179], a[56:59], a[0:3], v[176:179]
    ds_read_b64_tr_b16 a[48:49], v12 offset:36864
    v_mfma_f32_16x16x32_bf16 v[180:183], a[56:59], a[4:7], v[180:183]
    ds_read_b64_tr_b16 a[50:51], v12 offset:43008
    v_mfma_f32_16x16x32_bf16 v[184:187], a[56:59], a[8:11], v[184:187]
    s_mul_i32 s34, s34, 6
    s_lshl_b32 s86, s34, 10
    s_mul_i32 s87, s34, 40960
    v_mfma_f32_16x16x32_bf16 v[188:191], a[56:59], a[12:15], v[188:191]
    s_cmp_eq_u32 s99, 8
    s_cselect_b32 s38, 0, s38
    s_cselect_b32 s42, 0, s42
    v_mfma_f32_16x16x32_bf16 v[192:195], a[56:59], a[16:19], v[192:195]
    s_add_u32 m0, s29, 0
    v_mfma_f32_16x16x32_bf16 v[196:199], a[56:59], a[20:23], v[196:199]
    buffer_load_dwordx4 v2, s[36:39], s86 offen lds
    s_waitcnt lgkmcnt(10)
    v_mfma_f32_16x16x32_bf16 v[200:203], a[60:63], a[0:3], v[200:203]
    ds_read_b64_tr_b16 a[52:53], v15 offset:36864
    v_mfma_f32_16x16x32_bf16 v[204:207], a[60:63], a[4:7], v[204:207]
    ds_read_b64_tr_b16 a[54:55], v15 offset:43008
    v_mfma_f32_16x16x32_bf16 v[208:211], a[60:63], a[8:11], v[208:211]
    buffer_load_dwordx4 v3, s[36:39], s86 offen offset:1024 lds
    v_mfma_f32_16x16x32_bf16 v[212:215], a[60:63], a[12:15], v[212:215]
    buffer_load_dwordx4 v4, s[36:39], s86 offen offset:2048 lds
    s_add_u32 m0, s29, 12288
    v_mfma_f32_16x16x32_bf16 v[216:219], a[60:63], a[16:19], v[216:219]
    buffer_load_dwordx4 v5, s[40:43], s87 offen lds
    v_mfma_f32_16x16x32_bf16 v[220:223], a[60:63], a[20:23], v[220:223]
    buffer_load_dwordx4 v6, s[40:43], s87 offen offset:1024 lds
    s_waitcnt lgkmcnt(6)
    v_mfma_f32_16x16x32_bf16 v[224:227], a[64:67], a[0:3], v[224:227]
    ds_read_b64_tr_b16 a[56:57], v18 offset:36864
    v_mfma_f32_16x16x32_bf16 v[228:231], a[64:67], a[4:7], v[228:231]
    ds_read_b64_tr_b16 a[58:59], v18 offset:43008
    v_mfma_f32_16x16x32_bf16 v[232:235], a[64:67], a[8:11], v[232:235]
    buffer_load_dwordx4 v7, s[40:43], s87 offen offset:2048 lds
    v_mfma_f32_16x16x32_bf16 v[236:239], a[64:67], a[12:15], v[236:239]
    s_add_u32 s86, s86, 1024
    s_add_u32 s87, s87, 40960
    v_mfma_f32_16x16x32_bf16 v[240:243], a[64:67], a[16:19], v[240:243]
    s_add_u32 m0, s29, 24576
    v_mfma_f32_16x16x32_bf16 v[244:247], a[64:67], a[20:23], v[244:247]
    s_waitcnt lgkmcnt(4)
    v_mfma_f32_16x16x32_bf16 v[128:131], a[48:51], a[24:27], v[128:131]
    ds_read_b64_tr_b16 a[60:61], v21 offset:36864
    v_mfma_f32_16x16x32_bf16 v[132:135], a[48:51], a[28:31], v[132:135]
    ds_read_b64_tr_b16 a[62:63], v21 offset:43008
    v_mfma_f32_16x16x32_bf16 v[136:139], a[48:51], a[32:35], v[136:139]
    buffer_load_dwordx4 v2, s[36:39], s86 offen lds
    v_mfma_f32_16x16x32_bf16 v[140:143], a[48:51], a[36:39], v[140:143]
    buffer_load_dwordx4 v3, s[36:39], s86 offen offset:1024 lds
    v_mfma_f32_16x16x32_bf16 v[144:147], a[48:51], a[40:43], v[144:147]
    v_mfma_f32_16x16x32_bf16 v[148:151], a[48:51], a[44:47], v[148:151]
    s_waitcnt lgkmcnt(4)
    v_mfma_f32_16x16x32_bf16 v[152:155], a[52:55], a[24:27], v[152:155]
    ds_read_b64_tr_b16 a[64:65], v24 offset:36864
    v_mfma_f32_16x16x32_bf16 v[156:159], a[52:55], a[28:31], v[156:159]
    ds_read_b64_tr_b16 a[66:67], v24 offset:43008
    v_mfma_f32_16x16x32_bf16 v[160:163], a[52:55], a[32:35], v[160:163]
    buffer_load_dwordx4 v4, s[36:39], s86 offen offset:2048 lds
    v_mfma_f32_16x16x32_bf16 v[164:167], a[52:55], a[36:39], v[164:167]
    v_mfma_f32_16x16x32_bf16 v[168:171], a[52:55], a[40:43], v[168:171]
    v_mfma_f32_16x16x32_bf16 v[172:175], a[52:55], a[44:47], v[172:175]
    s_waitcnt vmcnt(9)
    s_barrier
    s_cmp_eq_u32 s88, 7
    s_cbranch_scc1 L_ool4
L_ool4_r:
    s_waitcnt lgkmcnt(4)
    v_mfma_f32_16x16x32_bf16 v[176:179], a[56:59], a[24:27], v[176:179]
    s_add_u32 m0, s29, 36864
    ds_read_b64_tr_b16 a[48:49], v13 offset:12288
    v_mfma_f32_16x16x32_bf16 v[180:183], a[56:59], a[28:31], v[180:183]
    ds_read_b64_tr_b16 a[50:51], v13 offset:18432
    v_mfma_f32_16x16x32_bf16 v[184:187], a[56:59], a[32:35], v[184:187]
    ds_read_b128 a[0:3], v10 offset:0
    v_mfma_f32_16x16x32_bf16 v[188:191], a[56:59], a[36:39], v[188:191]
    ds_read_b128 a[4:7], v10 offset:1024
    v_mfma_f32_16x16x32_bf16 v[192:195], a[56:59], a[40:43], v[192:195]
    ds_read_b128 a[8:11], v10 offset:2048
    v_mfma_f32_16x16x32_bf16 v[196:199], a[56:59], a[44:47], v[196:199]
    ds_read_b128 a[12:15], v10 offset:3072
    s_waitcnt lgkmcnt(8)
    v_mfma_f32_16x16x32_bf16 v[200:203], a[60:63], a[24:27], v[200:203]
    ds_read_b64_tr_b16 a[52:53], v16 offset:12288
    v_mfma_f32_16x16x32_bf16 v[204:207], a[60:63], a[28:31], v[204:207]
    ds_read_b64_tr_b16 a[54:55], v16 offset:18432
    v_mfma_f32_16x16x32_bf16 v[208:211], a[60:63], a[32:35], v[208:211]
    ds_read_b128 a[16:19], v10 offset:4096
    v_mfma_f32_16x16x32_bf16 v[212:215], a[60:63], a[36:39], v[212:215]
    ds_read_b128 a[20:23], v10 offset:5120
    v_mfma_f32_16x16x32_bf16 v[216:219], a[60:63], a[40:43], v[216:219]
    buffer_load_dwordx4 v5, s[40:43], s87 offen lds
    v_mfma_f32_16x16x32_bf16 v[220:223], a[60:63], a[44:47], v[220:223]
    buffer_load_dwordx4 v6, s[40:43], s87 offen offset:1024 lds
    s_waitcnt lgkmcnt(10)
    v_mfma_f32_16x16x32_bf16 v[224:227], a[64:67], a[24:27], v[224:227]
    ds_read_b64_tr_b16 a[56:57], v19 offset:12288
    v_mfma_f32_16x16x32_bf16 v[228:231], a[64:67], a[28:31], v[228:231]
    ds_read_b64_tr_b16 a[58:59], v19 offset:18432
    v_mfma_f32_16x16x32_bf16 v[232:235], a[64:67], a[32:35], v[232:235]
    buffer_load_dwordx4 v7, s[40:43], s87 offen offset:2048 lds
    v_mfma_f32_16x16x32_bf16 v[236:239], a[64:67], a[36:39], v[236:239]
    s_add_u32 s86, s86, 1024
    s_add_u32 s87, s87, 40960
    s_add_u32 m0, s29, 49152
    v_mfma_f32_16x16x32_bf16 v[240:243], a[64:67], a[40:43], v[240:243]
    v_mfma_f32_16x16x32_bf16 v[244:247], a[64:67], a[44:47], v[244:247]
    s_waitcnt lgkmcnt(2)
    v_mfma_f32_16x16x32_bf16 v[128:131], a[48:51], a[0:3], v[128:131]
    ds_read_b64_tr_b16 a[60:61], v22 offset:12288
    v_mfma_f32_16x16x32_bf16 v[132:135], a[48:51], a[4:7], v[132:135]
    ds_read_b64_tr_b16 a[62:63], v22 offset:18432
    v_mfma_f32_16x16x32_bf16 v[136:139], a[48:51], a[8:11], v[136:139]
    ds_read_b128 a[24:27], v10 offset:24576
    v_mfma_f32_16x16x32_bf16 v[140:143], a[48:51], a[12:15], v[140:143]
    ds_read_b128 a[28:31], v10 offset:25600
    v_mfma_f32_16x16x32_bf16 v[144:147], a[48:51], a[16:19], v[144:147]
    ds_read_b128 a[32:35], v10 offset:26624
    v_mfma_f32_16x16x32_bf16 v[148:151], a[48:51], a[20:23], v[148:151]
    ds_read_b128 a[36:39], v10 offset:27648
    v_mfma_f32_16x16x32_bf16 v[152:155], a[52:55], a[0:3], v[152:155]
    ds_read_b64_tr_b16 a[64:65], v25 offset:12288
    v_mfma_f32_16x16x32_bf16 v[156:159], a[52:55], a[4:7], v[156:159]
    ds_read_b64_tr_b16 a[66:67], v25 offset:18432
    v_mfma_f32_16x16x32_bf16 v[160:163], a[52:55], a[8:11], v[160:163]
    ds_read_b128 a[40:43], v10 offset:28672
    v_mfma_f32_16x16x32_bf16 v[164:167], a[52:55], a[12:15], v[164:167]
    ds_read_b128 a[44:47], v10 offset:29696
    v_mfma_f32_16x16x32_bf16 v[168:171], a[52:55], a[16:19], v[168:171]
    buffer_load_dwordx4 v2, s[36:39], s86 offen lds
    v_mfma_f32_16x16x32_bf16 v[172:175], a[52:55], a[20:23], v[172:175]
    buffer_load_dwordx4 v3, s[36:39], s86 offen offset:1024 lds
    s_waitcnt lgkmcnt(10)
    v_mfma_f32_16x16x32_bf16 v[176:179], a[56:59], a[0:3], v[176:179]
    ds_read_b64_tr_b16 a[48:49], v13 offset:36864
    v_mfma_f32_16x16x32_bf16 v[180:183], a[56:59], a[4:7], v[180:183]
    ds_read_b64_tr_b16 a[50:51], v13 offset:43008
    v_mfma_f32_16x16x32_bf16 v[184:187], a[56:59], a[8:11], v[184:187]
    buffer_load_dwordx4 v4, s[36:39], s86 offen offset:2048 lds
    s_add_u32 m0, s29, 61440
    v_mfma_f32_16x16x32_bf16 v[188:191], a[56:59], a[12:15], v[188:191]
    buffer_load_dwordx4 v5, s[40:43], s87 offen lds
    v_mfma_f32_16x16x32_bf16 v[192:195], a[56:59], a[16:19], v[192:195]
    buffer_load_dwordx4 v6, s[40:43], s87 offen offset:1024 lds
    v_mfma_f32_16x16x32_bf16 v[196:199], a[56:59], a[20:23], v[196:199]
    s_waitcnt lgkmcnt(10)
    v_mfma_f32_16x16x32_bf16 v[200:203], a[60:63], a[0:3], v[200:203]
    ds_read_b64_tr_b16 a[52:53], v16 offset:36864
    v_mfma_f32_16x16x32_bf16 v[204:207], a[60:63], a[4:7], v[204:207]
    ds_read_b64_tr_b16 a[54:55], v16 offset:43008
    v_mfma_f32_16x16x32_bf16 v[208:211], a[60:63], a[8:11], v[208:211]
    buffer_load_dwordx4 v7, s[40:43], s87 offen offset:2048 lds
    v_mfma_f32_16x16x32_bf16 v[212:215], a[60:63], a[12:15], v[212:215]
    v_mfma_f32_16x16x32_bf16 v[216:219], a[60:63], a[16:19], v[216:219]
    s_add_u32 s86, s86, 1024
    s_add_u32 s87, s87, 40960
    v_mfma_f32_16x16x32_bf16 v[220:223], a[60:63], a[20:23], v[220:223]
    s_waitcnt lgkmcnt(6)
    v_mfma_f32_16x16x32_bf16 v[224:227], a[64:67], a[0:3], v[224:227]
    ds_read_b64_tr_b16 a[56:57], v19 offset:36864
    v_mfma_f32_16x16x32_bf16 v[228:231], a[64:67], a[4:7], v[228:231]
    ds_read_b64_tr_b16 a[58:59], v19 offset:43008
    v_mfma_f32_16x16x32_bf16 v[232:235], a[64:67], a[8:11], v[232:235]
    s_add_u32 m0, s29, 73728
    v_mfma_f32_16x16x32_bf16 v[236:239], a[64:67], a[12:15], v[236:239]
    v_mfma_f32_16x16x32_bf16 v[240:243], a[64:67], a[16:19], v[240:243]
    v_mfma_f32_16x16x32_bf16 v[244:247], a[64:67], a[20:23], v[244:247]
    buffer_load_dwordx4 v2, s[36:39], s86 offen lds
    s_waitcnt lgkmcnt(4)
    v_mfma_f32_16x16x32_bf16 v[128:131], a[48:51], a[24:27], v[128:131]
    ds_read_b64_tr_b16 a[60:61], v22 offset:36864
    v_mfma_f32_16x16x32_bf16 v[132:135], a[48:51], a[28:31], v[132:135]
    ds_read_b64_tr_b16 a[62:63], v22 offset:43008
    v_mfma_f32_16x16x32_bf16 v[136:139], a[48:51], a[32:35], v[136:139]
    buffer_load_dwordx4 v3, s[36:39], s86 offen offset:1024 lds
    v_mfma_f32_16x16x32_bf16 v[140:143], a[48:51], a[36:39], v[140:143]
    v_mfma_f32_16x16x32_bf16 v[144:147], a[48:51], a[40:43], v[144:147]
    v_mfma_f32_16x16x32_bf16 v[148:151], a[48:51], a[44:47], v[148:151]
    buffer_load_dwordx4 v4, s[36:39], s86 offen offset:2048 lds
    s_waitcnt lgkmcnt(4)
    v_mfma_f32_16x16x32_bf16 v[152:155], a[52:55], a[24:27], v[152:155]
    ds_read_b64_tr_b16 a[64:65], v25 offset:36864
    v_mfma_f32_16x16x32_bf16 v[156:159], a[52:55], a[28:31], v[156:159]
    ds_read_b64_tr_b16 a[66:67], v25 offset:43008
    v_mfma_f32_16x16x32_bf16 v[160:163], a[52:55], a[32:35], v[160:163]
    v_mfma_f32_16x16x32_bf16 v[164:167], a[52:55], a[36:39], v[164:167]
    v_mfma_f32_16x16x32_bf16 v[168:171], a[52:55], a[40:43], v[168:171]
    v_mfma_f32_16x16x32_bf16 v[172:175], a[52:55], a[44:47], v[172:175]
    s_waitcnt vmcnt(9)
    s_barrier
    s_waitcnt lgkmcnt(4)
    v_mfma_f32_16x16x32_bf16 v[176:179], a[56:59], a[24:27], v[176:179]
    ds_read_b64_tr_b16 a[48:49], v11 offset:12288
    v_mfma_f32_16x16x32_bf16 v[180:183], a[56:59], a[28:31], v[180:183]
    ds_read_b64_tr_b16 a[50:51], v11 offset:18432
    v_mfma_f32_16x16x32_bf16 v[184:187], a[56:59], a[32:35], v[184:187]
    ds_read_b128 a[0:3], v8 offset:0
    v_mfma_f32_16x16x32_bf16 v[188:191], a[56:59], a[36:39], v[188:191]
    ds_read_b128 a[4:7], v8 offset:1024
    v_mfma_f32_16x16x32_bf16 v[192:195], a[56:59], a[40:43], v[192:195]
    ds_read_b128 a[8:11], v8 offset:2048
    v_mfma_f32_16x16x32_bf16 v[196:199], a[56:59], a[44:47], v[196:199]
    ds_read_b128 a[12:15], v8 offset:3072
    s_waitcnt lgkmcnt(8)
    v_mfma_f32_16x16x32_bf16 v[200:203], a[60:63], a[24:27], v[200:203]
    ds_read_b64_tr_b16 a[52:53], v14 offset:12288
    v_mfma_f32_16x16x32_bf16 v[204:207], a[60:63], a[28:31], v[204:207]
    ds_read_b64_tr_b16 a[54:55], v14 offset:18432
    v_mfma_f32_16x16x32_bf16 v[208:211], a[60:63], a[32:35], v[208:211]
    ds_read_b128 a[16:19], v8 offset:4096
    v_mfma_f32_16x16x32_bf16 v[212:215], a[60:63], a[36:39], v[212:215]
    ds_read_b128 a[20:23], v8 offset:5120
    v_mfma_f32_16x16x32_bf16 v[216:219], a[60:63], a[40:43], v[216:219]
    v_mfma_f32_16x16x32_bf16 v[220:223], a[60:63], a[44:47], v[220:223]
    s_waitcnt lgkmcnt(10)
    v_mfma_f32_16x16x32_bf16 v[224:227], a[64:67], a[24:27], v[224:227]
    ds_read_b64_tr_b16 a[56:57], v17 offset:12288
    v_mfma_f32_16x16x32_bf16 v[228:231], a[64:67], a[28:31], v[228:231]
    ds_read_b64_tr_b16 a[58:59], v17 offset:18432
    v_mfma_f32_16x16x32_bf16 v[232:235], a[64:67], a[32:35], v[232:235]
    v_mfma_f32_16x16x32_bf16 v[236:239], a[64:67], a[36:39], v[236:239]
    v_mfma_f32_16x16x32_bf16 v[240:243], a[64:67], a[40:43], v[240:243]
    v_mfma_f32_16x16x32_bf16 v[244:247], a[64:67], a[44:47], v[244:247]
    s_sub_u32 s88, s88, 1
    s_cmp_lg_u32 s88, 0
    s_cbranch_scc1 L_lb
    s_waitcnt vmcnt(0)
    s_nop 7
    s_lshl_b32 s60, s90, 1
    s_cmp_eq_u32 s60, s89
    s_cbranch_scc1 L_fb_skip0
    s_lshl_b32 s61, s89, 2
    s_add_u32 s61, s61, s60
    s_lshl_b32 s61, s61, 1
    s_add_u32 s61, s61, s91
    s_mul_i32 s61, s61, 8192
    v_cvt_pk_bf16_f32 v64, v128, v129
    v_cvt_pk_bf16_f32 v65, v130, v131
    v_cvt_pk_bf16_f32 v66, v132, v133
    v_cvt_pk_bf16_f32 v67, v134, v135
    buffer_store_dwordx4 v[64:67], v1, s[44:47], s61 offen offset:0 sc1
    v_cvt_pk_bf16_f32 v68, v136, v137
    v_cvt_pk_bf16_f32 v69, v138, v139
    v_cvt_pk_bf16_f32 v70, v152, v153
    v_cvt_pk_bf16_f32 v71, v154, v155
    buffer_store_dwordx4 v[68:71], v1, s[44:47], s61 offen offset:1024 sc1
    v_cvt_pk_bf16_f32 v72, v156, v157
    v_cvt_pk_bf16_f32 v73, v158, v159
    v_cvt_pk_bf16_f32 v74, v160, v161
    v_cvt_pk_bf16_f32 v75, v162, v163
    buffer_store_dwordx4 v[72:75], v1, s[44:47], s61 offen offset:2048 sc1
    v_cvt_pk_bf16_f32 v76, v176, v177
    v_cvt_pk_bf16_f32 v77, v178, v179
    v_cvt_pk_bf16_f32 v78, v180, v181
    v_cvt_pk_bf16_f32 v79, v182, v183
    buffer_store_dwordx4 v[76:79], v1, s[44:47], s61 offen offset:3072 sc1
    s_add_u32 s61, s61, 4096
    v_cvt_pk_bf16_f32 v80, v184, v185
    v_cvt_pk_bf16_f32 v81, v186, v187
    v_cvt_pk_bf16_f32 v82, v200, v201
    v_cvt_pk_bf16_f32 v83, v202, v203
    buffer_store_dwordx4 v[80:83], v1, s[44:47], s61 offen offset:0 sc1
    v_cvt_pk_bf16_f32 v84, v204, v205
    v_cvt_pk_bf16_f32 v85, v206, v207
    v_cvt_pk_bf16_f32 v86, v208, v209
    v_cvt_pk_bf16_f32 v87, v210, v211
    buffer_store_dwordx4 v[84:87], v1, s[44:47], s61 offen offset:1024 sc1
    v_cvt_pk_bf16_f32 v88, v224, v225
    v_cvt_pk_bf16_f32 v89, v226, v227
    v_cvt_pk_bf16_f32 v90, v228, v229
    v_cvt_pk_bf16_f32 v91, v230, v231
    buffer_store_dwordx4 v[88:91], v1, s[44:47], s61 offen offset:2048 sc1
    v_cvt_pk_bf16_f32 v92, v232, v233
    v_cvt_pk_bf16_f32 v93, v234, v235
    buffer_store_dwordx4 v[92:95], v1, s[44:47], s61 offen offset:3072 sc1
    s_nop 1
L_fb_skip0:
    s_lshl_b32 s60, s90, 1
    s_add_u32 s60, s60, 1
    s_cmp_eq_u32 s60, s89
    s_cbranch_scc1 L_fb_skip1
    s_lshl_b32 s61, s89, 2
    s_add_u32 s61, s61, s60
    s_lshl_b32 s61, s61, 1
    s_add_u32 s61, s61, s91
    s_mul_i32 s61, s61, 8192
    v_cvt_pk_bf16_f32 v64, v140, v141
    v_cvt_pk_bf16_f32 v65, v142, v143
    v_cvt_pk_bf16_f32 v66, v144, v145
    v_cvt_pk_bf16_f32 v67, v146, v147
    buffer_store_dwordx4 v[64:67], v1, s[44:47], s61 offen offset:0 sc1
    v_cvt_pk_bf16_f32 v68, v148, v149
    v_cvt_pk_bf16_f32 v69, v150, v151
    v_cvt_pk_bf16_f32 v70, v164, v165
    v_cvt_pk_bf16_f32 v71, v166, v167
    buffer_store_dwordx4 v[68:71], v1, s[44:47], s61 offen offset:1024 sc1
    v_cvt_pk_bf16_f32 v72, v168, v169
    v_cvt_pk_bf16_f32 v73, v170, v171
    v_cvt_pk_bf16_f32 v74, v172, v173
    v_cvt_pk_bf16_f32 v75, v174, v175
    buffer_store_dwordx4 v[72:75], v1, s[44:47], s61 offen offset:2048 sc1
    v_cvt_pk_bf16_f32 v76, v188, v189
    v_cvt_pk_bf16_f32 v77, v190, v191
    v_cvt_pk_bf16_f32 v78, v192, v193
    v_cvt_pk_bf16_f32 v79, v194, v195
    buffer_store_dwordx4 v[76:79], v1, s[44:47], s61 offen offset:3072 sc1
    s_add_u32 s61, s61, 4096
    v_cvt_pk_bf16_f32 v80, v196, v197
    v_cvt_pk_bf16_f32 v81, v198, v199
    v_cvt_pk_bf16_f32 v82, v212, v213
    v_cvt_pk_bf16_f32 v83, v214, v215
    buffer_store_dwordx4 v[80:83], v1, s[44:47], s61 offen offset:0 sc1
    v_cvt_pk_bf16_f32 v84, v216, v217
    v_cvt_pk_bf16_f32 v85, v218, v219
    v_cvt_pk_bf16_f32 v86, v220, v221
    v_cvt_pk_bf16_f32 v87, v222, v223
    buffer_store_dwordx4 v[84:87], v1, s[44:47], s61 offen offset:1024 sc1
    v_cvt_pk_bf16_f32 v88, v236, v237
    v_cvt_pk_bf16_f32 v89, v238, v239
    v_cvt_pk_bf16_f32 v90, v240, v241
    v_cvt_pk_bf16_f32 v91, v242, v243
    buffer_store_dwordx4 v[88:91], v1, s[44:47], s61 offen offset:2048 sc1
    v_cvt_pk_bf16_f32 v92, v244, v245
    v_cvt_pk_bf16_f32 v93, v246, v247
    buffer_store_dwordx4 v[92:95], v1, s[44:47], s61 offen offset:3072 sc1
    s_nop 1
L_fb_skip1:
    s_waitcnt vmcnt(0)
    s_barrier
    s_cmp_lg_u32 s31, 0
    s_cbranch_scc1 L_sig10
    v_accvgpr_read_b32 v104, a245
    v_mov_b32 v105, 1
    buffer_atomic_add v105, v104, s[76:79], 0 offen sc1
L_sig10:
    s_cmp_lg_u32 s31, 0
    s_cbranch_scc1 L_poll11_d
    v_accvgpr_read_b32 v104, a245
    s_mov_b32 s34, 0
L_poll11:
    buffer_load_dword v105, v104, s[76:79], 0 offen sc1
    s_waitcnt vmcnt(0)
    v_readfirstlane_b32 s35, v105
    s_add_u32 s34, s34, 1
    s_nop 2
    s_lshr_b32 s35, s35, 0
    s_and_b32 s35, s35, 0xff
    s_cmp_ge_u32 s35, 4
    s_cbranch_scc1 L_poll11_d
    s_sleep 2
    s_cmp_lt_u32 s34, 0x80000
    s_cbranch_scc1 L_poll11
L_poll11_d:
    s_barrier
    s_lshr_b32 s60, s89, 1
    s_cmp_lg_u32 s60, s90
    s_cbranch_scc1 L_fb_done
    s_add_u32 s61, s89, 1
    s_and_b32 s61, s61, 3
    s_lshl_b32 s61, s61, 2
    s_add_u32 s61, s61, s89
    s_lshl_b32 s61, s61, 1
    s_add_u32 s61, s61, s91
    s_mul_i32 s61, s61, 8192
    buffer_load_dwordx4 v[32:35], v1, s[44:47], s61 offen offset:0 sc1
    buffer_load_dwordx4 v[36:39], v1, s[44:47], s61 offen offset:1024 sc1
    buffer_load_dwordx4 v[40:43], v1, s[44:47], s61 offen offset:2048 sc1
    buffer_load_dwordx4 v[44:47], v1, s[44:47], s61 offen offset:3072 sc1
    s_add_u32 s61, s61, 4096
    buffer_load_dwordx4 v[48:51], v1, s[44:47], s61 offen offset:0 sc1
    buffer_load_dwordx4 v[52:55], v1, s[44:47], s61 offen offset:1024 sc1
    buffer_load_dwordx4 v[56:59], v1, s[44:47], s61 offen offset:2048 sc1
    buffer_load_dwordx2 v[60:61], v1, s[44:47], s61 offen offset:3072 sc1
    s_add_u32 s61, s89, 2
    s_and_b32 s61, s61, 3
    s_lshl_b32 s61, s61, 2
    s_add_u32 s61, s61, s89
    s_lshl_b32 s61, s61, 1
    s_add_u32 s61, s61, s91
    s_mul_i32 s61, s61, 8192
    buffer_load_dwordx4 v[64:67], v1, s[44:47], s61 offen offset:0 sc1
    buffer_load_dwordx4 v[68:71], v1, s[44:47], s61 offen offset:1024 sc1
    buffer_load_dwordx4 v[72:75], v1, s[44:47], s61 offen offset:2048 sc1
    buffer_load_dwordx4 v[76:79], v1, s[44:47], s61 offen offset:3072 sc1
    s_add_u32 s61, s61, 4096
    buffer_load_dwordx4 v[80:83], v1, s[44:47], s61 offen offset:0 sc1
    buffer_load_dwordx4 v[84:87], v1, s[44:47], s61 offen offset:1024 sc1
    buffer_load_dwordx4 v[88:91], v1, s[44:47], s61 offen offset:2048 sc1
    buffer_load_dwordx2 v[92:93], v1, s[44:47], s61 offen offset:3072 sc1
    s_add_u32 s61, s89, 3
    s_and_b32 s61, s61, 3
    s_lshl_b32 s61, s61, 2
    s_add_u32 s61, s61, s89
    s_lshl_b32 s61, s61, 1
    s_add_u32 s61, s61, s91
    s_mul_i32 s61, s61, 8192
    buffer_load_dwordx4 v[96:99], v1, s[44:47], s61 offen offset:0 sc1
    buffer_load_dwordx4 v[100:103], v1, s[44:47], s61 offen offset:1024 sc1
    buffer_load_dwordx4 v[104:107], v1, s[44:47], s61 offen offset:2048 sc1
    buffer_load_dwordx4 v[108:111], v1, s[44:47], s61 offen offset:3072 sc1
    s_add_u32 s61, s61, 4096
    buffer_load_dwordx4 v[112:115], v1, s[44:47], s61 offen offset:0 sc1
    buffer_load_dwordx4 v[116:119], v1, s[44:47], s61 offen offset:1024 sc1
    buffer_load_dwordx4 v[120:123], v1, s[44:47], s61 offen offset:2048 sc1
    buffer_load_dwordx2 v[124:125], v1, s[44:47], s61 offen offset:3072 sc1
    v_and_b32 v26, 15, v0
    v_lshrrev_b32 v27, 4, v0
    v_mul_u32_u24 v26, 2560, v26
    v_lshl_add_u32 v26, v27, 3, v26
    s_mul_i32 s60, s89, 122880
    s_mul_i32 s61, s91, 160
    s_add_u32 s60, s60, s61
    v_add_u32 v26, s60, v26
    s_and_b32 s60, s89, 1
    s_cmp_eq_u32 s60, 1
    s_waitcnt vmcnt(0)
    s_cbranch_scc1 L_fb_q1
    v_lshlrev_b32 v28, 16, v32
    v_lshlrev_b32 v29, 16, v64
    v_lshlrev_b32 v30, 16, v96
    v_add_f32 v28, v28, v29
    v_add_f32 v128, v128, v30
    v_add_f32 v128, v128, v28
    v_and_b32 v28, 0xffff0000, v32
    v_and_b32 v29, 0xffff0000, v64
    v_and_b32 v30, 0xffff0000, v96
    v_add_f32 v28, v28, v29
    v_add_f32 v129, v129, v30
    v_add_f32 v129, v129, v28
    v_lshlrev_b32 v28, 16, v33
    v_lshlrev_b32 v29, 16, v65
    v_lshlrev_b32 v30, 16, v97
    v_add_f32 v28, v28, v29
    v_add_f32 v130, v130, v30
    v_add_f32 v130, v130, v28
    v_and_b32 v28, 0xffff0000, v33
    v_and_b32 v29, 0xffff0000, v65
    v_and_b32 v30, 0xffff0000, v97
    v_add_f32 v28, v28, v29
    v_add_f32 v131, v131, v30
    v_add_f32 v131, v131, v28
    v_cvt_pk_bf16_f32 v128, v128, v129
    v_cvt_pk_bf16_f32 v129, v130, v131
    s_mov_b32 s61, 0
    buffer_store_dwordx2 v[128:129], v26, s[48:51], s61 offen offset:0
    v_lshlrev_b32 v28, 16, v34
    v_lshlrev_b32 v29, 16, v66
    v_lshlrev_b32 v30, 16, v98
    v_add_f32 v28, v28, v29
    v_add_f32 v132, v132, v30
    v_add_f32 v132, v132, v28
    v_and_b32 v28, 0xffff0000, v34
    v_and_b32 v29, 0xffff0000, v66
    v_and_b32 v30, 0xffff0000, v98
    v_add_f32 v28, v28, v29
    v_add_f32 v133, v133, v30
    v_add_f32 v133, v133, v28
    v_lshlrev_b32 v28, 16, v35
    v_lshlrev_b32 v29, 16, v67
    v_lshlrev_b32 v30, 16, v99
    v_add_f32 v28, v28, v29
    v_add_f32 v134, v134, v30
    v_add_f32 v134, v134, v28
    v_and_b32 v28, 0xffff0000, v35
    v_and_b32 v29, 0xffff0000, v67
    v_and_b32 v30, 0xffff0000, v99
    v_add_f32 v28, v28, v29
    v_add_f32 v135, v135, v30
    v_add_f32 v135, v135, v28
    v_cvt_pk_bf16_f32 v132, v132, v133
    v_cvt_pk_bf16_f32 v133, v134, v135
    s_mov_b32 s61, 40960
    buffer_store_dwordx2 v[132:133], v26, s[48:51], s61 offen offset:0
    v_lshlrev_b32 v28, 16, v36
    v_lshlrev_b32 v29, 16, v68
    v_lshlrev_b32 v30, 16, v100
    v_add_f32 v28, v28, v29
    v_add_f32 v136, v136, v30
    v_add_f32 v136, v136, v28
    v_and_b32 v28, 0xffff0000, v36
    v_and_b32 v29, 0xffff0000, v68
    v_and_b32 v30, 0xffff0000, v100
    v_add_f32 v28, v28, v29
    v_add_f32 v137, v137, v30
    v_add_f32 v137, v137, v28
    v_lshlrev_b32 v28, 16, v37
    v_lshlrev_b32 v29, 16, v69
    v_lshlrev_b32 v30, 16, v101
    v_add_f32 v28, v28, v29
    v_add_f32 v138, v138, v30
    v_add_f32 v138, v138, v28
    v_and_b32 v28, 0xffff0000, v37
    v_and_b32 v29, 0xffff0000, v69
    v_and_b32 v30, 0xffff0000, v101
    v_add_f32 v28, v28, v29
    v_add_f32 v139, v139, v30
    v_add_f32 v139, v139, v28
    v_cvt_pk_bf16_f32 v136, v136, v137
    v_cvt_pk_bf16_f32 v137, v138, v139
    s_mov_b32 s61, 81920
    buffer_store_dwordx2 v[136:137], v26, s[48:51], s61 offen offset:0
    v_lshlrev_b32 v28, 16, v38
    v_lshlrev_b32 v29, 16, v70
    v_lshlrev_b32 v30, 16, v102
    v_add_f32 v28, v28, v29
    v_add_f32 v152, v152, v30
    v_add_f32 v152, v152, v28
    v_and_b32 v28, 0xffff0000, v38
    v_and_b32 v29, 0xffff0000, v70
    v_and_b32 v30, 0xffff0000, v102
    v_add_f32 v28, v28, v29
    v_add_f32 v153, v153, v30
    v_add_f32 v153, v153, v28
    v_lshlrev_b32 v28, 16, v39
    v_lshlrev_b32 v29, 16, v71
    v_lshlrev_b32 v30, 16, v103
    v_add_f32 v28, v28, v29
    v_add_f32 v154, v154, v30
    v_add_f32 v154, v154, v28
    v_and_b32 v28, 0xffff0000, v39
    v_and_b32 v29, 0xffff0000, v71
    v_and_b32 v30, 0xffff0000, v103
    v_add_f32 v28, v28, v29
    v_add_f32 v155, v155, v30
    v_add_f32 v155, v155, v28
    v_cvt_pk_bf16_f32 v152, v152, v153
    v_cvt_pk_bf16_f32 v153, v154, v155
    s_mov_b32 s61, 0
    buffer_store_dwordx2 v[152:153], v26, s[48:51], s61 offen offset:32
    v_lshlrev_b32 v28, 16, v40
    v_lshlrev_b32 v29, 16, v72
    v_lshlrev_b32 v30, 16, v104
    v_add_f32 v28, v28, v29
    v_add_f32 v156, v156, v30
    v_add_f32 v156, v156, v28
    v_and_b32 v28, 0xffff0000, v40
    v_and_b32 v29, 0xffff0000, v72
    v_and_b32 v30, 0xffff0000, v104
    v_add_f32 v28, v28, v29
    v_add_f32 v157, v157, v30
    v_add_f32 v157, v157, v28
    v_lshlrev_b32 v28, 16, v41
    v_lshlrev_b32 v29, 16, v73
    v_lshlrev_b32 v30, 16, v105
    v_add_f32 v28, v28, v29
    v_add_f32 v158, v158, v30
    v_add_f32 v158, v158, v28
    v_and_b32 v28, 0xffff0000, v41
    v_and_b32 v29, 0xffff0000, v73
    v_and_b32 v30, 0xffff0000, v105
    v_add_f32 v28, v28, v29
    v_add_f32 v159, v159, v30
    v_add_f32 v159, v159, v28
    v_cvt_pk_bf16_f32 v156, v156, v157
    v_cvt_pk_bf16_f32 v157, v158, v159
    s_mov_b32 s61, 40960
    buffer_store_dwordx2 v[156:157], v26, s[48:51], s61 offen offset:32
    v_lshlrev_b32 v28, 16, v42
    v_lshlrev_b32 v29, 16, v74
    v_lshlrev_b32 v30, 16, v106
    v_add_f32 v28, v28, v29
    v_add_f32 v160, v160, v30
    v_add_f32 v160, v160, v28
    v_and_b32 v28, 0xffff0000, v42
    v_and_b32 v29, 0xffff0000, v74
    v_and_b32 v30, 0xffff0000, v106
    v_add_f32 v28, v28, v29
    v_add_f32 v161, v161, v30
    v_add_f32 v161, v161, v28
    v_lshlrev_b32 v28, 16, v43
    v_lshlrev_b32 v29, 16, v75
    v_lshlrev_b32 v30, 16, v107
    v_add_f32 v28, v28, v29
    v_add_f32 v162, v162, v30
    v_add_f32 v162, v162, v28
    v_and_b32 v28, 0xffff0000, v43
    v_and_b32 v29, 0xffff0000, v75
    v_and_b32 v30, 0xffff0000, v107
    v_add_f32 v28, v28, v29
    v_add_f32 v163, v163, v30
    v_add_f32 v163, v163, v28
    v_cvt_pk_bf16_f32 v160, v160, v161
    v_cvt_pk_bf16_f32 v161, v162, v163
    s_mov_b32 s61, 81920
    buffer_store_dwordx2 v[160:161], v26, s[48:51], s61 offen offset:32
    v_lshlrev_b32 v28, 16, v44
    v_lshlrev_b32 v29, 16, v76
    v_lshlrev_b32 v30, 16, v108
    v_add_f32 v28, v28, v29
    v_add_f32 v176, v176, v30
    v_add_f32 v176, v176, v28
    v_and_b32 v28, 0xffff0000, v44
    v_and_b32 v29, 0xffff0000, v76
    v_and_b32 v30, 0xffff0000, v108
    v_add_f32 v28, v28, v29
    v_add_f32 v177, v177, v30
    v_add_f32 v177, v177, v28
    v_lshlrev_b32 v28, 16, v45
    v_lshlrev_b32 v29, 16, v77
    v_lshlrev_b32 v30, 16, v109
    v_add_f32 v28, v28, v29
    v_add_f32 v178, v178, v30
    v_add_f32 v178, v178, v28
    v_and_b32 v28, 0xffff0000, v45
    v_and_b32 v29, 0xffff0000, v77
    v_and_b32 v30, 0xffff0000, v109
    v_add_f32 v28, v28, v29
    v_add_f32 v179, v179, v30
    v_add_f32 v179, v179, v28
    v_cvt_pk_bf16_f32 v176, v176, v177
    v_cvt_pk_bf16_f32 v177, v178, v179
    s_mov_b32 s61, 0
    buffer_store_dwordx2 v[176:177], v26, s[48:51], s61 offen offset:64
    v_lshlrev_b32 v28, 16, v46
    v_lshlrev_b32 v29, 16, v78
    v_lshlrev_b32 v30, 16, v110
    v_add_f32 v28, v28, v29
    v_add_f32 v180, v180, v30
    v_add_f32 v180, v180, v28
    v_and_b32 v28, 0xffff0000, v46
    v_and_b32 v29, 0xffff0000, v78
    v_and_b32 v30, 0xffff0000, v110
    v_add_f32 v28, v28, v29
    v_add_f32 v181, v181, v30
    v_add_f32 v181, v181, v28
    v_lshlrev_b32 v28, 16, v47
    v_lshlrev_b32 v29, 16, v79
    v_lshlrev_b32 v30, 16, v111
    v_add_f32 v28, v28, v29
    v_add_f32 v182, v182, v30
    v_add_f32 v182, v182, v28
    v_and_b32 v28, 0xffff0000, v47
    v_and_b32 v29, 0xffff0000, v79
    v_and_b32 v30, 0xffff0000, v111
    v_add_f32 v28, v28, v29
    v_add_f32 v183, v183, v30
    v_add_f32 v183, v183, v28
    v_cvt_pk_bf16_f32 v180, v180, v181
    v_cvt_pk_bf16_f32 v181, v182, v183
    s_mov_b32 s61, 40960
    buffer_store_dwordx2 v[180:181], v26, s[48:51], s61 offen offset:64
    v_lshlrev_b32 v28, 16, v48
    v_lshlrev_b32 v29, 16, v80
    v_lshlrev_b32 v30, 16, v112
    v_add_f32 v28, v28, v29
    v_add_f32 v184, v184, v30
    v_add_f32 v184, v184, v28
    v_and_b32 v28, 0xffff0000, v48
    v_and_b32 v29, 0xffff0000, v80
    v_and_b32 v30, 0xffff0000, v112
    v_add_f32 v28, v28, v29
    v_add_f32 v185, v185, v30
    v_add_f32 v185, v185, v28
    v_lshlrev_b32 v28, 16, v49
    v_lshlrev_b32 v29, 16, v81
    v_lshlrev_b32 v30, 16, v113
    v_add_f32 v28, v28, v29
    v_add_f32 v186, v186, v30
    v_add_f32 v186, v186, v28
    v_and_b32 v28, 0xffff0000, v49
    v_and_b32 v29, 0xffff0000, v81
    v_and_b32 v30, 0xffff0000, v113
    v_add_f32 v28, v28, v29
    v_add_f32 v187, v187, v30
    v_add_f32 v187, v187, v28
    v_cvt_pk_bf16_f32 v184, v184, v185
    v_cvt_pk_bf16_f32 v185, v186, v187
    s_mov_b32 s61, 81920
    buffer_store_dwordx2 v[184:185], v26, s[48:51], s61 offen offset:64
    v_lshlrev_b32 v28, 16, v50
    v_lshlrev_b32 v29, 16, v82
    v_lshlrev_b32 v30, 16, v114
    v_add_f32 v28, v28, v29
    v_add_f32 v200, v200, v30
    v_add_f32 v200, v200, v28
    v_and_b32 v28, 0xffff0000, v50
    v_and_b32 v29, 0xffff0000, v82
    v_and_b32 v30, 0xffff0000, v114
    v_add_f32 v28, v28, v29
    v_add_f32 v201, v201, v30
    v_add_f32 v201, v201, v28
    v_lshlrev_b32 v28, 16, v51
    v_lshlrev_b32 v29, 16, v83
    v_lshlrev_b32 v30, 16, v115
    v_add_f32 v28, v28, v29
    v_add_f32 v202, v202, v30
    v_add_f32 v202, v202, v28
    v_and_b32 v28, 0xffff0000, v51
    v_and_b32 v29, 0xffff0000, v83
    v_and_b32 v30, 0xffff0000, v115
    v_add_f32 v28, v28, v29
    v_add_f32 v203, v203, v30
    v_add_f32 v203, v203, v28
    v_cvt_pk_bf16_f32 v200, v200, v201
    v_cvt_pk_bf16_f32 v201, v202, v203
    s_mov_b32 s61, 0
    buffer_store_dwordx2 v[200:201], v26, s[48:51], s61 offen offset:96
    v_lshlrev_b32 v28, 16, v52
    v_lshlrev_b32 v29, 16, v84
    v_lshlrev_b32 v30, 16, v116
    v_add_f32 v28, v28, v29
    v_add_f32 v204, v204, v30
    v_add_f32 v204, v204, v28
    v_and_b32 v28, 0xffff0000, v52
    v_and_b32 v29, 0xffff0000, v84
    v_and_b32 v30, 0xffff0000, v116
    v_add_f32 v28, v28, v29
    v_add_f32 v205, v205, v30
    v_add_f32 v205, v205, v28
    v_lshlrev_b32 v28, 16, v53
    v_lshlrev_b32 v29, 16, v85
    v_lshlrev_b32 v30, 16, v117
    v_add_f32 v28, v28, v29
    v_add_f32 v206, v206, v30
    v_add_f32 v206, v206, v28
    v_and_b32 v28, 0xffff0000, v53
    v_and_b32 v29, 0xffff0000, v85
    v_and_b32 v30, 0xffff0000, v117
    v_add_f32 v28, v28, v29
    v_add_f32 v207, v207, v30
    v_add_f32 v207, v207, v28
    v_cvt_pk_bf16_f32 v204, v204, v205
    v_cvt_pk_bf16_f32 v205, v206, v207
    s_mov_b32 s61, 40960
    buffer_store_dwordx2 v[204:205], v26, s[48:51], s61 offen offset:96
    v_lshlrev_b32 v28, 16, v54
    v_lshlrev_b32 v29, 16, v86
    v_lshlrev_b32 v30, 16, v118
    v_add_f32 v28, v28, v29
    v_add_f32 v208, v208, v30
    v_add_f32 v208, v208, v28
    v_and_b32 v28, 0xffff0000, v54
    v_and_b32 v29, 0xffff0000, v86
    v_and_b32 v30, 0xffff0000, v118
    v_add_f32 v28, v28, v29
    v_add_f32 v209, v209, v30
    v_add_f32 v209, v209, v28
    v_lshlrev_b32 v28, 16, v55
    v_lshlrev_b32 v29, 16, v87
    v_lshlrev_b32 v30, 16, v119
    v_add_f32 v28, v28, v29
    v_add_f32 v210, v210, v30
    v_add_f32 v210, v210, v28
    v_and_b32 v28, 0xffff0000, v55
    v_and_b32 v29, 0xffff0000, v87
    v_and_b32 v30, 0xffff0000, v119
    v_add_f32 v28, v28, v29
    v_add_f32 v211, v211, v30
    v_add_f32 v211, v211, v28
    v_cvt_pk_bf16_f32 v208, v208, v209
    v_cvt_pk_bf16_f32 v209, v210, v211
    s_mov_b32 s61, 81920
    buffer_store_dwordx2 v[208:209], v26, s[48:51], s61 offen offset:96
    v_lshlrev_b32 v28, 16, v56
    v_lshlrev_b32 v29, 16, v88
    v_lshlrev_b32 v30, 16, v120
    v_add_f32 v28, v28, v29
    v_add_f32 v224, v224, v30
    v_add_f32 v224, v224, v28
    v_and_b32 v28, 0xffff0000, v56
    v_and_b32 v29, 0xffff0000, v88
    v_and_b32 v30, 0xffff0000, v120
    v_add_f32 v28, v28, v29
    v_add_f32 v225, v225, v30
    v_add_f32 v225, v225, v28
    v_lshlrev_b32 v28, 16, v57
    v_lshlrev_b32 v29, 16, v89
    v_lshlrev_b32 v30, 16, v121
    v_add_f32 v28, v28, v29
    v_add_f32 v226, v226, v30
    v_add_f32 v226, v226, v28
    v_and_b32 v28, 0xffff0000, v57
    v_and_b32 v29, 0xffff0000, v89
    v_and_b32 v30, 0xffff0000, v121
    v_add_f32 v28, v28, v29
    v_add_f32 v227, v227, v30
    v_add_f32 v227, v227, v28
    v_cvt_pk_bf16_f32 v224, v224, v225
    v_cvt_pk_bf16_f32 v225, v226, v227
    s_mov_b32 s61, 0
    buffer_store_dwordx2 v[224:225], v26, s[48:51], s61 offen offset:128
    v_lshlrev_b32 v28, 16, v58
    v_lshlrev_b32 v29, 16, v90
    v_lshlrev_b32 v30, 16, v122
    v_add_f32 v28, v28, v29
    v_add_f32 v228, v228, v30
    v_add_f32 v228, v228, v28
    v_and_b32 v28, 0xffff0000, v58
    v_and_b32 v29, 0xffff0000, v90
    v_and_b32 v30, 0xffff0000, v122
    v_add_f32 v28, v28, v29
    v_add_f32 v229, v229, v30
    v_add_f32 v229, v229, v28
    v_lshlrev_b32 v28, 16, v59
    v_lshlrev_b32 v29, 16, v91
    v_lshlrev_b32 v30, 16, v123
    v_add_f32 v28, v28, v29
    v_add_f32 v230, v230, v30
    v_add_f32 v230, v230, v28
    v_and_b32 v28, 0xffff0000, v59
    v_and_b32 v29, 0xffff0000, v91
    v_and_b32 v30, 0xffff0000, v123
    v_add_f32 v28, v28, v29
    v_add_f32 v231, v231, v30
    v_add_f32 v231, v231, v28
    v_cvt_pk_bf16_f32 v228, v228, v229
    v_cvt_pk_bf16_f32 v229, v230, v231
    s_mov_b32 s61, 40960
    buffer_store_dwordx2 v[228:229], v26, s[48:51], s61 offen offset:128
    v_lshlrev_b32 v28, 16, v60
    v_lshlrev_b32 v29, 16, v92
    v_lshlrev_b32 v30, 16, v124
    v_add_f32 v28, v28, v29
    v_add_f32 v232, v232, v30
    v_add_f32 v232, v232, v28
    v_and_b32 v28, 0xffff0000, v60
    v_and_b32 v29, 0xffff0000, v92
    v_and_b32 v30, 0xffff0000, v124
    v_add_f32 v28, v28, v29
    v_add_f32 v233, v233, v30
    v_add_f32 v233, v233, v28
    v_lshlrev_b32 v28, 16, v61
    v_lshlrev_b32 v29, 16, v93
    v_lshlrev_b32 v30, 16, v125
    v_add_f32 v28, v28, v29
    v_add_f32 v234, v234, v30
    v_add_f32 v234, v234, v28
    v_and_b32 v28, 0xffff0000, v61
    v_and_b32 v29, 0xffff0000, v93
    v_and_b32 v30, 0xffff0000, v125
    v_add_f32 v28, v28, v29
    v_add_f32 v235, v235, v30
    v_add_f32 v235, v235, v28
    v_cvt_pk_bf16_f32 v232, v232, v233
    v_cvt_pk_bf16_f32 v233, v234, v235
    s_mov_b32 s61, 81920
    buffer_store_dwordx2 v[232:233], v26, s[48:51], s61 offen offset:128
    s_branch L_fb_done
L_fb_q1:
    v_lshlrev_b32 v28, 16, v32
    v_lshlrev_b32 v29, 16, v64
    v_lshlrev_b32 v30, 16, v96
    v_add_f32 v28, v28, v29
    v_add_f32 v140, v140, v30
    v_add_f32 v140, v140, v28
    v_and_b32 v28, 0xffff0000, v32
    v_and_b32 v29, 0xffff0000, v64
    v_and_b32 v30, 0xffff0000, v96
    v_add_f32 v28, v28, v29
    v_add_f32 v141, v141, v30
    v_add_f32 v141, v141, v28
    v_lshlrev_b32 v28, 16, v33
    v_lshlrev_b32 v29, 16, v65
    v_lshlrev_b32 v30, 16, v97
    v_add_f32 v28, v28, v29
    v_add_f32 v142, v142, v30
    v_add_f32 v142, v142, v28
    v_and_b32 v28, 0xffff0000, v33
    v_and_b32 v29, 0xffff0000, v65
    v_and_b32 v30, 0xffff0000, v97
    v_add_f32 v28, v28, v29
    v_add_f32 v143, v143, v30
    v_add_f32 v143, v143, v28
    v_cvt_pk_bf16_f32 v140, v140, v141
    v_cvt_pk_bf16_f32 v141, v142, v143
    s_mov_b32 s61, 0
    buffer_store_dwordx2 v[140:141], v26, s[48:51], s61 offen offset:0
    v_lshlrev_b32 v28, 16, v34
    v_lshlrev_b32 v29, 16, v66
    v_lshlrev_b32 v30, 16, v98
    v_add_f32 v28, v28, v29
    v_add_f32 v144, v144, v30
    v_add_f32 v144, v144, v28
    v_and_b32 v28, 0xffff0000, v34
    v_and_b32 v29, 0xffff0000, v66
    v_and_b32 v30, 0xffff0000, v98
    v_add_f32 v28, v28, v29
    v_add_f32 v145, v145, v30
    v_add_f32 v145, v145, v28
    v_lshlrev_b32 v28, 16, v35
    v_lshlrev_b32 v29, 16, v67
    v_lshlrev_b32 v30, 16, v99
    v_add_f32 v28, v28, v29
    v_add_f32 v146, v146, v30
    v_add_f32 v146, v146, v28
    v_and_b32 v28, 0xffff0000, v35
    v_and_b32 v29, 0xffff0000, v67
    v_and_b32 v30, 0xffff0000, v99
    v_add_f32 v28, v28, v29
    v_add_f32 v147, v147, v30
    v_add_f32 v147, v147, v28
    v_cvt_pk_bf16_f32 v144, v144, v145
    v_cvt_pk_bf16_f32 v145, v146, v147
    s_mov_b32 s61, 40960
    buffer_store_dwordx2 v[144:145], v26, s[48:51], s61 offen offset:0
    v_lshlrev_b32 v28, 16, v36
    v_lshlrev_b32 v29, 16, v68
    v_lshlrev_b32 v30, 16, v100
    v_add_f32 v28, v28, v29
    v_add_f32 v148, v148, v30
    v_add_f32 v148, v148, v28
    v_and_b32 v28, 0xffff0000, v36
    v_and_b32 v29, 0xffff0000, v68
    v_and_b32 v30, 0xffff0000, v100
    v_add_f32 v28, v28, v29
    v_add_f32 v149, v149, v30
    v_add_f32 v149, v149, v28
    v_lshlrev_b32 v28, 16, v37
    v_lshlrev_b32 v29, 16, v69
    v_lshlrev_b32 v30, 16, v101
    v_add_f32 v28, v28, v29
    v_add_f32 v150, v150, v30
    v_add_f32 v150, v150, v28
    v_and_b32 v28, 0xffff0000, v37
    v_and_b32 v29, 0xffff0000, v69
    v_and_b32 v30, 0xffff0000, v101
    v_add_f32 v28, v28, v29
    v_add_f32 v151, v151, v30
    v_add_f32 v151, v151, v28
    v_cvt_pk_bf16_f32 v148, v148, v149
    v_cvt_pk_bf16_f32 v149, v150, v151
    s_mov_b32 s61, 81920
    buffer_store_dwordx2 v[148:149], v26, s[48:51], s61 offen offset:0
    v_lshlrev_b32 v28, 16, v38
    v_lshlrev_b32 v29, 16, v70
    v_lshlrev_b32 v30, 16, v102
    v_add_f32 v28, v28, v29
    v_add_f32 v164, v164, v30
    v_add_f32 v164, v164, v28
    v_and_b32 v28, 0xffff0000, v38
    v_and_b32 v29, 0xffff0000, v70
    v_and_b32 v30, 0xffff0000, v102
    v_add_f32 v28, v28, v29
    v_add_f32 v165, v165, v30
    v_add_f32 v165, v165, v28
    v_lshlrev_b32 v28, 16, v39
    v_lshlrev_b32 v29, 16, v71
    v_lshlrev_b32 v30, 16, v103
    v_add_f32 v28, v28, v29
    v_add_f32 v166, v166, v30
    v_add_f32 v166, v166, v28
    v_and_b32 v28, 0xffff0000, v39
    v_and_b32 v29, 0xffff0000, v71
    v_and_b32 v30, 0xffff0000, v103
    v_add_f32 v28, v28, v29
    v_add_f32 v167, v167, v30
    v_add_f32 v167, v167, v28
    v_cvt_pk_bf16_f32 v164, v164, v165
    v_cvt_pk_bf16_f32 v165, v166, v167
    s_mov_b32 s61, 0
    buffer_store_dwordx2 v[164:165], v26, s[48:51], s61 offen offset:32
    v_lshlrev_b32 v28, 16, v40
    v_lshlrev_b32 v29, 16, v72
    v_lshlrev_b32 v30, 16, v104
    v_add_f32 v28, v28, v29
    v_add_f32 v168, v168, v30
    v_add_f32 v168, v168, v28
    v_and_b32 v28, 0xffff0000, v40
    v_and_b32 v29, 0xffff0000, v72
    v_and_b32 v30, 0xffff0000, v104
    v_add_f32 v28, v28, v29
    v_add_f32 v169, v169, v30
    v_add_f32 v169, v169, v28
    v_lshlrev_b32 v28, 16, v41
    v_lshlrev_b32 v29, 16, v73
    v_lshlrev_b32 v30, 16, v105
    v_add_f32 v28, v28, v29
    v_add_f32 v170, v170, v30
    v_add_f32 v170, v170, v28
    v_and_b32 v28, 0xffff0000, v41
    v_and_b32 v29, 0xffff0000, v73
    v_and_b32 v30, 0xffff0000, v105
    v_add_f32 v28, v28, v29
    v_add_f32 v171, v171, v30
    v_add_f32 v171, v171, v28
    v_cvt_pk_bf16_f32 v168, v168, v169
    v_cvt_pk_bf16_f32 v169, v170, v171
    s_mov_b32 s61, 40960
    buffer_store_dwordx2 v[168:169], v26, s[48:51], s61 offen offset:32
    v_lshlrev_b32 v28, 16, v42
    v_lshlrev_b32 v29, 16, v74
    v_lshlrev_b32 v30, 16, v106
    v_add_f32 v28, v28, v29
    v_add_f32 v172, v172, v30
    v_add_f32 v172, v172, v28
    v_and_b32 v28, 0xffff0000, v42
    v_and_b32 v29, 0xffff0000, v74
    v_and_b32 v30, 0xffff0000, v106
    v_add_f32 v28, v28, v29
    v_add_f32 v173, v173, v30
    v_add_f32 v173, v173, v28
    v_lshlrev_b32 v28, 16, v43
    v_lshlrev_b32 v29, 16, v75
    v_lshlrev_b32 v30, 16, v107
    v_add_f32 v28, v28, v29
    v_add_f32 v174, v174, v30
    v_add_f32 v174, v174, v28
    v_and_b32 v28, 0xffff0000, v43
    v_and_b32 v29, 0xffff0000, v75
    v_and_b32 v30, 0xffff0000, v107
    v_add_f32 v28, v28, v29
    v_add_f32 v175, v175, v30
    v_add_f32 v175, v175, v28
    v_cvt_pk_bf16_f32 v172, v172, v173
    v_cvt_pk_bf16_f32 v173, v174, v175
    s_mov_b32 s61, 81920
    buffer_store_dwordx2 v[172:173], v26, s[48:51], s61 offen offset:32
    v_lshlrev_b32 v28, 16, v44
    v_lshlrev_b32 v29, 16, v76
    v_lshlrev_b32 v30, 16, v108
    v_add_f32 v28, v28, v29
    v_add_f32 v188, v188, v30
    v_add_f32 v188, v188, v28
    v_and_b32 v28, 0xffff0000, v44
    v_and_b32 v29, 0xffff0000, v76
    v_and_b32 v30, 0xffff0000, v108
    v_add_f32 v28, v28, v29
    v_add_f32 v189, v189, v30
    v_add_f32 v189, v189, v28
    v_lshlrev_b32 v28, 16, v45
    v_lshlrev_b32 v29, 16, v77
    v_lshlrev_b32 v30, 16, v109
    v_add_f32 v28, v28, v29
    v_add_f32 v190, v190, v30
    v_add_f32 v190, v190, v28
    v_and_b32 v28, 0xffff0000, v45
    v_and_b32 v29, 0xffff0000, v77
    v_and_b32 v30, 0xffff0000, v109
    v_add_f32 v28, v28, v29
    v_add_f32 v191, v191, v30
    v_add_f32 v191, v191, v28
    v_cvt_pk_bf16_f32 v188, v188, v189
    v_cvt_pk_bf16_f32 v189, v190, v191
    s_mov_b32 s61, 0
    buffer_store_dwordx2 v[188:189], v26, s[48:51], s61 offen offset:64
    v_lshlrev_b32 v28, 16, v46
    v_lshlrev_b32 v29, 16, v78
    v_lshlrev_b32 v30, 16, v110
    v_add_f32 v28, v28, v29
    v_add_f32 v192, v192, v30
    v_add_f32 v192, v192, v28
    v_and_b32 v28, 0xffff0000, v46
    v_and_b32 v29, 0xffff0000, v78
    v_and_b32 v30, 0xffff0000, v110
    v_add_f32 v28, v28, v29
    v_add_f32 v193, v193, v30
    v_add_f32 v193, v193, v28
    v_lshlrev_b32 v28, 16, v47
    v_lshlrev_b32 v29, 16, v79
    v_lshlrev_b32 v30, 16, v111
    v_add_f32 v28, v28, v29
    v_add_f32 v194, v194, v30
    v_add_f32 v194, v194, v28
    v_and_b32 v28, 0xffff0000, v47
    v_and_b32 v29, 0xffff0000, v79
    v_and_b32 v30, 0xffff0000, v111
    v_add_f32 v28, v28, v29
    v_add_f32 v195, v195, v30
    v_add_f32 v195, v195, v28
    v_cvt_pk_bf16_f32 v192, v192, v193
    v_cvt_pk_bf16_f32 v193, v194, v195
    s_mov_b32 s61, 40960
    buffer_store_dwordx2 v[192:193], v26, s[48:51], s61 offen offset:64
    v_lshlrev_b32 v28, 16, v48
    v_lshlrev_b32 v29, 16, v80
    v_lshlrev_b32 v30, 16, v112
    v_add_f32 v28, v28, v29
    v_add_f32 v196, v196, v30
    v_add_f32 v196, v196, v28
    v_and_b32 v28, 0xffff0000, v48
    v_and_b32 v29, 0xffff0000, v80
    v_and_b32 v30, 0xffff0000, v112
    v_add_f32 v28, v28, v29
    v_add_f32 v197, v197, v30
    v_add_f32 v197, v197, v28
    v_lshlrev_b32 v28, 16, v49
    v_lshlrev_b32 v29, 16, v81
    v_lshlrev_b32 v30, 16, v113
    v_add_f32 v28, v28, v29
    v_add_f32 v198, v198, v30
    v_add_f32 v198, v198, v28
    v_and_b32 v28, 0xffff0000, v49
    v_and_b32 v29, 0xffff0000, v81
    v_and_b32 v30, 0xffff0000, v113
    v_add_f32 v28, v28, v29
    v_add_f32 v199, v199, v30
    v_add_f32 v199, v199, v28
    v_cvt_pk_bf16_f32 v196, v196, v197
    v_cvt_pk_bf16_f32 v197, v198, v199
    s_mov_b32 s61, 81920
    buffer_store_dwordx2 v[196:197], v26, s[48:51], s61 offen offset:64
    v_lshlrev_b32 v28, 16, v50
    v_lshlrev_b32 v29, 16, v82
    v_lshlrev_b32 v30, 16, v114
    v_add_f32 v28, v28, v29
    v_add_f32 v212, v212, v30
    v_add_f32 v212, v212, v28
    v_and_b32 v28, 0xffff0000, v50
    v_and_b32 v29, 0xffff0000, v82
    v_and_b32 v30, 0xffff0000, v114
    v_add_f32 v28, v28, v29
    v_add_f32 v213, v213, v30
    v_add_f32 v213, v213, v28
    v_lshlrev_b32 v28, 16, v51
    v_lshlrev_b32 v29, 16, v83
    v_lshlrev_b32 v30, 16, v115
    v_add_f32 v28, v28, v29
    v_add_f32 v214, v214, v30
    v_add_f32 v214, v214, v28
    v_and_b32 v28, 0xffff0000, v51
    v_and_b32 v29, 0xffff0000, v83
    v_and_b32 v30, 0xffff0000, v115
    v_add_f32 v28, v28, v29
    v_add_f32 v215, v215, v30
    v_add_f32 v215, v215, v28
    v_cvt_pk_bf16_f32 v212, v212, v213
    v_cvt_pk_bf16_f32 v213, v214, v215
    s_mov_b32 s61, 0
    buffer_store_dwordx2 v[212:213], v26, s[48:51], s61 offen offset:96
    v_lshlrev_b32 v28, 16, v52
    v_lshlrev_b32 v29, 16, v84
    v_lshlrev_b32 v30, 16, v116
    v_add_f32 v28, v28, v29
    v_add_f32 v216, v216, v30
    v_add_f32 v216, v216, v28
    v_and_b32 v28, 0xffff0000, v52
    v_and_b32 v29, 0xffff0000, v84
    v_and_b32 v30, 0xffff0000, v116
    v_add_f32 v28, v28, v29
    v_add_f32 v217, v217, v30
    v_add_f32 v217, v217, v28
    v_lshlrev_b32 v28, 16, v53
    v_lshlrev_b32 v29, 16, v85
    v_lshlrev_b32 v30, 16, v117
    v_add_f32 v28, v28, v29
    v_add_f32 v218, v218, v30
    v_add_f32 v218, v218, v28
    v_and_b32 v28, 0xffff0000, v53
    v_and_b32 v29, 0xffff0000, v85
    v_and_b32 v30, 0xffff0000, v117
    v_add_f32 v28, v28, v29
    v_add_f32 v219, v219, v30
    v_add_f32 v219, v219, v28
    v_cvt_pk_bf16_f32 v216, v216, v217
    v_cvt_pk_bf16_f32 v217, v218, v219
    s_mov_b32 s61, 40960
    buffer_store_dwordx2 v[216:217], v26, s[48:51], s61 offen offset:96
    v_lshlrev_b32 v28, 16, v54
    v_lshlrev_b32 v29, 16, v86
    v_lshlrev_b32 v30, 16, v118
    v_add_f32 v28, v28, v29
    v_add_f32 v220, v220, v30
    v_add_f32 v220, v220, v28
    v_and_b32 v28, 0xffff0000, v54
    v_and_b32 v29, 0xffff0000, v86
    v_and_b32 v30, 0xffff0000, v118
    v_add_f32 v28, v28, v29
    v_add_f32 v221, v221, v30
    v_add_f32 v221, v221, v28
    v_lshlrev_b32 v28, 16, v55
    v_lshlrev_b32 v29, 16, v87
    v_lshlrev_b32 v30, 16, v119
    v_add_f32 v28, v28, v29
    v_add_f32 v222, v222, v30
    v_add_f32 v222, v222, v28
    v_and_b32 v28, 0xffff0000, v55
    v_and_b32 v29, 0xffff0000, v87
    v_and_b32 v30, 0xffff0000, v119
    v_add_f32 v28, v28, v29
    v_add_f32 v223, v223, v30
    v_add_f32 v223, v223, v28
    v_cvt_pk_bf16_f32 v220, v220, v221
    v_cvt_pk_bf16_f32 v221, v222, v223
    s_mov_b32 s61, 81920
    buffer_store_dwordx2 v[220:221], v26, s[48:51], s61 offen offset:96
    v_lshlrev_b32 v28, 16, v56
    v_lshlrev_b32 v29, 16, v88
    v_lshlrev_b32 v30, 16, v120
    v_add_f32 v28, v28, v29
    v_add_f32 v236, v236, v30
    v_add_f32 v236, v236, v28
    v_and_b32 v28, 0xffff0000, v56
    v_and_b32 v29, 0xffff0000, v88
    v_and_b32 v30, 0xffff0000, v120
    v_add_f32 v28, v28, v29
    v_add_f32 v237, v237, v30
    v_add_f32 v237, v237, v28
    v_lshlrev_b32 v28, 16, v57
    v_lshlrev_b32 v29, 16, v89
    v_lshlrev_b32 v30, 16, v121
    v_add_f32 v28, v28, v29
    v_add_f32 v238, v238, v30
    v_add_f32 v238, v238, v28
    v_and_b32 v28, 0xffff0000, v57
    v_and_b32 v29, 0xffff0000, v89
    v_and_b32 v30, 0xffff0000, v121
    v_add_f32 v28, v28, v29
    v_add_f32 v239, v239, v30
    v_add_f32 v239, v239, v28
    v_cvt_pk_bf16_f32 v236, v236, v237
    v_cvt_pk_bf16_f32 v237, v238, v239
    s_mov_b32 s61, 0
    buffer_store_dwordx2 v[236:237], v26, s[48:51], s61 offen offset:128
    v_lshlrev_b32 v28, 16, v58
    v_lshlrev_b32 v29, 16, v90
    v_lshlrev_b32 v30, 16, v122
    v_add_f32 v28, v28, v29
    v_add_f32 v240, v240, v30
    v_add_f32 v240, v240, v28
    v_and_b32 v28, 0xffff0000, v58
    v_and_b32 v29, 0xffff0000, v90
    v_and_b32 v30, 0xffff0000, v122
    v_add_f32 v28, v28, v29
    v_add_f32 v241, v241, v30
    v_add_f32 v241, v241, v28
    v_lshlrev_b32 v28, 16, v59
    v_lshlrev_b32 v29, 16, v91
    v_lshlrev_b32 v30, 16, v123
    v_add_f32 v28, v28, v29
    v_add_f32 v242, v242, v30
    v_add_f32 v242, v242, v28
    v_and_b32 v28, 0xffff0000, v59
    v_and_b32 v29, 0xffff0000, v91
    v_and_b32 v30, 0xffff0000, v123
    v_add_f32 v28, v28, v29
    v_add_f32 v243, v243, v30
    v_add_f32 v243, v243, v28
    v_cvt_pk_bf16_f32 v240, v240, v241
    v_cvt_pk_bf16_f32 v241, v242, v243
    s_mov_b32 s61, 40960
    buffer_store_dwordx2 v[240:241], v26, s[48:51], s61 offen offset:128
    v_lshlrev_b32 v28, 16, v60
    v_lshlrev_b32 v29, 16, v92
    v_lshlrev_b32 v30, 16, v124
    v_add_f32 v28, v28, v29
    v_add_f32 v244, v244, v30
    v_add_f32 v244, v244, v28
    v_and_b32 v28, 0xffff0000, v60
    v_and_b32 v29, 0xffff0000, v92
    v_and_b32 v30, 0xffff0000, v124
    v_add_f32 v28, v28, v29
    v_add_f32 v245, v245, v30
    v_add_f32 v245, v245, v28
    v_lshlrev_b32 v28, 16, v61
    v_lshlrev_b32 v29, 16, v93
    v_lshlrev_b32 v30, 16, v125
    v_add_f32 v28, v28, v29
    v_add_f32 v246, v246, v30
    v_add_f32 v246, v246, v28
    v_and_b32 v28, 0xffff0000, v61
    v_and_b32 v29, 0xffff0000, v93
    v_and_b32 v30, 0xffff0000, v125
    v_add_f32 v28, v28, v29
    v_add_f32 v247, v247, v30
    v_add_f32 v247, v247, v28
    v_cvt_pk_bf16_f32 v244, v244, v245
    v_cvt_pk_bf16_f32 v245, v246, v247
    s_mov_b32 s61, 81920
    buffer_store_dwordx2 v[244:245], v26, s[48:51], s61 offen offset:128
L_fb_done:
L_exit1:
    s_endpgm
    L_slow:
    s_waitcnt vmcnt(0) lgkmcnt(0)
    s_sub_u32 s34, s27, 196608
    v_and_b32 v100, 15, v0
    v_lshrrev_b32 v101, 4, v0
    v_lshrrev_b32 v102, 1, v101
    v_and_b32 v103, 1, v101
    v_lshl_or_b32 v102, v103, 1, v102
    v_mul_u32_u24 v100, 384, v100
    v_lshl_add_u32 v104, v102, 4, v100
    v_lshrrev_b32 v100, 3, v0
    v_and_b32 v101, 7, v0
    v_mul_u32_u24 v100, 384, v100
    v_lshl_add_u32 v105, v101, 4, v100
    v_lshrrev_b32 v100, 2, v0
    v_lshlrev_b32 v100, 7, v100
    v_and_b32 v101, 3, v0
    v_lshl_add_u32 v100, v101, 3, v100
    s_lshl_b32 s35, s31, 12
    s_add_u32 s35, s35, 147456
    v_add_u32 v106, s35, v100
    v_mov_b32 v108, 0xff800000
    v_mov_b32 v109, 0xff800000
    v_mov_b32 v110, 0xff800000
    s_mov_b32 s100, s34
    s_mov_b32 s101, 16
    L_slow1:
    s_add_u32 s33, s100, 0
    buffer_load_dwordx4 v[64:67], v104, s[12:15], s33 offen offset:0
    buffer_load_dwordx4 v[68:71], v104, s[12:15], s33 offen offset:64
    buffer_load_dwordx4 v[72:75], v104, s[12:15], s33 offen offset:128
    buffer_load_dwordx4 v[76:79], v104, s[12:15], s33 offen offset:192
    buffer_load_dwordx4 v[80:83], v104, s[12:15], s33 offen offset:256
    buffer_load_dwordx4 v[84:87], v104, s[12:15], s33 offen offset:320
    s_waitcnt vmcnt(0)
    v_mfma_f32_16x16x32_bf16 v[116:119], v[64:67], v[112:115], 0
    v_mfma_f32_16x16x32_bf16 v[124:127], v[64:67], v[120:123], 0
    v_mfma_f32_16x16x32_bf16 v[132:135], v[64:67], v[128:131], 0
    v_mfma_f32_16x16x32_bf16 v[116:119], v[68:71], v[136:139], v[116:119]
    v_mfma_f32_16x16x32_bf16 v[124:127], v[68:71], v[144:147], v[124:127]
    v_mfma_f32_16x16x32_bf16 v[132:135], v[68:71], v[152:155], v[132:135]
    v_mfma_f32_16x16x32_bf16 v[116:119], v[72:75], v[160:163], v[116:119]
    v_mfma_f32_16x16x32_bf16 v[124:127], v[72:75], v[168:171], v[124:127]
    v_mfma_f32_16x16x32_bf16 v[132:135], v[72:75], v[176:179], v[132:135]
    v_mfma_f32_16x16x32_bf16 v[116:119], v[76:79], v[184:187], v[116:119]
    v_mfma_f32_16x16x32_bf16 v[124:127], v[76:79], v[192:195], v[124:127]
    v_mfma_f32_16x16x32_bf16 v[132:135], v[76:79], v[200:203], v[132:135]
    v_mfma_f32_16x16x32_bf16 v[116:119], v[80:83], v[208:211], v[116:119]
    v_mfma_f32_16x16x32_bf16 v[124:127], v[80:83], v[216:219], v[124:127]
    v_mfma_f32_16x16x32_bf16 v[132:135], v[80:83], v[224:227], v[132:135]
    v_mfma_f32_16x16x32_bf16 v[116:119], v[84:87], v[232:235], v[116:119]
    v_mfma_f32_16x16x32_bf16 v[124:127], v[84:87], v[240:243], v[124:127]
    v_mfma_f32_16x16x32_bf16 v[132:135], v[84:87], v[248:251], v[132:135]
    s_nop 7
    s_nop 7
    s_add_u32 s33, s100, 6144
    buffer_load_dwordx4 v[64:67], v104, s[12:15], s33 offen offset:0
    buffer_load_dwordx4 v[68:71], v104, s[12:15], s33 offen offset:64
    buffer_load_dwordx4 v[72:75], v104, s[12:15], s33 offen offset:128
    buffer_load_dwordx4 v[76:79], v104, s[12:15], s33 offen offset:192
    buffer_load_dwordx4 v[80:83], v104, s[12:15], s33 offen offset:256
    buffer_load_dwordx4 v[84:87], v104, s[12:15], s33 offen offset:320
    s_waitcnt vmcnt(0)
    v_mfma_f32_16x16x32_bf16 v[140:143], v[64:67], v[112:115], 0
    v_mfma_f32_16x16x32_bf16 v[148:151], v[64:67], v[120:123], 0
    v_mfma_f32_16x16x32_bf16 v[156:159], v[64:67], v[128:131], 0
    v_mfma_f32_16x16x32_bf16 v[140:143], v[68:71], v[136:139], v[140:143]
    v_mfma_f32_16x16x32_bf16 v[148:151], v[68:71], v[144:147], v[148:151]
    v_mfma_f32_16x16x32_bf16 v[156:159], v[68:71], v[152:155], v[156:159]
    v_mfma_f32_16x16x32_bf16 v[140:143], v[72:75], v[160:163], v[140:143]
    v_mfma_f32_16x16x32_bf16 v[148:151], v[72:75], v[168:171], v[148:151]
    v_mfma_f32_16x16x32_bf16 v[156:159], v[72:75], v[176:179], v[156:159]
    v_mfma_f32_16x16x32_bf16 v[140:143], v[76:79], v[184:187], v[140:143]
    v_mfma_f32_16x16x32_bf16 v[148:151], v[76:79], v[192:195], v[148:151]
    v_mfma_f32_16x16x32_bf16 v[156:159], v[76:79], v[200:203], v[156:159]
    v_mfma_f32_16x16x32_bf16 v[140:143], v[80:83], v[208:211], v[140:143]
    v_mfma_f32_16x16x32_bf16 v[148:151], v[80:83], v[216:219], v[148:151]
    v_mfma_f32_16x16x32_bf16 v[156:159], v[80:83], v[224:227], v[156:159]
    v_mfma_f32_16x16x32_bf16 v[140:143], v[84:87], v[232:235], v[140:143]
    v_mfma_f32_16x16x32_bf16 v[148:151], v[84:87], v[240:243], v[148:151]
    v_mfma_f32_16x16x32_bf16 v[156:159], v[84:87], v[248:251], v[156:159]
    s_nop 7
    s_nop 7
    v_max3_f32 v108, v108, v116, v117
    v_max3_f32 v108, v108, v118, v119
    v_max3_f32 v108, v108, v140, v141
    v_max3_f32 v108, v108, v142, v143
    v_max3_f32 v109, v109, v124, v125
    v_max3_f32 v109, v109, v126, v127
    v_max3_f32 v109, v109, v148, v149
    v_max3_f32 v109, v109, v150, v151
    v_max3_f32 v110, v110, v132, v133
    v_max3_f32 v110, v110, v134, v135
    v_max3_f32 v110, v110, v156, v157
    v_max3_f32 v110, v110, v158, v159
    s_add_u32 s100, s100, 12288
    s_sub_u32 s101, s101, 1
    s_cmp_lg_u32 s101, 0
    s_cbranch_scc1 L_slow1
    v_mov_b32 v100, v108
    v_mov_b32 v101, v109
    v_mov_b32 v102, v110
    s_nop 1
    v_permlane16_swap_b32 v108, v100
    v_permlane16_swap_b32 v109, v101
    v_permlane16_swap_b32 v110, v102
    s_nop 1
    v_max_f32 v108, v108, v100
    v_max_f32 v109, v109, v101
    v_max_f32 v110, v110, v102
    v_mov_b32 v100, v108
    v_mov_b32 v101, v109
    v_mov_b32 v102, v110
    s_nop 1
    v_permlane32_swap_b32 v108, v100
    v_permlane32_swap_b32 v109, v101
    v_permlane32_swap_b32 v110, v102
    s_nop 1
    v_max_f32 v108, v108, v100
    v_max_f32 v109, v109, v101
    v_max_f32 v110, v110, v102
    v_sub_f32 v212, 0, v108
    v_sub_f32 v213, 0, v108
    v_sub_f32 v214, 0, v108
    v_sub_f32 v215, 0, v108
    v_sub_f32 v220, 0, v109
    v_sub_f32 v221, 0, v109
    v_sub_f32 v222, 0, v109
    v_sub_f32 v223, 0, v109
    v_sub_f32 v228, 0, v110
    v_sub_f32 v229, 0, v110
    v_sub_f32 v230, 0, v110
    v_sub_f32 v231, 0, v110
    v_accvgpr_write_b32 a0, 0
    v_accvgpr_write_b32 a1, 0
    v_accvgpr_write_b32 a2, 0
    v_accvgpr_write_b32 a3, 0
    v_accvgpr_write_b32 a4, 0
    v_accvgpr_write_b32 a5, 0
    v_accvgpr_write_b32 a6, 0
    v_accvgpr_write_b32 a7, 0
    v_accvgpr_write_b32 a8, 0
    v_accvgpr_write_b32 a9, 0
    v_accvgpr_write_b32 a10, 0
    v_accvgpr_write_b32 a11, 0
    v_accvgpr_write_b32 a12, 0
    v_accvgpr_write_b32 a13, 0
    v_accvgpr_write_b32 a14, 0
    v_accvgpr_write_b32 a15, 0
    v_accvgpr_write_b32 a16, 0
    v_accvgpr_write_b32 a17, 0
    v_accvgpr_write_b32 a18, 0
    v_accvgpr_write_b32 a19, 0
    v_accvgpr_write_b32 a20, 0
    v_accvgpr_write_b32 a21, 0
    v_accvgpr_write_b32 a22, 0
    v_accvgpr_write_b32 a23, 0
    v_accvgpr_write_b32 a24, 0
    v_accvgpr_write_b32 a25, 0
    v_accvgpr_write_b32 a26, 0
    v_accvgpr_write_b32 a27, 0
    v_accvgpr_write_b32 a28, 0
    v_accvgpr_write_b32 a29, 0
    v_accvgpr_write_b32 a30, 0
    v_accvgpr_write_b32 a31, 0
    v_accvgpr_write_b32 a32, 0
    v_accvgpr_write_b32 a33, 0
    v_accvgpr_write_b32 a34, 0
    v_accvgpr_write_b32 a35, 0
    v_accvgpr_write_b32 a36, 0
    v_accvgpr_write_b32 a37, 0
    v_accvgpr_write_b32 a38, 0
    v_accvgpr_write_b32 a39, 0
    v_accvgpr_write_b32 a40, 0
    v_accvgpr_write_b32 a41, 0
    v_accvgpr_write_b32 a42, 0
    v_accvgpr_write_b32 a43, 0
    v_accvgpr_write_b32 a44, 0
    v_accvgpr_write_b32 a45, 0
    v_accvgpr_write_b32 a46, 0
    v_accvgpr_write_b32 a47, 0
    v_accvgpr_write_b32 a48, 0
    v_accvgpr_write_b32 a49, 0
    v_accvgpr_write_b32 a50, 0
    v_accvgpr_write_b32 a51, 0
    v_accvgpr_write_b32 a52, 0
    v_accvgpr_write_b32 a53, 0
    v_accvgpr_write_b32 a54, 0
    v_accvgpr_write_b32 a55, 0
    v_accvgpr_write_b32 a56, 0
    v_accvgpr_write_b32 a57, 0
    v_accvgpr_write_b32 a58, 0
    v_accvgpr_write_b32 a59, 0
    v_accvgpr_write_b32 a60, 0
    v_accvgpr_write_b32 a61, 0
    v_accvgpr_write_b32 a62, 0
    v_accvgpr_write_b32 a63, 0
    v_accvgpr_write_b32 a64, 0
    v_accvgpr_write_b32 a65, 0
    v_accvgpr_write_b32 a66, 0
    v_accvgpr_write_b32 a67, 0
    v_accvgpr_write_b32 a68, 0
    v_accvgpr_write_b32 a69, 0
    v_accvgpr_write_b32 a70, 0
    v_accvgpr_write_b32 a71, 0
    v_accvgpr_write_b32 a72, 0
    v_accvgpr_write_b32 a73, 0
    v_accvgpr_write_b32 a74, 0
    v_accvgpr_write_b32 a75, 0
    v_accvgpr_write_b32 a76, 0
    v_accvgpr_write_b32 a77, 0
    v_accvgpr_write_b32 a78, 0
    v_accvgpr_write_b32 a79, 0
    v_accvgpr_write_b32 a80, 0
    v_accvgpr_write_b32 a81, 0
    v_accvgpr_write_b32 a82, 0
    v_accvgpr_write_b32 a83, 0
    v_accvgpr_write_b32 a84, 0
    v_accvgpr_write_b32 a85, 0
    v_accvgpr_write_b32 a86, 0
    v_accvgpr_write_b32 a87, 0
    v_accvgpr_write_b32 a88, 0
    v_accvgpr_write_b32 a89, 0
    v_accvgpr_write_b32 a90, 0
    v_accvgpr_write_b32 a91, 0
    v_accvgpr_write_b32 a92, 0
    v_accvgpr_write_b32 a93, 0
    v_accvgpr_write_b32 a94, 0
    v_accvgpr_write_b32 a95, 0
    v_accvgpr_write_b32 a96, 0
    v_accvgpr_write_b32 a97, 0
    v_accvgpr_write_b32 a98, 0
    v_accvgpr_write_b32 a99, 0
    v_accvgpr_write_b32 a100, 0
    v_accvgpr_write_b32 a101, 0
    v_accvgpr_write_b32 a102, 0
    v_accvgpr_write_b32 a103, 0
    v_accvgpr_write_b32 a104, 0
    v_accvgpr_write_b32 a105, 0
    v_accvgpr_write_b32 a106, 0
    v_accvgpr_write_b32 a107, 0
    v_accvgpr_write_b32 a108, 0
    v_accvgpr_write_b32 a109, 0
    v_accvgpr_write_b32 a110, 0
    v_accvgpr_write_b32 a111, 0
    v_accvgpr_write_b32 a112, 0
    v_accvgpr_write_b32 a113, 0
    v_accvgpr_write_b32 a114, 0
    v_accvgpr_write_b32 a115, 0
    v_accvgpr_write_b32 a116, 0
    v_accvgpr_write_b32 a117, 0
    v_accvgpr_write_b32 a118, 0
    v_accvgpr_write_b32 a119, 0
    v_accvgpr_write_b32 a120, 0
    v_accvgpr_write_b32 a121, 0
    v_accvgpr_write_b32 a122, 0
    v_accvgpr_write_b32 a123, 0
    v_accvgpr_write_b32 a124, 0
    v_accvgpr_write_b32 a125, 0
    v_accvgpr_write_b32 a126, 0
    v_accvgpr_write_b32 a127, 0
    v_accvgpr_write_b32 a128, 0
    v_accvgpr_write_b32 a129, 0
    v_accvgpr_write_b32 a130, 0
    v_accvgpr_write_b32 a131, 0
    v_accvgpr_write_b32 a132, 0
    v_accvgpr_write_b32 a133, 0
    v_accvgpr_write_b32 a134, 0
    v_accvgpr_write_b32 a135, 0
    v_accvgpr_write_b32 a136, 0
    v_accvgpr_write_b32 a137, 0
    v_accvgpr_write_b32 a138, 0
    v_accvgpr_write_b32 a139, 0
    v_accvgpr_write_b32 a140, 0
    v_accvgpr_write_b32 a141, 0
    v_accvgpr_write_b32 a142, 0
    v_accvgpr_write_b32 a143, 0
    v_accvgpr_write_b32 a144, 0
    v_accvgpr_write_b32 a145, 0
    v_accvgpr_write_b32 a146, 0
    v_accvgpr_write_b32 a147, 0
    v_accvgpr_write_b32 a148, 0
    v_accvgpr_write_b32 a149, 0
    v_accvgpr_write_b32 a150, 0
    v_accvgpr_write_b32 a151, 0
    v_accvgpr_write_b32 a152, 0
    v_accvgpr_write_b32 a153, 0
    v_accvgpr_write_b32 a154, 0
    v_accvgpr_write_b32 a155, 0
    s_mov_b32 s100, s34
    s_mov_b32 s101, 16
    L_slow2:
    s_add_u32 s33, s100, 0
    buffer_load_dwordx4 v[64:67], v104, s[12:15], s33 offen offset:0
    buffer_load_dwordx4 v[68:71], v104, s[12:15], s33 offen offset:64
    buffer_load_dwordx4 v[72:75], v104, s[12:15], s33 offen offset:128
    buffer_load_dwordx4 v[76:79], v104, s[12:15], s33 offen offset:192
    buffer_load_dwordx4 v[80:83], v104, s[12:15], s33 offen offset:256
    buffer_load_dwordx4 v[84:87], v104, s[12:15], s33 offen offset:320
    s_waitcnt vmcnt(0)
    v_mfma_f32_16x16x32_bf16 v[116:119], v[64:67], v[112:115], v[212:215]
    v_mfma_f32_16x16x32_bf16 v[124:127], v[64:67], v[120:123], v[220:223]
    v_mfma_f32_16x16x32_bf16 v[132:135], v[64:67], v[128:131], v[228:231]
    v_mfma_f32_16x16x32_bf16 v[116:119], v[68:71], v[136:139], v[116:119]
    v_mfma_f32_16x16x32_bf16 v[124:127], v[68:71], v[144:147], v[124:127]
    v_mfma_f32_16x16x32_bf16 v[132:135], v[68:71], v[152:155], v[132:135]
    v_mfma_f32_16x16x32_bf16 v[116:119], v[72:75], v[160:163], v[116:119]
    v_mfma_f32_16x16x32_bf16 v[124:127], v[72:75], v[168:171], v[124:127]
    v_mfma_f32_16x16x32_bf16 v[132:135], v[72:75], v[176:179], v[132:135]
    v_mfma_f32_16x16x32_bf16 v[116:119], v[76:79], v[184:187], v[116:119]
    v_mfma_f32_16x16x32_bf16 v[124:127], v[76:79], v[192:195], v[124:127]
    v_mfma_f32_16x16x32_bf16 v[132:135], v[76:79], v[200:203], v[132:135]
    v_mfma_f32_16x16x32_bf16 v[116:119], v[80:83], v[208:211], v[116:119]
    v_mfma_f32_16x16x32_bf16 v[124:127], v[80:83], v[216:219], v[124:127]
    v_mfma_f32_16x16x32_bf16 v[132:135], v[80:83], v[224:227], v[132:135]
    v_mfma_f32_16x16x32_bf16 v[116:119], v[84:87], v[232:235], v[116:119]
    v_mfma_f32_16x16x32_bf16 v[124:127], v[84:87], v[240:243], v[124:127]
    v_mfma_f32_16x16x32_bf16 v[132:135], v[84:87], v[248:251], v[132:135]
    s_nop 7
    s_nop 7
    s_add_u32 s33, s100, 6144
    buffer_load_dwordx4 v[64:67], v104, s[12:15], s33 offen offset:0
    buffer_load_dwordx4 v[68:71], v104, s[12:15], s33 offen offset:64
    buffer_load_dwordx4 v[72:75], v104, s[12:15], s33 offen offset:128
    buffer_load_dwordx4 v[76:79], v104, s[12:15], s33 offen offset:192
    buffer_load_dwordx4 v[80:83], v104, s[12:15], s33 offen offset:256
    buffer_load_dwordx4 v[84:87], v104, s[12:15], s33 offen offset:320
    s_waitcnt vmcnt(0)
    v_mfma_f32_16x16x32_bf16 v[140:143], v[64:67], v[112:115], v[212:215]
    v_mfma_f32_16x16x32_bf16 v[148:151], v[64:67], v[120:123], v[220:223]
    v_mfma_f32_16x16x32_bf16 v[156:159], v[64:67], v[128:131], v[228:231]
    v_mfma_f32_16x16x32_bf16 v[140:143], v[68:71], v[136:139], v[140:143]
    v_mfma_f32_16x16x32_bf16 v[148:151], v[68:71], v[144:147], v[148:151]
    v_mfma_f32_16x16x32_bf16 v[156:159], v[68:71], v[152:155], v[156:159]
    v_mfma_f32_16x16x32_bf16 v[140:143], v[72:75], v[160:163], v[140:143]
    v_mfma_f32_16x16x32_bf16 v[148:151], v[72:75], v[168:171], v[148:151]
    v_mfma_f32_16x16x32_bf16 v[156:159], v[72:75], v[176:179], v[156:159]
    v_mfma_f32_16x16x32_bf16 v[140:143], v[76:79], v[184:187], v[140:143]
    v_mfma_f32_16x16x32_bf16 v[148:151], v[76:79], v[192:195], v[148:151]
    v_mfma_f32_16x16x32_bf16 v[156:159], v[76:79], v[200:203], v[156:159]
    v_mfma_f32_16x16x32_bf16 v[140:143], v[80:83], v[208:211], v[140:143]
    v_mfma_f32_16x16x32_bf16 v[148:151], v[80:83], v[216:219], v[148:151]
    v_mfma_f32_16x16x32_bf16 v[156:159], v[80:83], v[224:227], v[156:159]
    v_mfma_f32_16x16x32_bf16 v[140:143], v[84:87], v[232:235], v[140:143]
    v_mfma_f32_16x16x32_bf16 v[148:151], v[84:87], v[240:243], v[148:151]
    v_mfma_f32_16x16x32_bf16 v[156:159], v[84:87], v[248:251], v[156:159]
    s_nop 7
    s_nop 7
    v_exp_f32 v116, v116
    v_exp_f32 v117, v117
    v_exp_f32 v118, v118
    v_exp_f32 v119, v119
    v_exp_f32 v140, v140
    v_exp_f32 v141, v141
    v_exp_f32 v142, v142
    v_exp_f32 v143, v143
    v_exp_f32 v124, v124
    v_exp_f32 v125, v125
    v_exp_f32 v126, v126
    v_exp_f32 v127, v127
    v_exp_f32 v148, v148
    v_exp_f32 v149, v149
    v_exp_f32 v150, v150
    v_exp_f32 v151, v151
    v_exp_f32 v132, v132
    v_exp_f32 v133, v133
    v_exp_f32 v134, v134
    v_exp_f32 v135, v135
    v_exp_f32 v156, v156
    v_exp_f32 v157, v157
    v_exp_f32 v158, v158
    v_exp_f32 v159, v159
    s_nop 1
    v_cvt_pk_bf16_f32 v164, v116, v117
    v_cvt_pk_bf16_f32 v165, v118, v119
    v_cvt_pk_bf16_f32 v166, v140, v141
    v_cvt_pk_bf16_f32 v167, v142, v143
    v_cvt_pk_bf16_f32 v172, v124, v125
    v_cvt_pk_bf16_f32 v173, v126, v127
    v_cvt_pk_bf16_f32 v174, v148, v149
    v_cvt_pk_bf16_f32 v175, v150, v151
    v_cvt_pk_bf16_f32 v180, v132, v133
    v_cvt_pk_bf16_f32 v181, v134, v135
    v_cvt_pk_bf16_f32 v182, v156, v157
    v_cvt_pk_bf16_f32 v183, v158, v159
    s_nop 1
    v_mfma_f32_16x16x32_bf16 a[144:147], a[156:159], v[164:167], a[144:147]
    v_mfma_f32_16x16x32_bf16 a[148:151], a[156:159], v[172:175], a[148:151]
    v_mfma_f32_16x16x32_bf16 a[152:155], a[156:159], v[180:183], a[152:155]
    s_add_u32 m0, s35, 0
    s_add_u32 s33, s100, 0
    buffer_load_dwordx4 v105, s[16:19], s33 offen lds
    s_add_u32 m0, s35, 1024
    s_add_u32 s33, s100, 3072
    buffer_load_dwordx4 v105, s[16:19], s33 offen lds
    s_add_u32 m0, s35, 2048
    s_add_u32 s33, s100, 6144
    buffer_load_dwordx4 v105, s[16:19], s33 offen lds
    s_add_u32 m0, s35, 3072
    s_add_u32 s33, s100, 9216
    buffer_load_dwordx4 v105, s[16:19], s33 offen lds
    s_waitcnt vmcnt(0)
    ds_read_b64_tr_b16 v[88:89], v106 offset:0
    ds_read_b64_tr_b16 v[90:91], v106 offset:2048
    ds_read_b64_tr_b16 v[92:93], v106 offset:32
    ds_read_b64_tr_b16 v[94:95], v106 offset:2080
    ds_read_b64_tr_b16 v[96:97], v106 offset:64
    ds_read_b64_tr_b16 v[98:99], v106 offset:2112
    ds_read_b64_tr_b16 v[100:101], v106 offset:96
    ds_read_b64_tr_b16 v[102:103], v106 offset:2144
    s_waitcnt lgkmcnt(0)
    v_mfma_f32_16x16x32_bf16 a[0:3], v[88:91], v[164:167], a[0:3]
    v_mfma_f32_16x16x32_bf16 a[4:7], v[88:91], v[172:175], a[4:7]
    v_mfma_f32_16x16x32_bf16 a[8:11], v[88:91], v[180:183], a[8:11]
    v_mfma_f32_16x16x32_bf16 a[12:15], v[92:95], v[164:167], a[12:15]
    v_mfma_f32_16x16x32_bf16 a[16:19], v[92:95], v[172:175], a[16:19]
    v_mfma_f32_16x16x32_bf16 a[20:23], v[92:95], v[180:183], a[20:23]
    v_mfma_f32_16x16x32_bf16 a[24:27], v[96:99], v[164:167], a[24:27]
    v_mfma_f32_16x16x32_bf16 a[28:31], v[96:99], v[172:175], a[28:31]
    v_mfma_f32_16x16x32_bf16 a[32:35], v[96:99], v[180:183], a[32:35]
    v_mfma_f32_16x16x32_bf16 a[36:39], v[100:103], v[164:167], a[36:39]
    v_mfma_f32_16x16x32_bf16 a[40:43], v[100:103], v[172:175], a[40:43]
    v_mfma_f32_16x16x32_bf16 a[44:47], v[100:103], v[180:183], a[44:47]
    s_nop 7
    s_add_u32 m0, s35, 0
    s_add_u32 s33, s100, 128
    buffer_load_dwordx4 v105, s[16:19], s33 offen lds
    s_add_u32 m0, s35, 1024
    s_add_u32 s33, s100, 3200
    buffer_load_dwordx4 v105, s[16:19], s33 offen lds
    s_add_u32 m0, s35, 2048
    s_add_u32 s33, s100, 6272
    buffer_load_dwordx4 v105, s[16:19], s33 offen lds
    s_add_u32 m0, s35, 3072
    s_add_u32 s33, s100, 9344
    buffer_load_dwordx4 v105, s[16:19], s33 offen lds
    s_waitcnt vmcnt(0)
    ds_read_b64_tr_b16 v[88:89], v106 offset:0
    ds_read_b64_tr_b16 v[90:91], v106 offset:2048
    ds_read_b64_tr_b16 v[92:93], v106 offset:32
    ds_read_b64_tr_b16 v[94:95], v106 offset:2080
    ds_read_b64_tr_b16 v[96:97], v106 offset:64
    ds_read_b64_tr_b16 v[98:99], v106 offset:2112
    ds_read_b64_tr_b16 v[100:101], v106 offset:96
    ds_read_b64_tr_b16 v[102:103], v106 offset:2144
    s_waitcnt lgkmcnt(0)
    v_mfma_f32_16x16x32_bf16 a[48:51], v[88:91], v[164:167], a[48:51]
    v_mfma_f32_16x16x32_bf16 a[52:55], v[88:91], v[172:175], a[52:55]
    v_mfma_f32_16x16x32_bf16 a[56:59], v[88:91], v[180:183], a[56:59]
    v_mfma_f32_16x16x32_bf16 a[60:63], v[92:95], v[164:167], a[60:63]
    v_mfma_f32_16x16x32_bf16 a[64:67], v[92:95], v[172:175], a[64:67]
    v_mfma_f32_16x16x32_bf16 a[68:71], v[92:95], v[180:183], a[68:71]
    v_mfma_f32_16x16x32_bf16 a[72:75], v[96:99], v[164:167], a[72:75]
    v_mfma_f32_16x16x32_bf16 a[76:79], v[96:99], v[172:175], a[76:79]
    v_mfma_f32_16x16x32_bf16 a[80:83], v[96:99], v[180:183], a[80:83]
    v_mfma_f32_16x16x32_bf16 a[84:87], v[100:103], v[164:167], a[84:87]
    v_mfma_f32_16x16x32_bf16 a[88:91], v[100:103], v[172:175], a[88:91]
    v_mfma_f32_16x16x32_bf16 a[92:95], v[100:103], v[180:183], a[92:95]
    s_nop 7
    s_add_u32 m0, s35, 0
    s_add_u32 s33, s100, 256
    buffer_load_dwordx4 v105, s[16:19], s33 offen lds
    s_add_u32 m0, s35, 1024
    s_add_u32 s33, s100, 3328
    buffer_load_dwordx4 v105, s[16:19], s33 offen lds
    s_add_u32 m0, s35, 2048
    s_add_u32 s33, s100, 6400
    buffer_load_dwordx4 v105, s[16:19], s33 offen lds
    s_add_u32 m0, s35, 3072
    s_add_u32 s33, s100, 9472
    buffer_load_dwordx4 v105, s[16:19], s33 offen lds
    s_waitcnt vmcnt(0)
    ds_read_b64_tr_b16 v[88:89], v106 offset:0
    ds_read_b64_tr_b16 v[90:91], v106 offset:2048
    ds_read_b64_tr_b16 v[92:93], v106 offset:32
    ds_read_b64_tr_b16 v[94:95], v106 offset:2080
    ds_read_b64_tr_b16 v[96:97], v106 offset:64
    ds_read_b64_tr_b16 v[98:99], v106 offset:2112
    ds_read_b64_tr_b16 v[100:101], v106 offset:96
    ds_read_b64_tr_b16 v[102:103], v106 offset:2144
    s_waitcnt lgkmcnt(0)
    v_mfma_f32_16x16x32_bf16 a[96:99], v[88:91], v[164:167], a[96:99]
    v_mfma_f32_16x16x32_bf16 a[100:103], v[88:91], v[172:175], a[100:103]
    v_mfma_f32_16x16x32_bf16 a[104:107], v[88:91], v[180:183], a[104:107]
    v_mfma_f32_16x16x32_bf16 a[108:111], v[92:95], v[164:167], a[108:111]
    v_mfma_f32_16x16x32_bf16 a[112:115], v[92:95], v[172:175], a[112:115]
    v_mfma_f32_16x16x32_bf16 a[116:119], v[92:95], v[180:183], a[116:119]
    v_mfma_f32_16x16x32_bf16 a[120:123], v[96:99], v[164:167], a[120:123]
    v_mfma_f32_16x16x32_bf16 a[124:127], v[96:99], v[172:175], a[124:127]
    v_mfma_f32_16x16x32_bf16 a[128:131], v[96:99], v[180:183], a[128:131]
    v_mfma_f32_16x16x32_bf16 a[132:135], v[100:103], v[164:167], a[132:135]
    v_mfma_f32_16x16x32_bf16 a[136:139], v[100:103], v[172:175], a[136:139]
    v_mfma_f32_16x16x32_bf16 a[140:143], v[100:103], v[180:183], a[140:143]
    s_nop 7
    s_add_u32 s100, s100, 12288
    s_sub_u32 s101, s101, 1
    s_cmp_lg_u32 s101, 0
    s_cbranch_scc1 L_slow2
    s_nop 7
    s_nop 7
    s_branch L_slow_ret
L_ool2:
    s_cmp_lg_u32 s31, 0
    s_cbranch_scc1 L_poll1_d
    v_accvgpr_read_b32 v104, a240
    s_mov_b32 s34, 0
L_poll1:
    buffer_load_dword v105, v104, s[52:55], 0 offen sc1
    s_waitcnt vmcnt(0)
    v_readfirstlane_b32 s35, v105
    s_add_u32 s34, s34, 1
    s_nop 2
    s_lshr_b32 s35, s35, 8
    s_and_b32 s35, s35, 0xff
    s_cmp_ge_u32 s35, 4
    s_cbranch_scc1 L_poll1_d
    s_sleep 2
    s_cmp_lt_u32 s34, 0x80000
    s_cbranch_scc1 L_poll1
L_poll1_d:
    s_branch L_ool2_r
L_ool4:
    s_cmp_lg_u32 s31, 0
    s_cbranch_scc1 L_sig3
    v_accvgpr_read_b32 v104, a240
    v_mov_b32 v105, 256
    buffer_atomic_add v105, v104, s[52:55], 0 offen sc1
L_sig3:
    s_branch L_ool4_r
L_ool6:
    s_cmp_lg_u32 s31, 0
    s_cbranch_scc1 L_sig5
    v_accvgpr_read_b32 v104, a240
    v_mov_b32 v105, 1
    buffer_atomic_add v105, v104, s[52:55], 0 offen sc1
L_sig5:
    s_branch L_ool6_r
L_ool8:
    s_cmp_lg_u32 s89, 0
    s_cbranch_scc1 L_sig7
    s_cmp_lg_u32 s31, 0
    s_cbranch_scc1 L_sig7
    v_accvgpr_read_b32 v104, a241
    v_mov_b32 v105, 65536
    buffer_atomic_add v105, v104, s[52:55], 0 offen sc1
L_sig7:
    s_branch L_ool8_r
L_code_end:
.section .rodata,"a"
.p2align 6
.amdhsa_kernel concat_heads__mha_block_cached__gqa_block_cached__near_ridge_kernel
  .amdhsa_next_free_vgpr 512
  .amdhsa_next_free_sgpr 102
  .amdhsa_accum_offset 256
  .amdhsa_group_segment_fixed_size 0
  .amdhsa_kernarg_size 104
  .amdhsa_user_sgpr_count 2
  .amdhsa_user_sgpr_kernarg_segment_ptr 1
  .amdhsa_system_sgpr_workgroup_id_x 1
.end_amdhsa_kernel
```
